```python
import torch

def _softmax(x, axis=-1):
    return torch.softmax(x, dim=axis)
def _gelu(x):
    return torch.nn.functional.gelu(x, approximate="tanh")
def _silu(x):
    return torch.nn.functional.silu(x)
def _sigmoid(x):
    return torch.sigmoid(x)
def _layernorm(x, axis=-1, eps=1e-5):
    m = x.mean(dim=axis, keepdim=True)
    v = x.var(dim=axis, keepdim=True, unbiased=False)
    return (x - m) / torch.sqrt(v + eps)
def _scatter_add(tgt, idx, src, axis=0):
    return tgt.clone().index_add_(axis, idx, src)
def _segment_sum(src, seg, n):
    out = torch.zeros((n,) + src.shape[1:], dtype=src.dtype)
    return out.index_add_(0, seg, src)
def _pad(x, pw):
    flat = tuple(v for pair in reversed(pw) for v in pair)
    return torch.nn.functional.pad(x, flat)

kernel_name = 'concat_heads__gqa_block_cached__gqa_block_cached__near_ridge'

def setup_inputs():

    _w = (lambda a: (lambda t: t.to(torch.bfloat16) if t.is_floating_point() else t)(torch.as_tensor(a)))
    def _A_setup():
        B, Sq, D = 16, 80, 512
        Hq, Hkv, Sk, Dh = 32, 32, 80, 128
        assert Hq % Hkv == 0, (Hq, Hkv)
        return {
            "x": _w((lambda *s: torch.randn(*s, dtype=torch.bfloat16) * 0.8)(B, Sq, D)),
            "k_cache": _w((lambda *s: torch.randn(*s, dtype=torch.bfloat16) * 0.8)(B, Hkv, Sk, Dh)),
            "v_cache": _w((lambda *s: torch.randn(*s, dtype=torch.bfloat16) * 0.05)(B, Hkv, Sk, Dh)),
            "wq": _w((lambda *s: torch.randn(*s, dtype=torch.bfloat16) * 0.8)(D, Hq * Dh) * (D ** -0.5)),
            "wo": _w((lambda *s: torch.randn(*s, dtype=torch.bfloat16) * 0.05)(Hq * Dh, D) * ((Hq * Dh) ** -0.5)),
        }
    _A_in = _A_setup()

    def _B_setup():
        B, Sq, D = 16, 80, 512
        Hq, Hkv, Sk, Dh = 32, 32, 80, 128
        assert Hq % Hkv == 0, (Hq, Hkv)
        return {
            "x": _w((lambda *s: torch.randn(*s, dtype=torch.bfloat16) * 0.8)(B, Sq, D)),
            "k_cache": _w((lambda *s: torch.randn(*s, dtype=torch.bfloat16) * 0.8)(B, Hkv, Sk, Dh)),
            "v_cache": _w((lambda *s: torch.randn(*s, dtype=torch.bfloat16) * 0.05)(B, Hkv, Sk, Dh)),
            "wq": _w((lambda *s: torch.randn(*s, dtype=torch.bfloat16) * 0.8)(D, Hq * Dh) * (D ** -0.5)),
            "wo": _w((lambda *s: torch.randn(*s, dtype=torch.bfloat16) * 0.05)(Hq * Dh, D) * ((Hq * Dh) ** -0.5)),
        }
    _B_in = _B_setup()

    return {
        "A_x": _A_in["x"],
        "A_k_cache": _A_in["k_cache"],
        "A_v_cache": _A_in["v_cache"],
        "A_wq": _A_in["wq"],
        "A_wo": _A_in["wo"],
        "B_x": _B_in["x"],
        "B_k_cache": _B_in["k_cache"],
        "B_v_cache": _B_in["v_cache"],
        "B_wq": _B_in["wq"],
        "B_wo": _B_in["wo"],
    }

def reference(A_x, A_k_cache, A_v_cache, A_wq, A_wo, B_x, B_k_cache, B_v_cache, B_wq, B_wo):
    def _A_ref(x, k_cache, v_cache, wq, wo):
        B, Sq, D = x.shape
        Hq, Dh = 32, 128
        Hkv = k_cache.shape[1]
        rep = Hq // Hkv
        q = (lambda x, *d: x.permute(*d))((x @ wq).reshape(B, Sq, Hq, Dh), 0, 2, 1, 3)
        k = (lambda x, n, axis: torch.repeat_interleave(x, n, dim=axis))(k_cache, rep, axis=1)
        v = (lambda x, n, axis: torch.repeat_interleave(x, n, dim=axis))(v_cache, rep, axis=1)
        scores = torch.einsum("bhqd,bhkd->bhqk", q, k) * (Dh ** -0.5)
        p = _softmax(scores, axis=-1)
        o = torch.einsum("bhqk,bhkd->bhqd", p, v)
        return (lambda x, *d: x.permute(*d))(o, 0, 2, 1, 3).reshape(B, Sq, Hq * Dh) @ wo

    def _B_ref(x, k_cache, v_cache, wq, wo):
        B, Sq, D = x.shape
        Hq, Dh = 32, 128
        Hkv = k_cache.shape[1]
        rep = Hq // Hkv
        q = (lambda x, *d: x.permute(*d))((x @ wq).reshape(B, Sq, Hq, Dh), 0, 2, 1, 3)
        k = (lambda x, n, axis: torch.repeat_interleave(x, n, dim=axis))(k_cache, rep, axis=1)
        v = (lambda x, n, axis: torch.repeat_interleave(x, n, dim=axis))(v_cache, rep, axis=1)
        scores = torch.einsum("bhqd,bhkd->bhqk", q, k) * (Dh ** -0.5)
        p = _softmax(scores, axis=-1)
        o = torch.einsum("bhqk,bhkd->bhqd", p, v)
        return (lambda x, *d: x.permute(*d))(o, 0, 2, 1, 3).reshape(B, Sq, Hq * Dh) @ wo

    a = _A_ref(A_x, A_k_cache, A_v_cache, A_wq, A_wo)
    b = _B_ref(B_x, B_k_cache, B_v_cache, B_wq, B_wo)
    return torch.concatenate([a, b], axis=-1)
```

```asm
; @launch grid=(256,1,1) block=(256,1,1) lds=163840
.amdgcn_target "amdgcn-amd-amdhsa--gfx950"
.text
.globl concat_heads__gqa_block_cached__gqa_block_cached__near_ridge_kernel
.p2align 8
.type concat_heads__gqa_block_cached__gqa_block_cached__near_ridge_kernel,@function
concat_heads__gqa_block_cached__gqa_block_cached__near_ridge_kernel:
    s_load_dwordx16 s[48:63], s[0:1], 0
    s_load_dwordx4 s[64:67], s[0:1], 64
    s_load_dwordx2 s[16:17], s[0:1], 96
    s_load_dwordx4 s[80:83], s[0:1], 80
    s_cmp_ge_u32 s2, 256
    s_cbranch_scc1 L_main_end
    s_lshr_b32 s38, s2, 3
    s_and_b32 s33, s38, 15
    s_getpc_b64 s[76:77]
L_pc:
    s_sub_u32 s76, s76, L_pc-concat_heads__gqa_block_cached__gqa_block_cached__near_ridge_kernel
    s_subb_u32 s77, s77, 0
    s_mov_b32 s78, L_code_end-concat_heads__gqa_block_cached__gqa_block_cached__near_ridge_kernel
    s_mov_b32 s79, 0x20000
    s_lshl_b32 s39, s33, 12
    v_lshlrev_b32 v24, 4, v0
    buffer_load_dwordx4 v[28:31], v24, s[76:79], s39 offen
    s_lshr_b32 s38, s38, 4
    s_and_b32 s34, s2, 3
    s_lshl_b32 s34, s34, 1
    s_add_u32 s34, s34, s38
    s_bfe_u32 s35, s2, 0x10002
    v_lshrrev_b32 v22, 6, v0
    v_and_b32 v1, 63, v0
    v_and_b32 v2, 15, v0
    v_readfirstlane_b32 s32, v22
    v_lshrrev_b32 v3, 4, v1
    s_mov_b32 s42, 0x05040100
    s_mov_b32 s43, 0x07060302
    s_lshl_b32 s46, s34, 2
    s_add_u32 s46, s46, s32
    v_lshlrev_b32 v4, 16, v3
    v_lshl_add_u32 v4, v2, 4, v4
    s_lshl_b32 s38, s46, 8
    v_add_u32 v4, s38, v4
    v_add_u32 v5, 8192, v4
    v_add_u32 v6, 16384, v4
    v_add_u32 v7, 24576, v4
    v_add_u32 v8, 32768, v4
    v_add_u32 v9, 40960, v4
    v_add_u32 v10, 49152, v4
    v_add_u32 v11, 57344, v4
    v_xor_b32 v23, v2, v3
    v_lshlrev_b32 v23, 4, v23
    v_lshl_add_u32 v0, v3, 10, v23
    s_lshr_b32 s38, s33, 2
    s_and_b32 s39, s33, 3
    s_lshl_b32 s39, s39, 1
    s_lshr_b32 s39, 0xe79, s39
    s_mov_b32 s88, 0
    s_add_u32 s84, s38, 0
    s_and_b32 s84, s84, 3
    s_lshl_b32 s84, s84, 20
    s_add_u32 s85, s38, 1
    s_and_b32 s85, s85, 3
    s_lshl_b32 s85, s85, 20
    s_bfe_u32 s89, s39, 0x20000
    s_lshl_b32 s89, s89, 18
    s_add_u32 s86, s38, 2
    s_and_b32 s86, s86, 3
    s_lshl_b32 s86, s86, 20
    s_bfe_u32 s90, s39, 0x20002
    s_lshl_b32 s90, s90, 18
    s_add_u32 s87, s38, 3
    s_and_b32 s87, s87, 3
    s_lshl_b32 s87, s87, 20
    s_bfe_u32 s91, s39, 0x20004
    s_lshl_b32 s91, s91, 18
    s_mul_i32 s100, s33, 81920
    s_mul_i32 s39, s32, 20480
    s_add_u32 s100, s100, s39
    s_mul_i32 s101, s32, 5120
    s_add_u32 s70, s32, 0
    s_and_b32 s70, s70, 3
    s_lshl_b32 s70, s70, 6
    s_add_u32 s71, s32, 1
    s_and_b32 s71, s71, 3
    s_lshl_b32 s71, s71, 6
    s_add_u32 s72, s32, 2
    s_and_b32 s72, s72, 3
    s_lshl_b32 s72, s72, 6
    s_add_u32 s73, s32, 3
    s_and_b32 s73, s73, 3
    s_lshl_b32 s73, s73, 6
    s_add_u32 s74, s32, 4
    s_and_b32 s74, s74, 3
    s_lshl_b32 s74, s74, 6
    s_waitcnt lgkmcnt(0)
    s_cmp_eq_u32 s35, 0
    s_cselect_b32 s8, s54, s64
    s_cselect_b32 s9, s55, s65
    s_mov_b32 s10, 0x400000
    s_mov_b32 s11, 0x20000
    s_cselect_b32 s12, s48, s58
    s_cselect_b32 s13, s49, s59
    s_mov_b32 s14, 0x140000
    s_mov_b32 s15, 0x20000
    s_cselect_b32 s20, s50, s60
    s_cselect_b32 s21, s51, s61
    s_mov_b32 s22, 0xa00000
    s_mov_b32 s23, 0x20000
    s_cselect_b32 s24, s52, s62
    s_cselect_b32 s25, s53, s63
    s_mov_b32 s26, 0xa00000
    s_mov_b32 s27, 0x20000
    s_cselect_b32 s28, s56, s66
    s_cselect_b32 s29, s57, s67
    s_mov_b32 s30, 0x400000
    s_mov_b32 s31, 0x20000
    s_add_u32 s37, s84, s88
    buffer_load_dwordx4 v[24:27], v4, s[8:11], s37 offen
    buffer_load_dwordx4 v[28:31], v5, s[8:11], s37 offen
    buffer_load_dwordx4 v[32:35], v6, s[8:11], s37 offen
    buffer_load_dwordx4 v[36:39], v7, s[8:11], s37 offen
    buffer_load_dwordx4 v[40:43], v8, s[8:11], s37 offen
    buffer_load_dwordx4 v[44:47], v9, s[8:11], s37 offen
    buffer_load_dwordx4 v[48:51], v10, s[8:11], s37 offen
    buffer_load_dwordx4 v[52:55], v11, s[8:11], s37 offen
    s_lshr_b32 s40, s84, 12
    s_add_u32 s40, s40, s100
    v_xor_b32 v22, s70, v0
    s_add_u32 m0, s101, 0
    s_add_u32 s5, s40, 0
    buffer_load_dwordx4 v22, s[12:15], s5 offen lds
    v_xor_b32 v22, s71, v0
    s_add_u32 m0, s101, 1024
    s_add_u32 s5, s40, 4096
    buffer_load_dwordx4 v22, s[12:15], s5 offen lds
    v_xor_b32 v22, s72, v0
    s_add_u32 m0, s101, 2048
    s_add_u32 s5, s40, 8192
    buffer_load_dwordx4 v22, s[12:15], s5 offen lds
    v_xor_b32 v22, s73, v0
    s_add_u32 m0, s101, 3072
    s_add_u32 s5, s40, 12288
    buffer_load_dwordx4 v22, s[12:15], s5 offen lds
    v_xor_b32 v22, s74, v0
    s_add_u32 m0, s101, 4096
    s_add_u32 s5, s40, 16384
    buffer_load_dwordx4 v22, s[12:15], s5 offen lds
    s_add_u32 s37, s84, s89
    buffer_load_dwordx4 v[56:59], v4, s[8:11], s37 offen
    buffer_load_dwordx4 v[60:63], v5, s[8:11], s37 offen
    buffer_load_dwordx4 v[64:67], v6, s[8:11], s37 offen
    buffer_load_dwordx4 v[68:71], v7, s[8:11], s37 offen
    buffer_load_dwordx4 v[72:75], v8, s[8:11], s37 offen
    buffer_load_dwordx4 v[76:79], v9, s[8:11], s37 offen
    buffer_load_dwordx4 v[80:83], v10, s[8:11], s37 offen
    buffer_load_dwordx4 v[84:87], v11, s[8:11], s37 offen
    s_mov_b32 s18, 0x10000000
    s_mov_b32 s19, 0x20000
    s_lshl_b32 s7, s35, 4
    s_add_u32 s7, s7, s33
    s_lshl_b32 s75, s7, 2
    s_add_u32 s75, s75, s32
    s_lshl_b32 s75, s75, 7
    s_lshl_b32 s38, s34, 2
    s_add_u32 s75, s75, s38
    s_add_u32 s75, s75, 0x1600000
    v_mov_b32 v16, 0
    s_mov_b64 exec, 1
    buffer_store_dword v16, v16, s[16:19], s75 offen sc1
    s_mov_b64 exec, -1
    s_mov_b32 s76, s82
    s_mov_b32 s77, s83
    s_mov_b32 s78, 256
    s_mov_b32 s79, 0x20000
    s_mov_b32 s82, 0x280000
    s_mov_b32 s83, 0x20000
    v_lshlrev_b32 v12, 12, v3
    v_lshl_add_u32 v12, v2, 4, v12
    s_lshl_b32 s38, s34, 19
    s_lshl_b32 s39, s32, 8
    s_add_u32 s38, s38, s39
    v_add_u32 v12, s38, v12
    v_add_u32 v13, 0x4000, v12
    v_lshl_add_u32 v14, v2, 8, v23
    s_mov_b32 s92, 0
    s_lshr_b32 s96, s88, 12
    s_mov_b32 s93, 20480
    s_lshr_b32 s97, s89, 12
    s_mov_b32 s94, 40960
    s_lshr_b32 s98, s90, 12
    s_mov_b32 s95, 61440
    s_lshr_b32 s99, s91, 12
    v_lshlrev_b32 v16, 2, v3
    v_xor_b32 v16, v16, v2
    v_lshlrev_b32 v16, 4, v16
    v_lshl_add_u32 v17, v3, 8, v16
    v_xor_b32 v18, 16, v17
    v_xor_b32 v19, 32, v17
    v_xor_b32 v20, 48, v17
    v_lshlrev_b32 v16, 1, v3
    v_xor_b32 v16, v16, v2
    v_lshlrev_b32 v16, 4, v16
    v_lshl_add_u32 v21, v3, 8, v16
    v_xor_b32 v23, 128, v21
    s_lshl_b32 s36, s33, 5
    s_add_u32 s36, s36, s46
    s_mul_i32 s36, s36, 20480
    s_lshl_b32 s3, s32, 12
    s_mul_i32 s47, s32, 20480
    s_add_u32 s47, s47, 81920
    s_mov_b32 s44, 0x3e0293ee
    s_mov_b32 s45, 0x3e0293ee
    s_lshl_b32 s38, s7, 2
    s_add_u32 s38, s38, s32
    s_lshl_b32 s38, s38, 3
    s_add_u32 s38, s38, s34
    s_mul_i32 s54, s38, 20736
    s_lshr_b32 s38, s34, 1
    s_and_b32 s39, s34, 1
    s_mul_i32 s39, s39, 10
    s_add_u32 s39, s39, s32
    s_lshl_b32 s40, s7, 2
    s_add_u32 s40, s40, s38
    s_lshl_b32 s55, s40, 7
    s_add_u32 s55, s55, 0x1600000
    s_mul_i32 s40, s40, 165888
    s_add_u32 s40, s40, 0
    s_mul_i32 s41, s33, 163840
    s_lshl_b32 s4, s35, 10
    s_add_u32 s41, s41, s4
    s_lshl_b32 s4, s38, 8
    s_add_u32 s41, s41, s4
    s_lshr_b32 s5, s39, 2
    s_and_b32 s6, s39, 3
    s_lshl_b32 s48, s5, 12
    s_lshl_b32 s4, s6, 8
    s_add_u32 s48, s48, s4
    s_add_u32 s48, s48, s40
    s_lshl_b32 s51, s5, 15
    s_lshl_b32 s4, s6, 6
    s_add_u32 s51, s51, s4
    s_add_u32 s51, s51, s41
    s_add_u32 s49, s48, 4096
    s_add_u32 s50, s48, 8192
    s_add_u32 s52, s51, 0x8000
    s_add_u32 s53, s51, 0x10000
    s_cmp_lt_u32 s32, 2
    s_cselect_b32 s50, s50, 0x7f000000
    s_cselect_b32 s53, s53, 0x7f000000
    s_lshl_b32 s56, s7, 3
    s_waitcnt vmcnt(9)
    s_barrier
    s_bitcmp1_b32 s2, 5
    s_cbranch_scc1 L_g1b
    v_xor_b32 v15, s96, v14
    ds_read_b128 a[160:163], v15
    ds_read_b128 a[164:167], v15 offset:4096
    ds_read_b128 a[168:171], v15 offset:8192
    ds_read_b128 a[172:175], v15 offset:12288
    ds_read_b128 a[176:179], v15 offset:16384
    v_perm_b32 v152, v28, v24, s42
    v_perm_b32 v153, v36, v32, s42
    v_perm_b32 v154, v44, v40, s42
    v_perm_b32 v155, v52, v48, s42
    s_nop 0
    s_waitcnt lgkmcnt(0)
    v_mfma_f32_16x16x32_bf16 a[0:3], v[152:155], a[160:163], 0
    v_perm_b32 v156, v28, v24, s43
    v_perm_b32 v157, v36, v32, s43
    v_mfma_f32_16x16x32_bf16 a[32:35], v[152:155], a[164:167], 0
    v_perm_b32 v158, v44, v40, s43
    v_perm_b32 v159, v52, v48, s43
    v_mfma_f32_16x16x32_bf16 a[64:67], v[152:155], a[168:171], 0
    v_mfma_f32_16x16x32_bf16 a[96:99], v[152:155], a[172:175], 0
    s_add_u32 s37, s84, s90
    buffer_load_dwordx4 v[88:91], v4, s[8:11], s37 offen
    v_mfma_f32_16x16x32_bf16 a[128:131], v[152:155], a[176:179], 0
    v_xor_b32 v15, s97, v14
    ds_read_b128 a[180:183], v15
    v_mfma_f32_16x16x32_bf16 a[4:7], v[156:159], a[160:163], 0
    v_perm_b32 v160, v29, v25, s42
    v_perm_b32 v161, v37, v33, s42
    v_mfma_f32_16x16x32_bf16 a[36:39], v[156:159], a[164:167], 0
    v_perm_b32 v162, v45, v41, s42
    v_perm_b32 v163, v53, v49, s42
    v_mfma_f32_16x16x32_bf16 a[68:71], v[156:159], a[168:171], 0
    v_mfma_f32_16x16x32_bf16 a[100:103], v[156:159], a[172:175], 0
    buffer_load_dwordx4 v[92:95], v5, s[8:11], s37 offen
    v_mfma_f32_16x16x32_bf16 a[132:135], v[156:159], a[176:179], 0
    ds_read_b128 a[184:187], v15 offset:4096
    v_mfma_f32_16x16x32_bf16 a[8:11], v[160:163], a[160:163], 0
    v_perm_b32 v152, v29, v25, s43
    v_perm_b32 v153, v37, v33, s43
    v_mfma_f32_16x16x32_bf16 a[40:43], v[160:163], a[164:167], 0
    v_perm_b32 v154, v45, v41, s43
    v_perm_b32 v155, v53, v49, s43
    v_mfma_f32_16x16x32_bf16 a[72:75], v[160:163], a[168:171], 0
    v_mfma_f32_16x16x32_bf16 a[104:107], v[160:163], a[172:175], 0
    buffer_load_dwordx4 v[96:99], v6, s[8:11], s37 offen
    v_mfma_f32_16x16x32_bf16 a[136:139], v[160:163], a[176:179], 0
    ds_read_b128 a[188:191], v15 offset:8192
    v_mfma_f32_16x16x32_bf16 a[12:15], v[152:155], a[160:163], 0
    v_perm_b32 v156, v30, v26, s42
    v_perm_b32 v157, v38, v34, s42
    v_mfma_f32_16x16x32_bf16 a[44:47], v[152:155], a[164:167], 0
    v_perm_b32 v158, v46, v42, s42
    v_perm_b32 v159, v54, v50, s42
    v_mfma_f32_16x16x32_bf16 a[76:79], v[152:155], a[168:171], 0
    v_mfma_f32_16x16x32_bf16 a[108:111], v[152:155], a[172:175], 0
    buffer_load_dwordx4 v[100:103], v7, s[8:11], s37 offen
    v_mfma_f32_16x16x32_bf16 a[140:143], v[152:155], a[176:179], 0
    ds_read_b128 a[192:195], v15 offset:12288
    v_mfma_f32_16x16x32_bf16 a[16:19], v[156:159], a[160:163], 0
    v_perm_b32 v160, v30, v26, s43
    v_perm_b32 v161, v38, v34, s43
    v_mfma_f32_16x16x32_bf16 a[48:51], v[156:159], a[164:167], 0
    v_perm_b32 v162, v46, v42, s43
    v_perm_b32 v163, v54, v50, s43
    v_mfma_f32_16x16x32_bf16 a[80:83], v[156:159], a[168:171], 0
    v_mfma_f32_16x16x32_bf16 a[112:115], v[156:159], a[172:175], 0
    buffer_load_dwordx4 v[104:107], v8, s[8:11], s37 offen
    v_mfma_f32_16x16x32_bf16 a[144:147], v[156:159], a[176:179], 0
    ds_read_b128 a[196:199], v15 offset:16384
    v_mfma_f32_16x16x32_bf16 a[20:23], v[160:163], a[160:163], 0
    v_perm_b32 v152, v31, v27, s42
    v_perm_b32 v153, v39, v35, s42
    v_mfma_f32_16x16x32_bf16 a[52:55], v[160:163], a[164:167], 0
    v_perm_b32 v154, v47, v43, s42
    v_perm_b32 v155, v55, v51, s42
    v_mfma_f32_16x16x32_bf16 a[84:87], v[160:163], a[168:171], 0
    v_mfma_f32_16x16x32_bf16 a[116:119], v[160:163], a[172:175], 0
    buffer_load_dwordx4 v[108:111], v9, s[8:11], s37 offen
    v_mfma_f32_16x16x32_bf16 a[148:151], v[160:163], a[176:179], 0
    v_mfma_f32_16x16x32_bf16 a[24:27], v[152:155], a[160:163], 0
    v_perm_b32 v156, v31, v27, s43
    v_perm_b32 v157, v39, v35, s43
    v_mfma_f32_16x16x32_bf16 a[56:59], v[152:155], a[164:167], 0
    v_perm_b32 v158, v47, v43, s43
    v_perm_b32 v159, v55, v51, s43
    v_mfma_f32_16x16x32_bf16 a[88:91], v[152:155], a[168:171], 0
    v_mfma_f32_16x16x32_bf16 a[120:123], v[152:155], a[172:175], 0
    buffer_load_dwordx4 v[112:115], v10, s[8:11], s37 offen
    v_mfma_f32_16x16x32_bf16 a[152:155], v[152:155], a[176:179], 0
    v_mfma_f32_16x16x32_bf16 a[28:31], v[156:159], a[160:163], 0
    s_waitcnt vmcnt(8)
    v_perm_b32 v160, v60, v56, s42
    v_perm_b32 v161, v68, v64, s42
    v_mfma_f32_16x16x32_bf16 a[60:63], v[156:159], a[164:167], 0
    v_perm_b32 v162, v76, v72, s42
    v_perm_b32 v163, v84, v80, s42
    v_mfma_f32_16x16x32_bf16 a[92:95], v[156:159], a[168:171], 0
    v_mfma_f32_16x16x32_bf16 a[124:127], v[156:159], a[172:175], 0
    buffer_load_dwordx4 v[116:119], v11, s[8:11], s37 offen
    v_mfma_f32_16x16x32_bf16 a[156:159], v[156:159], a[176:179], 0
    s_waitcnt lgkmcnt(0)
    v_mfma_f32_16x16x32_bf16 a[0:3], v[160:163], a[180:183], a[0:3]
    v_perm_b32 v152, v60, v56, s43
    v_perm_b32 v153, v68, v64, s43
    v_mfma_f32_16x16x32_bf16 a[32:35], v[160:163], a[184:187], a[32:35]
    v_perm_b32 v154, v76, v72, s43
    v_perm_b32 v155, v84, v80, s43
    v_mfma_f32_16x16x32_bf16 a[64:67], v[160:163], a[188:191], a[64:67]
    s_add_u32 s37, s84, s91
    buffer_load_dwordx4 v[120:123], v4, s[8:11], s37 offen
    v_mfma_f32_16x16x32_bf16 a[96:99], v[160:163], a[192:195], a[96:99]
    buffer_load_dwordx4 v[124:127], v5, s[8:11], s37 offen
    v_mfma_f32_16x16x32_bf16 a[128:131], v[160:163], a[196:199], a[128:131]
    v_xor_b32 v15, s98, v14
    ds_read_b128 a[200:203], v15
    v_mfma_f32_16x16x32_bf16 a[4:7], v[152:155], a[180:183], a[4:7]
    v_perm_b32 v156, v61, v57, s42
    v_perm_b32 v157, v69, v65, s42
    v_mfma_f32_16x16x32_bf16 a[36:39], v[152:155], a[184:187], a[36:39]
    v_perm_b32 v158, v77, v73, s42
    v_perm_b32 v159, v85, v81, s42
    v_mfma_f32_16x16x32_bf16 a[68:71], v[152:155], a[188:191], a[68:71]
    buffer_load_dwordx4 v[128:131], v6, s[8:11], s37 offen
    v_mfma_f32_16x16x32_bf16 a[100:103], v[152:155], a[192:195], a[100:103]
    buffer_load_dwordx4 v[132:135], v7, s[8:11], s37 offen
    v_mfma_f32_16x16x32_bf16 a[132:135], v[152:155], a[196:199], a[132:135]
    ds_read_b128 a[204:207], v15 offset:4096
    v_mfma_f32_16x16x32_bf16 a[8:11], v[156:159], a[180:183], a[8:11]
    v_perm_b32 v160, v61, v57, s43
    v_perm_b32 v161, v69, v65, s43
    v_mfma_f32_16x16x32_bf16 a[40:43], v[156:159], a[184:187], a[40:43]
    v_perm_b32 v162, v77, v73, s43
    v_perm_b32 v163, v85, v81, s43
    v_mfma_f32_16x16x32_bf16 a[72:75], v[156:159], a[188:191], a[72:75]
    buffer_load_dwordx4 v[136:139], v8, s[8:11], s37 offen
    v_mfma_f32_16x16x32_bf16 a[104:107], v[156:159], a[192:195], a[104:107]
    buffer_load_dwordx4 v[140:143], v9, s[8:11], s37 offen
    v_mfma_f32_16x16x32_bf16 a[136:139], v[156:159], a[196:199], a[136:139]
    ds_read_b128 a[208:211], v15 offset:8192
    v_mfma_f32_16x16x32_bf16 a[12:15], v[160:163], a[180:183], a[12:15]
    v_perm_b32 v152, v62, v58, s42
    v_perm_b32 v153, v70, v66, s42
    v_mfma_f32_16x16x32_bf16 a[44:47], v[160:163], a[184:187], a[44:47]
    v_perm_b32 v154, v78, v74, s42
    v_perm_b32 v155, v86, v82, s42
    v_mfma_f32_16x16x32_bf16 a[76:79], v[160:163], a[188:191], a[76:79]
    buffer_load_dwordx4 v[144:147], v10, s[8:11], s37 offen
    v_mfma_f32_16x16x32_bf16 a[108:111], v[160:163], a[192:195], a[108:111]
    buffer_load_dwordx4 v[148:151], v11, s[8:11], s37 offen
    v_mfma_f32_16x16x32_bf16 a[140:143], v[160:163], a[196:199], a[140:143]
    ds_read_b128 a[212:215], v15 offset:12288
    v_mfma_f32_16x16x32_bf16 a[16:19], v[152:155], a[180:183], a[16:19]
    v_perm_b32 v156, v62, v58, s43
    v_perm_b32 v157, v70, v66, s43
    v_mfma_f32_16x16x32_bf16 a[48:51], v[152:155], a[184:187], a[48:51]
    v_perm_b32 v158, v78, v74, s43
    v_perm_b32 v159, v86, v82, s43
    v_mfma_f32_16x16x32_bf16 a[80:83], v[152:155], a[188:191], a[80:83]
    s_lshr_b32 s40, s85, 12
    s_add_u32 s40, s40, s100
    v_xor_b32 v22, s70, v0
    s_add_u32 m0, s101, 20480
    s_add_u32 s5, s40, 0
    buffer_load_dwordx4 v22, s[12:15], s5 offen lds
    v_mfma_f32_16x16x32_bf16 a[112:115], v[152:155], a[192:195], a[112:115]
    v_xor_b32 v22, s71, v0
    s_add_u32 m0, s101, 21504
    s_add_u32 s5, s40, 4096
    buffer_load_dwordx4 v22, s[12:15], s5 offen lds
    v_mfma_f32_16x16x32_bf16 a[144:147], v[152:155], a[196:199], a[144:147]
    ds_read_b128 a[216:219], v15 offset:16384
    v_mfma_f32_16x16x32_bf16 a[20:23], v[156:159], a[180:183], a[20:23]
    v_perm_b32 v160, v63, v59, s42
    v_perm_b32 v161, v71, v67, s42
    v_mfma_f32_16x16x32_bf16 a[52:55], v[156:159], a[184:187], a[52:55]
    v_perm_b32 v162, v79, v75, s42
    v_perm_b32 v163, v87, v83, s42
    v_mfma_f32_16x16x32_bf16 a[84:87], v[156:159], a[188:191], a[84:87]
    v_xor_b32 v22, s72, v0
    s_add_u32 m0, s101, 22528
    s_add_u32 s5, s40, 8192
    buffer_load_dwordx4 v22, s[12:15], s5 offen lds
    v_mfma_f32_16x16x32_bf16 a[116:119], v[156:159], a[192:195], a[116:119]
    v_xor_b32 v22, s73, v0
    s_add_u32 m0, s101, 23552
    s_add_u32 s5, s40, 12288
    buffer_load_dwordx4 v22, s[12:15], s5 offen lds
    v_mfma_f32_16x16x32_bf16 a[148:151], v[156:159], a[196:199], a[148:151]
    v_mfma_f32_16x16x32_bf16 a[24:27], v[160:163], a[180:183], a[24:27]
    v_perm_b32 v152, v63, v59, s43
    v_perm_b32 v153, v71, v67, s43
    v_mfma_f32_16x16x32_bf16 a[56:59], v[160:163], a[184:187], a[56:59]
    v_perm_b32 v154, v79, v75, s43
    v_perm_b32 v155, v87, v83, s43
    v_mfma_f32_16x16x32_bf16 a[88:91], v[160:163], a[188:191], a[88:91]
    v_xor_b32 v22, s74, v0
    s_add_u32 m0, s101, 24576
    s_add_u32 s5, s40, 16384
    buffer_load_dwordx4 v22, s[12:15], s5 offen lds
    v_mfma_f32_16x16x32_bf16 a[120:123], v[160:163], a[192:195], a[120:123]
    v_mfma_f32_16x16x32_bf16 a[152:155], v[160:163], a[196:199], a[152:155]
    v_mfma_f32_16x16x32_bf16 a[28:31], v[152:155], a[180:183], a[28:31]
    s_waitcnt vmcnt(13)
    v_perm_b32 v156, v92, v88, s42
    v_perm_b32 v157, v100, v96, s42
    v_mfma_f32_16x16x32_bf16 a[60:63], v[152:155], a[184:187], a[60:63]
    v_perm_b32 v158, v108, v104, s42
    v_perm_b32 v159, v116, v112, s42
    v_mfma_f32_16x16x32_bf16 a[92:95], v[152:155], a[188:191], a[92:95]
    v_mfma_f32_16x16x32_bf16 a[124:127], v[152:155], a[192:195], a[124:127]
    v_mfma_f32_16x16x32_bf16 a[156:159], v[152:155], a[196:199], a[156:159]
    s_waitcnt lgkmcnt(0)
    v_mfma_f32_16x16x32_bf16 a[0:3], v[156:159], a[200:203], a[0:3]
    v_perm_b32 v160, v92, v88, s43
    v_perm_b32 v161, v100, v96, s43
    v_mfma_f32_16x16x32_bf16 a[32:35], v[156:159], a[204:207], a[32:35]
    v_perm_b32 v162, v108, v104, s43
    v_perm_b32 v163, v116, v112, s43
    v_mfma_f32_16x16x32_bf16 a[64:67], v[156:159], a[208:211], a[64:67]
    s_add_u32 s37, s85, s88
    buffer_load_dwordx4 v[24:27], v4, s[8:11], s37 offen
    v_mfma_f32_16x16x32_bf16 a[96:99], v[156:159], a[212:215], a[96:99]
    buffer_load_dwordx4 v[28:31], v5, s[8:11], s37 offen
    v_mfma_f32_16x16x32_bf16 a[128:131], v[156:159], a[216:219], a[128:131]
    v_xor_b32 v15, s99, v14
    ds_read_b128 a[160:163], v15
    v_mfma_f32_16x16x32_bf16 a[4:7], v[160:163], a[200:203], a[4:7]
    v_perm_b32 v152, v93, v89, s42
    v_perm_b32 v153, v101, v97, s42
    v_mfma_f32_16x16x32_bf16 a[36:39], v[160:163], a[204:207], a[36:39]
    v_perm_b32 v154, v109, v105, s42
    v_perm_b32 v155, v117, v113, s42
    v_mfma_f32_16x16x32_bf16 a[68:71], v[160:163], a[208:211], a[68:71]
    buffer_load_dwordx4 v[32:35], v6, s[8:11], s37 offen
    v_mfma_f32_16x16x32_bf16 a[100:103], v[160:163], a[212:215], a[100:103]
    buffer_load_dwordx4 v[36:39], v7, s[8:11], s37 offen
    v_mfma_f32_16x16x32_bf16 a[132:135], v[160:163], a[216:219], a[132:135]
    ds_read_b128 a[164:167], v15 offset:4096
    v_mfma_f32_16x16x32_bf16 a[8:11], v[152:155], a[200:203], a[8:11]
    v_perm_b32 v156, v93, v89, s43
    v_perm_b32 v157, v101, v97, s43
    v_mfma_f32_16x16x32_bf16 a[40:43], v[152:155], a[204:207], a[40:43]
    v_perm_b32 v158, v109, v105, s43
    v_perm_b32 v159, v117, v113, s43
    v_mfma_f32_16x16x32_bf16 a[72:75], v[152:155], a[208:211], a[72:75]
    buffer_load_dwordx4 v[40:43], v8, s[8:11], s37 offen
    v_mfma_f32_16x16x32_bf16 a[104:107], v[152:155], a[212:215], a[104:107]
    buffer_load_dwordx4 v[44:47], v9, s[8:11], s37 offen
    v_mfma_f32_16x16x32_bf16 a[136:139], v[152:155], a[216:219], a[136:139]
    ds_read_b128 a[168:171], v15 offset:8192
    v_mfma_f32_16x16x32_bf16 a[12:15], v[156:159], a[200:203], a[12:15]
    v_perm_b32 v160, v94, v90, s42
    v_perm_b32 v161, v102, v98, s42
    v_mfma_f32_16x16x32_bf16 a[44:47], v[156:159], a[204:207], a[44:47]
    v_perm_b32 v162, v110, v106, s42
    v_perm_b32 v163, v118, v114, s42
    v_mfma_f32_16x16x32_bf16 a[76:79], v[156:159], a[208:211], a[76:79]
    buffer_load_dwordx4 v[48:51], v10, s[8:11], s37 offen
    v_mfma_f32_16x16x32_bf16 a[108:111], v[156:159], a[212:215], a[108:111]
    buffer_load_dwordx4 v[52:55], v11, s[8:11], s37 offen
    v_mfma_f32_16x16x32_bf16 a[140:143], v[156:159], a[216:219], a[140:143]
    ds_read_b128 a[172:175], v15 offset:12288
    v_mfma_f32_16x16x32_bf16 a[16:19], v[160:163], a[200:203], a[16:19]
    v_perm_b32 v152, v94, v90, s43
    v_perm_b32 v153, v102, v98, s43
    v_mfma_f32_16x16x32_bf16 a[48:51], v[160:163], a[204:207], a[48:51]
    v_perm_b32 v154, v110, v106, s43
    v_perm_b32 v155, v118, v114, s43
    v_mfma_f32_16x16x32_bf16 a[80:83], v[160:163], a[208:211], a[80:83]
    s_add_u32 s37, s85, s89
    buffer_load_dwordx4 v[56:59], v4, s[8:11], s37 offen
    v_mfma_f32_16x16x32_bf16 a[112:115], v[160:163], a[212:215], a[112:115]
    buffer_load_dwordx4 v[60:63], v5, s[8:11], s37 offen
    v_mfma_f32_16x16x32_bf16 a[144:147], v[160:163], a[216:219], a[144:147]
    ds_read_b128 a[176:179], v15 offset:16384
    v_mfma_f32_16x16x32_bf16 a[20:23], v[152:155], a[200:203], a[20:23]
    v_perm_b32 v156, v95, v91, s42
    v_perm_b32 v157, v103, v99, s42
    v_mfma_f32_16x16x32_bf16 a[52:55], v[152:155], a[204:207], a[52:55]
    v_perm_b32 v158, v111, v107, s42
    v_perm_b32 v159, v119, v115, s42
    v_mfma_f32_16x16x32_bf16 a[84:87], v[152:155], a[208:211], a[84:87]
    buffer_load_dwordx4 v[64:67], v6, s[8:11], s37 offen
    v_mfma_f32_16x16x32_bf16 a[116:119], v[152:155], a[212:215], a[116:119]
    buffer_load_dwordx4 v[68:71], v7, s[8:11], s37 offen
    v_mfma_f32_16x16x32_bf16 a[148:151], v[152:155], a[216:219], a[148:151]
    v_mfma_f32_16x16x32_bf16 a[24:27], v[156:159], a[200:203], a[24:27]
    v_perm_b32 v160, v95, v91, s43
    v_perm_b32 v161, v103, v99, s43
    v_mfma_f32_16x16x32_bf16 a[56:59], v[156:159], a[204:207], a[56:59]
    v_perm_b32 v162, v111, v107, s43
    v_perm_b32 v163, v119, v115, s43
    v_mfma_f32_16x16x32_bf16 a[88:91], v[156:159], a[208:211], a[88:91]
    buffer_load_dwordx4 v[72:75], v8, s[8:11], s37 offen
    v_mfma_f32_16x16x32_bf16 a[120:123], v[156:159], a[212:215], a[120:123]
    buffer_load_dwordx4 v[76:79], v9, s[8:11], s37 offen
    v_mfma_f32_16x16x32_bf16 a[152:155], v[156:159], a[216:219], a[152:155]
    v_mfma_f32_16x16x32_bf16 a[28:31], v[160:163], a[200:203], a[28:31]
    s_waitcnt vmcnt(19)
    v_perm_b32 v152, v124, v120, s42
    v_perm_b32 v153, v132, v128, s42
    v_mfma_f32_16x16x32_bf16 a[60:63], v[160:163], a[204:207], a[60:63]
    v_perm_b32 v154, v140, v136, s42
    v_perm_b32 v155, v148, v144, s42
    v_mfma_f32_16x16x32_bf16 a[92:95], v[160:163], a[208:211], a[92:95]
    buffer_load_dwordx4 v[80:83], v10, s[8:11], s37 offen
    v_mfma_f32_16x16x32_bf16 a[124:127], v[160:163], a[212:215], a[124:127]
    buffer_load_dwordx4 v[84:87], v11, s[8:11], s37 offen
    v_mfma_f32_16x16x32_bf16 a[156:159], v[160:163], a[216:219], a[156:159]
    s_waitcnt lgkmcnt(0)
    s_waitcnt vmcnt(16)
    s_barrier
    v_mfma_f32_16x16x32_bf16 a[0:3], v[152:155], a[160:163], a[0:3]
    v_perm_b32 v156, v124, v120, s43
    v_perm_b32 v157, v132, v128, s43
    v_mfma_f32_16x16x32_bf16 a[32:35], v[152:155], a[164:167], a[32:35]
    v_perm_b32 v158, v140, v136, s43
    v_perm_b32 v159, v148, v144, s43
    v_mfma_f32_16x16x32_bf16 a[64:67], v[152:155], a[168:171], a[64:67]
    s_add_u32 s37, s85, s90
    buffer_load_dwordx4 v[88:91], v4, s[8:11], s37 offen
    v_mfma_f32_16x16x32_bf16 a[96:99], v[152:155], a[172:175], a[96:99]
    buffer_load_dwordx4 v[92:95], v5, s[8:11], s37 offen
    v_mfma_f32_16x16x32_bf16 a[128:131], v[152:155], a[176:179], a[128:131]
    v_xor_b32 v15, s96, v14
    ds_read_b128 a[180:183], v15 offset:20480
    v_mfma_f32_16x16x32_bf16 a[4:7], v[156:159], a[160:163], a[4:7]
    v_perm_b32 v160, v125, v121, s42
    v_perm_b32 v161, v133, v129, s42
    v_mfma_f32_16x16x32_bf16 a[36:39], v[156:159], a[164:167], a[36:39]
    v_perm_b32 v162, v141, v137, s42
    v_perm_b32 v163, v149, v145, s42
    v_mfma_f32_16x16x32_bf16 a[68:71], v[156:159], a[168:171], a[68:71]
    buffer_load_dwordx4 v[96:99], v6, s[8:11], s37 offen
    v_mfma_f32_16x16x32_bf16 a[100:103], v[156:159], a[172:175], a[100:103]
    buffer_load_dwordx4 v[100:103], v7, s[8:11], s37 offen
    v_mfma_f32_16x16x32_bf16 a[132:135], v[156:159], a[176:179], a[132:135]
    ds_read_b128 a[184:187], v15 offset:24576
    v_mfma_f32_16x16x32_bf16 a[8:11], v[160:163], a[160:163], a[8:11]
    v_perm_b32 v152, v125, v121, s43
    v_perm_b32 v153, v133, v129, s43
    v_mfma_f32_16x16x32_bf16 a[40:43], v[160:163], a[164:167], a[40:43]
    v_perm_b32 v154, v141, v137, s43
    v_perm_b32 v155, v149, v145, s43
    v_mfma_f32_16x16x32_bf16 a[72:75], v[160:163], a[168:171], a[72:75]
    buffer_load_dwordx4 v[104:107], v8, s[8:11], s37 offen
    v_mfma_f32_16x16x32_bf16 a[104:107], v[160:163], a[172:175], a[104:107]
    buffer_load_dwordx4 v[108:111], v9, s[8:11], s37 offen
    v_mfma_f32_16x16x32_bf16 a[136:139], v[160:163], a[176:179], a[136:139]
    ds_read_b128 a[188:191], v15 offset:28672
    v_mfma_f32_16x16x32_bf16 a[12:15], v[152:155], a[160:163], a[12:15]
    v_perm_b32 v156, v126, v122, s42
    v_perm_b32 v157, v134, v130, s42
    v_mfma_f32_16x16x32_bf16 a[44:47], v[152:155], a[164:167], a[44:47]
    v_perm_b32 v158, v142, v138, s42
    v_perm_b32 v159, v150, v146, s42
    v_mfma_f32_16x16x32_bf16 a[76:79], v[152:155], a[168:171], a[76:79]
    buffer_load_dwordx4 v[112:115], v10, s[8:11], s37 offen
    v_mfma_f32_16x16x32_bf16 a[108:111], v[152:155], a[172:175], a[108:111]
    buffer_load_dwordx4 v[116:119], v11, s[8:11], s37 offen
    v_mfma_f32_16x16x32_bf16 a[140:143], v[152:155], a[176:179], a[140:143]
    ds_read_b128 a[192:195], v15 offset:32768
    v_mfma_f32_16x16x32_bf16 a[16:19], v[156:159], a[160:163], a[16:19]
    v_perm_b32 v160, v126, v122, s43
    v_perm_b32 v161, v134, v130, s43
    v_mfma_f32_16x16x32_bf16 a[48:51], v[156:159], a[164:167], a[48:51]
    v_perm_b32 v162, v142, v138, s43
    v_perm_b32 v163, v150, v146, s43
    v_mfma_f32_16x16x32_bf16 a[80:83], v[156:159], a[168:171], a[80:83]
    s_lshr_b32 s40, s86, 12
    s_add_u32 s40, s40, s100
    v_xor_b32 v22, s70, v0
    s_add_u32 m0, s101, 40960
    s_add_u32 s5, s40, 0
    buffer_load_dwordx4 v22, s[12:15], s5 offen lds
    v_mfma_f32_16x16x32_bf16 a[112:115], v[156:159], a[172:175], a[112:115]
    v_xor_b32 v22, s71, v0
    s_add_u32 m0, s101, 41984
    s_add_u32 s5, s40, 4096
    buffer_load_dwordx4 v22, s[12:15], s5 offen lds
    v_mfma_f32_16x16x32_bf16 a[144:147], v[156:159], a[176:179], a[144:147]
    ds_read_b128 a[196:199], v15 offset:36864
    v_mfma_f32_16x16x32_bf16 a[20:23], v[160:163], a[160:163], a[20:23]
    v_perm_b32 v152, v127, v123, s42
    v_perm_b32 v153, v135, v131, s42
    v_mfma_f32_16x16x32_bf16 a[52:55], v[160:163], a[164:167], a[52:55]
    v_perm_b32 v154, v143, v139, s42
    v_perm_b32 v155, v151, v147, s42
    v_mfma_f32_16x16x32_bf16 a[84:87], v[160:163], a[168:171], a[84:87]
    v_xor_b32 v22, s72, v0
    s_add_u32 m0, s101, 43008
    s_add_u32 s5, s40, 8192
    buffer_load_dwordx4 v22, s[12:15], s5 offen lds
    v_mfma_f32_16x16x32_bf16 a[116:119], v[160:163], a[172:175], a[116:119]
    v_xor_b32 v22, s73, v0
    s_add_u32 m0, s101, 44032
    s_add_u32 s5, s40, 12288
    buffer_load_dwordx4 v22, s[12:15], s5 offen lds
    v_mfma_f32_16x16x32_bf16 a[148:151], v[160:163], a[176:179], a[148:151]
    v_mfma_f32_16x16x32_bf16 a[24:27], v[152:155], a[160:163], a[24:27]
    v_perm_b32 v156, v127, v123, s43
    v_perm_b32 v157, v135, v131, s43
    v_mfma_f32_16x16x32_bf16 a[56:59], v[152:155], a[164:167], a[56:59]
    v_perm_b32 v158, v143, v139, s43
    v_perm_b32 v159, v151, v147, s43
    v_mfma_f32_16x16x32_bf16 a[88:91], v[152:155], a[168:171], a[88:91]
    v_xor_b32 v22, s74, v0
    s_add_u32 m0, s101, 45056
    s_add_u32 s5, s40, 16384
    buffer_load_dwordx4 v22, s[12:15], s5 offen lds
    v_mfma_f32_16x16x32_bf16 a[120:123], v[152:155], a[172:175], a[120:123]
    s_add_u32 m0, s47, 0
    s_add_u32 s4, s36, 0
    buffer_load_dwordx4 v17, s[20:23], s4 offen nt lds
    v_mfma_f32_16x16x32_bf16 a[152:155], v[152:155], a[176:179], a[152:155]
    v_mfma_f32_16x16x32_bf16 a[28:31], v[156:159], a[160:163], a[28:31]
    s_waitcnt vmcnt(22)
    v_perm_b32 v160, v28, v24, s42
    v_perm_b32 v161, v36, v32, s42
    v_mfma_f32_16x16x32_bf16 a[60:63], v[156:159], a[164:167], a[60:63]
    v_perm_b32 v162, v44, v40, s42
    v_perm_b32 v163, v52, v48, s42
    v_mfma_f32_16x16x32_bf16 a[92:95], v[156:159], a[168:171], a[92:95]
    v_mfma_f32_16x16x32_bf16 a[124:127], v[156:159], a[172:175], a[124:127]
    v_mfma_f32_16x16x32_bf16 a[156:159], v[156:159], a[176:179], a[156:159]
    s_waitcnt lgkmcnt(0)
    v_mfma_f32_16x16x32_bf16 a[0:3], v[160:163], a[180:183], a[0:3]
    v_perm_b32 v152, v28, v24, s43
    v_perm_b32 v153, v36, v32, s43
    v_mfma_f32_16x16x32_bf16 a[32:35], v[160:163], a[184:187], a[32:35]
    v_perm_b32 v154, v44, v40, s43
    v_perm_b32 v155, v52, v48, s43
    v_mfma_f32_16x16x32_bf16 a[64:67], v[160:163], a[188:191], a[64:67]
    v_mfma_f32_16x16x32_bf16 a[96:99], v[160:163], a[192:195], a[96:99]
    s_add_u32 s37, s85, s91
    buffer_load_dwordx4 v[120:123], v4, s[8:11], s37 offen
    v_mfma_f32_16x16x32_bf16 a[128:131], v[160:163], a[196:199], a[128:131]
    v_xor_b32 v15, s97, v14
    ds_read_b128 a[200:203], v15 offset:20480
    v_mfma_f32_16x16x32_bf16 a[4:7], v[152:155], a[180:183], a[4:7]
    v_perm_b32 v156, v29, v25, s42
    v_perm_b32 v157, v37, v33, s42
    v_mfma_f32_16x16x32_bf16 a[36:39], v[152:155], a[184:187], a[36:39]
    v_perm_b32 v158, v45, v41, s42
    v_perm_b32 v159, v53, v49, s42
    v_mfma_f32_16x16x32_bf16 a[68:71], v[152:155], a[188:191], a[68:71]
    v_mfma_f32_16x16x32_bf16 a[100:103], v[152:155], a[192:195], a[100:103]
    buffer_load_dwordx4 v[124:127], v5, s[8:11], s37 offen
    v_mfma_f32_16x16x32_bf16 a[132:135], v[152:155], a[196:199], a[132:135]
    ds_read_b128 a[204:207], v15 offset:24576
    v_mfma_f32_16x16x32_bf16 a[8:11], v[156:159], a[180:183], a[8:11]
    v_perm_b32 v160, v29, v25, s43
    v_perm_b32 v161, v37, v33, s43
    v_mfma_f32_16x16x32_bf16 a[40:43], v[156:159], a[184:187], a[40:43]
    v_perm_b32 v162, v45, v41, s43
    v_perm_b32 v163, v53, v49, s43
    v_mfma_f32_16x16x32_bf16 a[72:75], v[156:159], a[188:191], a[72:75]
    v_mfma_f32_16x16x32_bf16 a[104:107], v[156:159], a[192:195], a[104:107]
    buffer_load_dwordx4 v[128:131], v6, s[8:11], s37 offen
    v_mfma_f32_16x16x32_bf16 a[136:139], v[156:159], a[196:199], a[136:139]
    ds_read_b128 a[208:211], v15 offset:28672
    v_mfma_f32_16x16x32_bf16 a[12:15], v[160:163], a[180:183], a[12:15]
    v_perm_b32 v152, v30, v26, s42
    v_perm_b32 v153, v38, v34, s42
    v_mfma_f32_16x16x32_bf16 a[44:47], v[160:163], a[184:187], a[44:47]
    v_perm_b32 v154, v46, v42, s42
    v_perm_b32 v155, v54, v50, s42
    v_mfma_f32_16x16x32_bf16 a[76:79], v[160:163], a[188:191], a[76:79]
    v_mfma_f32_16x16x32_bf16 a[108:111], v[160:163], a[192:195], a[108:111]
    buffer_load_dwordx4 v[132:135], v7, s[8:11], s37 offen
    v_mfma_f32_16x16x32_bf16 a[140:143], v[160:163], a[196:199], a[140:143]
    ds_read_b128 a[212:215], v15 offset:32768
    v_mfma_f32_16x16x32_bf16 a[16:19], v[152:155], a[180:183], a[16:19]
    v_perm_b32 v156, v30, v26, s43
    v_perm_b32 v157, v38, v34, s43
    v_mfma_f32_16x16x32_bf16 a[48:51], v[152:155], a[184:187], a[48:51]
    v_perm_b32 v158, v46, v42, s43
    v_perm_b32 v159, v54, v50, s43
    v_mfma_f32_16x16x32_bf16 a[80:83], v[152:155], a[188:191], a[80:83]
    v_mfma_f32_16x16x32_bf16 a[112:115], v[152:155], a[192:195], a[112:115]
    buffer_load_dwordx4 v[136:139], v8, s[8:11], s37 offen
    v_mfma_f32_16x16x32_bf16 a[144:147], v[152:155], a[196:199], a[144:147]
    ds_read_b128 a[216:219], v15 offset:36864
    v_mfma_f32_16x16x32_bf16 a[20:23], v[156:159], a[180:183], a[20:23]
    v_perm_b32 v160, v31, v27, s42
    v_perm_b32 v161, v39, v35, s42
    v_mfma_f32_16x16x32_bf16 a[52:55], v[156:159], a[184:187], a[52:55]
    v_perm_b32 v162, v47, v43, s42
    v_perm_b32 v163, v55, v51, s42
    v_mfma_f32_16x16x32_bf16 a[84:87], v[156:159], a[188:191], a[84:87]
    v_mfma_f32_16x16x32_bf16 a[116:119], v[156:159], a[192:195], a[116:119]
    buffer_load_dwordx4 v[140:143], v9, s[8:11], s37 offen
    v_mfma_f32_16x16x32_bf16 a[148:151], v[156:159], a[196:199], a[148:151]
    v_mfma_f32_16x16x32_bf16 a[24:27], v[160:163], a[180:183], a[24:27]
    v_perm_b32 v152, v31, v27, s43
    v_perm_b32 v153, v39, v35, s43
    v_mfma_f32_16x16x32_bf16 a[56:59], v[160:163], a[184:187], a[56:59]
    v_perm_b32 v154, v47, v43, s43
    v_perm_b32 v155, v55, v51, s43
    v_mfma_f32_16x16x32_bf16 a[88:91], v[160:163], a[188:191], a[88:91]
    v_mfma_f32_16x16x32_bf16 a[120:123], v[160:163], a[192:195], a[120:123]
    buffer_load_dwordx4 v[144:147], v10, s[8:11], s37 offen
    v_mfma_f32_16x16x32_bf16 a[152:155], v[160:163], a[196:199], a[152:155]
    v_mfma_f32_16x16x32_bf16 a[28:31], v[152:155], a[180:183], a[28:31]
    s_waitcnt vmcnt(21)
    v_perm_b32 v156, v60, v56, s42
    v_perm_b32 v157, v68, v64, s42
    v_mfma_f32_16x16x32_bf16 a[60:63], v[152:155], a[184:187], a[60:63]
    v_perm_b32 v158, v76, v72, s42
    v_perm_b32 v159, v84, v80, s42
    v_mfma_f32_16x16x32_bf16 a[92:95], v[152:155], a[188:191], a[92:95]
    v_mfma_f32_16x16x32_bf16 a[124:127], v[152:155], a[192:195], a[124:127]
    buffer_load_dwordx4 v[148:151], v11, s[8:11], s37 offen
    v_mfma_f32_16x16x32_bf16 a[156:159], v[152:155], a[196:199], a[156:159]
    s_waitcnt lgkmcnt(0)
    s_barrier
    v_mfma_f32_16x16x32_bf16 a[0:3], v[156:159], a[200:203], a[0:3]
    v_perm_b32 v160, v60, v56, s43
    v_perm_b32 v161, v68, v64, s43
    v_mfma_f32_16x16x32_bf16 a[32:35], v[156:159], a[204:207], a[32:35]
    v_perm_b32 v162, v76, v72, s43
    v_perm_b32 v163, v84, v80, s43
    v_mfma_f32_16x16x32_bf16 a[64:67], v[156:159], a[208:211], a[64:67]
    s_add_u32 s37, s86, s88
    buffer_load_dwordx4 v[24:27], v4, s[8:11], s37 offen
    v_mfma_f32_16x16x32_bf16 a[96:99], v[156:159], a[212:215], a[96:99]
    buffer_load_dwordx4 v[28:31], v5, s[8:11], s37 offen
    v_mfma_f32_16x16x32_bf16 a[128:131], v[156:159], a[216:219], a[128:131]
    v_xor_b32 v15, s98, v14
    ds_read_b128 a[160:163], v15 offset:20480
    v_mfma_f32_16x16x32_bf16 a[4:7], v[160:163], a[200:203], a[4:7]
    v_perm_b32 v152, v61, v57, s42
    v_perm_b32 v153, v69, v65, s42
    v_mfma_f32_16x16x32_bf16 a[36:39], v[160:163], a[204:207], a[36:39]
    v_perm_b32 v154, v77, v73, s42
    v_perm_b32 v155, v85, v81, s42
    v_mfma_f32_16x16x32_bf16 a[68:71], v[160:163], a[208:211], a[68:71]
    buffer_load_dwordx4 v[32:35], v6, s[8:11], s37 offen
    v_mfma_f32_16x16x32_bf16 a[100:103], v[160:163], a[212:215], a[100:103]
    buffer_load_dwordx4 v[36:39], v7, s[8:11], s37 offen
    v_mfma_f32_16x16x32_bf16 a[132:135], v[160:163], a[216:219], a[132:135]
    ds_read_b128 a[164:167], v15 offset:24576
    v_mfma_f32_16x16x32_bf16 a[8:11], v[152:155], a[200:203], a[8:11]
    v_perm_b32 v156, v61, v57, s43
    v_perm_b32 v157, v69, v65, s43
    v_mfma_f32_16x16x32_bf16 a[40:43], v[152:155], a[204:207], a[40:43]
    v_perm_b32 v158, v77, v73, s43
    v_perm_b32 v159, v85, v81, s43
    v_mfma_f32_16x16x32_bf16 a[72:75], v[152:155], a[208:211], a[72:75]
    buffer_load_dwordx4 v[40:43], v8, s[8:11], s37 offen
    v_mfma_f32_16x16x32_bf16 a[104:107], v[152:155], a[212:215], a[104:107]
    buffer_load_dwordx4 v[44:47], v9, s[8:11], s37 offen
    v_mfma_f32_16x16x32_bf16 a[136:139], v[152:155], a[216:219], a[136:139]
    ds_read_b128 a[168:171], v15 offset:28672
    v_mfma_f32_16x16x32_bf16 a[12:15], v[156:159], a[200:203], a[12:15]
    v_perm_b32 v160, v62, v58, s42
    v_perm_b32 v161, v70, v66, s42
    v_mfma_f32_16x16x32_bf16 a[44:47], v[156:159], a[204:207], a[44:47]
    v_perm_b32 v162, v78, v74, s42
    v_perm_b32 v163, v86, v82, s42
    v_mfma_f32_16x16x32_bf16 a[76:79], v[156:159], a[208:211], a[76:79]
    buffer_load_dwordx4 v[48:51], v10, s[8:11], s37 offen
    v_mfma_f32_16x16x32_bf16 a[108:111], v[156:159], a[212:215], a[108:111]
    buffer_load_dwordx4 v[52:55], v11, s[8:11], s37 offen
    v_mfma_f32_16x16x32_bf16 a[140:143], v[156:159], a[216:219], a[140:143]
    ds_read_b128 a[172:175], v15 offset:32768
    v_mfma_f32_16x16x32_bf16 a[16:19], v[160:163], a[200:203], a[16:19]
    v_perm_b32 v152, v62, v58, s43
    v_perm_b32 v153, v70, v66, s43
    v_mfma_f32_16x16x32_bf16 a[48:51], v[160:163], a[204:207], a[48:51]
    v_perm_b32 v154, v78, v74, s43
    v_perm_b32 v155, v86, v82, s43
    v_mfma_f32_16x16x32_bf16 a[80:83], v[160:163], a[208:211], a[80:83]
    s_add_u32 m0, s47, 0
    s_add_u32 s4, s36, 0
    buffer_load_dwordx4 v18, s[20:23], s4 offen offset:1024 nt lds
    v_mfma_f32_16x16x32_bf16 a[112:115], v[160:163], a[212:215], a[112:115]
    s_add_u32 m0, s47, 0
    s_add_u32 s4, s36, 0
    buffer_load_dwordx4 v19, s[20:23], s4 offen offset:2048 nt lds
    v_mfma_f32_16x16x32_bf16 a[144:147], v[160:163], a[216:219], a[144:147]
    ds_read_b128 a[176:179], v15 offset:36864
    v_mfma_f32_16x16x32_bf16 a[20:23], v[152:155], a[200:203], a[20:23]
    v_perm_b32 v156, v63, v59, s42
    v_perm_b32 v157, v71, v67, s42
    v_mfma_f32_16x16x32_bf16 a[52:55], v[152:155], a[204:207], a[52:55]
    v_perm_b32 v158, v79, v75, s42
    v_perm_b32 v159, v87, v83, s42
    v_mfma_f32_16x16x32_bf16 a[84:87], v[152:155], a[208:211], a[84:87]
    s_add_u32 m0, s47, 0
    s_add_u32 s4, s36, 0
    buffer_load_dwordx4 v20, s[20:23], s4 offen offset:3072 nt lds
    v_mfma_f32_16x16x32_bf16 a[116:119], v[152:155], a[212:215], a[116:119]
    s_add_u32 m0, s47, 4096
    s_add_u32 s4, s36, 4096
    buffer_load_dwordx4 v17, s[20:23], s4 offen nt lds
    v_mfma_f32_16x16x32_bf16 a[148:151], v[152:155], a[216:219], a[148:151]
    v_mfma_f32_16x16x32_bf16 a[24:27], v[156:159], a[200:203], a[24:27]
    v_perm_b32 v160, v63, v59, s43
    v_perm_b32 v161, v71, v67, s43
    v_mfma_f32_16x16x32_bf16 a[56:59], v[156:159], a[204:207], a[56:59]
    v_perm_b32 v162, v79, v75, s43
    v_perm_b32 v163, v87, v83, s43
    v_mfma_f32_16x16x32_bf16 a[88:91], v[156:159], a[208:211], a[88:91]
    s_add_u32 m0, s47, 4096
    s_add_u32 s4, s36, 4096
    buffer_load_dwordx4 v18, s[20:23], s4 offen offset:1024 nt lds
    v_mfma_f32_16x16x32_bf16 a[120:123], v[156:159], a[212:215], a[120:123]
    s_add_u32 m0, s47, 4096
    s_add_u32 s4, s36, 4096
    buffer_load_dwordx4 v19, s[20:23], s4 offen offset:2048 nt lds
    v_mfma_f32_16x16x32_bf16 a[152:155], v[156:159], a[216:219], a[152:155]
    v_mfma_f32_16x16x32_bf16 a[28:31], v[160:163], a[200:203], a[28:31]
    s_waitcnt vmcnt(28)
    v_perm_b32 v152, v92, v88, s42
    v_perm_b32 v153, v100, v96, s42
    v_mfma_f32_16x16x32_bf16 a[60:63], v[160:163], a[204:207], a[60:63]
    v_perm_b32 v154, v108, v104, s42
    v_perm_b32 v155, v116, v112, s42
    v_mfma_f32_16x16x32_bf16 a[92:95], v[160:163], a[208:211], a[92:95]
    v_mfma_f32_16x16x32_bf16 a[124:127], v[160:163], a[212:215], a[124:127]
    v_mfma_f32_16x16x32_bf16 a[156:159], v[160:163], a[216:219], a[156:159]
    s_waitcnt lgkmcnt(0)
    v_mfma_f32_16x16x32_bf16 a[0:3], v[152:155], a[160:163], a[0:3]
    v_perm_b32 v156, v92, v88, s43
    v_perm_b32 v157, v100, v96, s43
    v_mfma_f32_16x16x32_bf16 a[32:35], v[152:155], a[164:167], a[32:35]
    v_perm_b32 v158, v108, v104, s43
    v_perm_b32 v159, v116, v112, s43
    v_mfma_f32_16x16x32_bf16 a[64:67], v[152:155], a[168:171], a[64:67]
    v_mfma_f32_16x16x32_bf16 a[96:99], v[152:155], a[172:175], a[96:99]
    s_add_u32 s37, s86, s89
    buffer_load_dwordx4 v[56:59], v4, s[8:11], s37 offen
    v_mfma_f32_16x16x32_bf16 a[128:131], v[152:155], a[176:179], a[128:131]
    v_xor_b32 v15, s99, v14
    ds_read_b128 a[180:183], v15 offset:20480
    v_mfma_f32_16x16x32_bf16 a[4:7], v[156:159], a[160:163], a[4:7]
    v_perm_b32 v160, v93, v89, s42
    v_perm_b32 v161, v101, v97, s42
    v_mfma_f32_16x16x32_bf16 a[36:39], v[156:159], a[164:167], a[36:39]
    v_perm_b32 v162, v109, v105, s42
    v_perm_b32 v163, v117, v113, s42
    v_mfma_f32_16x16x32_bf16 a[68:71], v[156:159], a[168:171], a[68:71]
    v_mfma_f32_16x16x32_bf16 a[100:103], v[156:159], a[172:175], a[100:103]
    buffer_load_dwordx4 v[60:63], v5, s[8:11], s37 offen
    v_mfma_f32_16x16x32_bf16 a[132:135], v[156:159], a[176:179], a[132:135]
    ds_read_b128 a[184:187], v15 offset:24576
    v_mfma_f32_16x16x32_bf16 a[8:11], v[160:163], a[160:163], a[8:11]
    v_perm_b32 v152, v93, v89, s43
    v_perm_b32 v153, v101, v97, s43
    v_mfma_f32_16x16x32_bf16 a[40:43], v[160:163], a[164:167], a[40:43]
    v_perm_b32 v154, v109, v105, s43
    v_perm_b32 v155, v117, v113, s43
    v_mfma_f32_16x16x32_bf16 a[72:75], v[160:163], a[168:171], a[72:75]
    v_mfma_f32_16x16x32_bf16 a[104:107], v[160:163], a[172:175], a[104:107]
    buffer_load_dwordx4 v[64:67], v6, s[8:11], s37 offen
    v_mfma_f32_16x16x32_bf16 a[136:139], v[160:163], a[176:179], a[136:139]
    ds_read_b128 a[188:191], v15 offset:28672
    v_mfma_f32_16x16x32_bf16 a[12:15], v[152:155], a[160:163], a[12:15]
    v_perm_b32 v156, v94, v90, s42
    v_perm_b32 v157, v102, v98, s42
    v_mfma_f32_16x16x32_bf16 a[44:47], v[152:155], a[164:167], a[44:47]
    v_perm_b32 v158, v110, v106, s42
    v_perm_b32 v159, v118, v114, s42
    v_mfma_f32_16x16x32_bf16 a[76:79], v[152:155], a[168:171], a[76:79]
    v_mfma_f32_16x16x32_bf16 a[108:111], v[152:155], a[172:175], a[108:111]
    buffer_load_dwordx4 v[68:71], v7, s[8:11], s37 offen
    v_mfma_f32_16x16x32_bf16 a[140:143], v[152:155], a[176:179], a[140:143]
    ds_read_b128 a[192:195], v15 offset:32768
    v_mfma_f32_16x16x32_bf16 a[16:19], v[156:159], a[160:163], a[16:19]
    v_perm_b32 v160, v94, v90, s43
    v_perm_b32 v161, v102, v98, s43
    v_mfma_f32_16x16x32_bf16 a[48:51], v[156:159], a[164:167], a[48:51]
    v_perm_b32 v162, v110, v106, s43
    v_perm_b32 v163, v118, v114, s43
    v_mfma_f32_16x16x32_bf16 a[80:83], v[156:159], a[168:171], a[80:83]
    v_mfma_f32_16x16x32_bf16 a[112:115], v[156:159], a[172:175], a[112:115]
    buffer_load_dwordx4 v[72:75], v8, s[8:11], s37 offen
    v_mfma_f32_16x16x32_bf16 a[144:147], v[156:159], a[176:179], a[144:147]
    ds_read_b128 a[196:199], v15 offset:36864
    v_mfma_f32_16x16x32_bf16 a[20:23], v[160:163], a[160:163], a[20:23]
    v_perm_b32 v152, v95, v91, s42
    v_perm_b32 v153, v103, v99, s42
    v_mfma_f32_16x16x32_bf16 a[52:55], v[160:163], a[164:167], a[52:55]
    v_perm_b32 v154, v111, v107, s42
    v_perm_b32 v155, v119, v115, s42
    v_mfma_f32_16x16x32_bf16 a[84:87], v[160:163], a[168:171], a[84:87]
    v_mfma_f32_16x16x32_bf16 a[116:119], v[160:163], a[172:175], a[116:119]
    buffer_load_dwordx4 v[76:79], v9, s[8:11], s37 offen
    v_mfma_f32_16x16x32_bf16 a[148:151], v[160:163], a[176:179], a[148:151]
    v_mfma_f32_16x16x32_bf16 a[24:27], v[152:155], a[160:163], a[24:27]
    v_perm_b32 v156, v95, v91, s43
    v_perm_b32 v157, v103, v99, s43
    v_mfma_f32_16x16x32_bf16 a[56:59], v[152:155], a[164:167], a[56:59]
    v_perm_b32 v158, v111, v107, s43
    v_perm_b32 v159, v119, v115, s43
    v_mfma_f32_16x16x32_bf16 a[88:91], v[152:155], a[168:171], a[88:91]
    v_mfma_f32_16x16x32_bf16 a[120:123], v[152:155], a[172:175], a[120:123]
    buffer_load_dwordx4 v[80:83], v10, s[8:11], s37 offen
    v_mfma_f32_16x16x32_bf16 a[152:155], v[152:155], a[176:179], a[152:155]
    v_mfma_f32_16x16x32_bf16 a[28:31], v[156:159], a[160:163], a[28:31]
    s_waitcnt vmcnt(21)
    v_perm_b32 v160, v124, v120, s42
    v_perm_b32 v161, v132, v128, s42
    v_mfma_f32_16x16x32_bf16 a[60:63], v[156:159], a[164:167], a[60:63]
    v_perm_b32 v162, v140, v136, s42
    v_perm_b32 v163, v148, v144, s42
    v_mfma_f32_16x16x32_bf16 a[92:95], v[156:159], a[168:171], a[92:95]
    v_mfma_f32_16x16x32_bf16 a[124:127], v[156:159], a[172:175], a[124:127]
    buffer_load_dwordx4 v[84:87], v11, s[8:11], s37 offen
    v_mfma_f32_16x16x32_bf16 a[156:159], v[156:159], a[176:179], a[156:159]
    s_waitcnt lgkmcnt(0)
    s_barrier
    v_mfma_f32_16x16x32_bf16 a[0:3], v[160:163], a[180:183], a[0:3]
    v_perm_b32 v152, v124, v120, s43
    v_perm_b32 v153, v132, v128, s43
    v_mfma_f32_16x16x32_bf16 a[32:35], v[160:163], a[184:187], a[32:35]
    v_perm_b32 v154, v140, v136, s43
    v_perm_b32 v155, v148, v144, s43
    v_mfma_f32_16x16x32_bf16 a[64:67], v[160:163], a[188:191], a[64:67]
    s_add_u32 s37, s86, s90
    buffer_load_dwordx4 v[88:91], v4, s[8:11], s37 offen
    v_mfma_f32_16x16x32_bf16 a[96:99], v[160:163], a[192:195], a[96:99]
    buffer_load_dwordx4 v[92:95], v5, s[8:11], s37 offen
    v_mfma_f32_16x16x32_bf16 a[128:131], v[160:163], a[196:199], a[128:131]
    v_xor_b32 v15, s96, v14
    ds_read_b128 a[200:203], v15 offset:40960
    v_mfma_f32_16x16x32_bf16 a[4:7], v[152:155], a[180:183], a[4:7]
    v_perm_b32 v156, v125, v121, s42
    v_perm_b32 v157, v133, v129, s42
    v_mfma_f32_16x16x32_bf16 a[36:39], v[152:155], a[184:187], a[36:39]
    v_perm_b32 v158, v141, v137, s42
    v_perm_b32 v159, v149, v145, s42
    v_mfma_f32_16x16x32_bf16 a[68:71], v[152:155], a[188:191], a[68:71]
    buffer_load_dwordx4 v[96:99], v6, s[8:11], s37 offen
    v_mfma_f32_16x16x32_bf16 a[100:103], v[152:155], a[192:195], a[100:103]
    buffer_load_dwordx4 v[100:103], v7, s[8:11], s37 offen
    v_mfma_f32_16x16x32_bf16 a[132:135], v[152:155], a[196:199], a[132:135]
    ds_read_b128 a[204:207], v15 offset:45056
    v_mfma_f32_16x16x32_bf16 a[8:11], v[156:159], a[180:183], a[8:11]
    v_perm_b32 v160, v125, v121, s43
    v_perm_b32 v161, v133, v129, s43
    v_mfma_f32_16x16x32_bf16 a[40:43], v[156:159], a[184:187], a[40:43]
    v_perm_b32 v162, v141, v137, s43
    v_perm_b32 v163, v149, v145, s43
    v_mfma_f32_16x16x32_bf16 a[72:75], v[156:159], a[188:191], a[72:75]
    buffer_load_dwordx4 v[104:107], v8, s[8:11], s37 offen
    v_mfma_f32_16x16x32_bf16 a[104:107], v[156:159], a[192:195], a[104:107]
    buffer_load_dwordx4 v[108:111], v9, s[8:11], s37 offen
    v_mfma_f32_16x16x32_bf16 a[136:139], v[156:159], a[196:199], a[136:139]
    ds_read_b128 a[208:211], v15 offset:49152
    v_mfma_f32_16x16x32_bf16 a[12:15], v[160:163], a[180:183], a[12:15]
    v_perm_b32 v152, v126, v122, s42
    v_perm_b32 v153, v134, v130, s42
    v_mfma_f32_16x16x32_bf16 a[44:47], v[160:163], a[184:187], a[44:47]
    v_perm_b32 v154, v142, v138, s42
    v_perm_b32 v155, v150, v146, s42
    v_mfma_f32_16x16x32_bf16 a[76:79], v[160:163], a[188:191], a[76:79]
    buffer_load_dwordx4 v[112:115], v10, s[8:11], s37 offen
    v_mfma_f32_16x16x32_bf16 a[108:111], v[160:163], a[192:195], a[108:111]
    buffer_load_dwordx4 v[116:119], v11, s[8:11], s37 offen
    v_mfma_f32_16x16x32_bf16 a[140:143], v[160:163], a[196:199], a[140:143]
    ds_read_b128 a[212:215], v15 offset:53248
    v_mfma_f32_16x16x32_bf16 a[16:19], v[152:155], a[180:183], a[16:19]
    v_perm_b32 v156, v126, v122, s43
    v_perm_b32 v157, v134, v130, s43
    v_mfma_f32_16x16x32_bf16 a[48:51], v[152:155], a[184:187], a[48:51]
    v_perm_b32 v158, v142, v138, s43
    v_perm_b32 v159, v150, v146, s43
    v_mfma_f32_16x16x32_bf16 a[80:83], v[152:155], a[188:191], a[80:83]
    s_lshr_b32 s40, s87, 12
    s_add_u32 s40, s40, s100
    v_xor_b32 v22, s70, v0
    s_add_u32 m0, s101, 61440
    s_add_u32 s5, s40, 0
    buffer_load_dwordx4 v22, s[12:15], s5 offen lds
    v_mfma_f32_16x16x32_bf16 a[112:115], v[152:155], a[192:195], a[112:115]
    v_xor_b32 v22, s71, v0
    s_add_u32 m0, s101, 62464
    s_add_u32 s5, s40, 4096
    buffer_load_dwordx4 v22, s[12:15], s5 offen lds
    v_mfma_f32_16x16x32_bf16 a[144:147], v[152:155], a[196:199], a[144:147]
    ds_read_b128 a[216:219], v15 offset:57344
    v_mfma_f32_16x16x32_bf16 a[20:23], v[156:159], a[180:183], a[20:23]
    v_perm_b32 v160, v127, v123, s42
    v_perm_b32 v161, v135, v131, s42
    v_mfma_f32_16x16x32_bf16 a[52:55], v[156:159], a[184:187], a[52:55]
    v_perm_b32 v162, v143, v139, s42
    v_perm_b32 v163, v151, v147, s42
    v_mfma_f32_16x16x32_bf16 a[84:87], v[156:159], a[188:191], a[84:87]
    v_xor_b32 v22, s72, v0
    s_add_u32 m0, s101, 63488
    s_add_u32 s5, s40, 8192
    buffer_load_dwordx4 v22, s[12:15], s5 offen lds
    v_mfma_f32_16x16x32_bf16 a[116:119], v[156:159], a[192:195], a[116:119]
    v_xor_b32 v22, s73, v0
    s_add_u32 m0, s101, 64512
    s_add_u32 s5, s40, 12288
    buffer_load_dwordx4 v22, s[12:15], s5 offen lds
    v_mfma_f32_16x16x32_bf16 a[148:151], v[156:159], a[196:199], a[148:151]
    v_mfma_f32_16x16x32_bf16 a[24:27], v[160:163], a[180:183], a[24:27]
    v_perm_b32 v152, v127, v123, s43
    v_perm_b32 v153, v135, v131, s43
    v_mfma_f32_16x16x32_bf16 a[56:59], v[160:163], a[184:187], a[56:59]
    v_perm_b32 v154, v143, v139, s43
    v_perm_b32 v155, v151, v147, s43
    v_mfma_f32_16x16x32_bf16 a[88:91], v[160:163], a[188:191], a[88:91]
    v_xor_b32 v22, s74, v0
    s_add_u32 m0, s101, 65536
    s_add_u32 s5, s40, 16384
    buffer_load_dwordx4 v22, s[12:15], s5 offen lds
    v_mfma_f32_16x16x32_bf16 a[120:123], v[160:163], a[192:195], a[120:123]
    s_add_u32 m0, s47, 4096
    s_add_u32 s4, s36, 4096
    buffer_load_dwordx4 v20, s[20:23], s4 offen offset:3072 nt lds
    v_mfma_f32_16x16x32_bf16 a[152:155], v[160:163], a[196:199], a[152:155]
    v_mfma_f32_16x16x32_bf16 a[28:31], v[152:155], a[180:183], a[28:31]
    s_waitcnt vmcnt(28)
    v_perm_b32 v156, v28, v24, s42
    v_perm_b32 v157, v36, v32, s42
    v_mfma_f32_16x16x32_bf16 a[60:63], v[152:155], a[184:187], a[60:63]
    v_perm_b32 v158, v44, v40, s42
    v_perm_b32 v159, v52, v48, s42
    v_mfma_f32_16x16x32_bf16 a[92:95], v[152:155], a[188:191], a[92:95]
    v_mfma_f32_16x16x32_bf16 a[124:127], v[152:155], a[192:195], a[124:127]
    v_mfma_f32_16x16x32_bf16 a[156:159], v[152:155], a[196:199], a[156:159]
    s_waitcnt lgkmcnt(0)
    v_mfma_f32_16x16x32_bf16 a[0:3], v[156:159], a[200:203], a[0:3]
    v_perm_b32 v160, v28, v24, s43
    v_perm_b32 v161, v36, v32, s43
    v_mfma_f32_16x16x32_bf16 a[32:35], v[156:159], a[204:207], a[32:35]
    v_perm_b32 v162, v44, v40, s43
    v_perm_b32 v163, v52, v48, s43
    v_mfma_f32_16x16x32_bf16 a[64:67], v[156:159], a[208:211], a[64:67]
    v_mfma_f32_16x16x32_bf16 a[96:99], v[156:159], a[212:215], a[96:99]
    s_add_u32 s37, s86, s91
    buffer_load_dwordx4 v[120:123], v4, s[8:11], s37 offen
    v_mfma_f32_16x16x32_bf16 a[128:131], v[156:159], a[216:219], a[128:131]
    v_xor_b32 v15, s97, v14
    ds_read_b128 a[160:163], v15 offset:40960
    v_mfma_f32_16x16x32_bf16 a[4:7], v[160:163], a[200:203], a[4:7]
    v_perm_b32 v152, v29, v25, s42
    v_perm_b32 v153, v37, v33, s42
    v_mfma_f32_16x16x32_bf16 a[36:39], v[160:163], a[204:207], a[36:39]
    v_perm_b32 v154, v45, v41, s42
    v_perm_b32 v155, v53, v49, s42
    v_mfma_f32_16x16x32_bf16 a[68:71], v[160:163], a[208:211], a[68:71]
    v_mfma_f32_16x16x32_bf16 a[100:103], v[160:163], a[212:215], a[100:103]
    buffer_load_dwordx4 v[124:127], v5, s[8:11], s37 offen
    v_mfma_f32_16x16x32_bf16 a[132:135], v[160:163], a[216:219], a[132:135]
    ds_read_b128 a[164:167], v15 offset:45056
    v_mfma_f32_16x16x32_bf16 a[8:11], v[152:155], a[200:203], a[8:11]
    v_perm_b32 v156, v29, v25, s43
    v_perm_b32 v157, v37, v33, s43
    v_mfma_f32_16x16x32_bf16 a[40:43], v[152:155], a[204:207], a[40:43]
    v_perm_b32 v158, v45, v41, s43
    v_perm_b32 v159, v53, v49, s43
    v_mfma_f32_16x16x32_bf16 a[72:75], v[152:155], a[208:211], a[72:75]
    v_mfma_f32_16x16x32_bf16 a[104:107], v[152:155], a[212:215], a[104:107]
    buffer_load_dwordx4 v[128:131], v6, s[8:11], s37 offen
    v_mfma_f32_16x16x32_bf16 a[136:139], v[152:155], a[216:219], a[136:139]
    ds_read_b128 a[168:171], v15 offset:49152
    v_mfma_f32_16x16x32_bf16 a[12:15], v[156:159], a[200:203], a[12:15]
    v_perm_b32 v160, v30, v26, s42
    v_perm_b32 v161, v38, v34, s42
    v_mfma_f32_16x16x32_bf16 a[44:47], v[156:159], a[204:207], a[44:47]
    v_perm_b32 v162, v46, v42, s42
    v_perm_b32 v163, v54, v50, s42
    v_mfma_f32_16x16x32_bf16 a[76:79], v[156:159], a[208:211], a[76:79]
    v_mfma_f32_16x16x32_bf16 a[108:111], v[156:159], a[212:215], a[108:111]
    buffer_load_dwordx4 v[132:135], v7, s[8:11], s37 offen
    v_mfma_f32_16x16x32_bf16 a[140:143], v[156:159], a[216:219], a[140:143]
    ds_read_b128 a[172:175], v15 offset:53248
    v_mfma_f32_16x16x32_bf16 a[16:19], v[160:163], a[200:203], a[16:19]
    v_perm_b32 v152, v30, v26, s43
    v_perm_b32 v153, v38, v34, s43
    v_mfma_f32_16x16x32_bf16 a[48:51], v[160:163], a[204:207], a[48:51]
    v_perm_b32 v154, v46, v42, s43
    v_perm_b32 v155, v54, v50, s43
    v_mfma_f32_16x16x32_bf16 a[80:83], v[160:163], a[208:211], a[80:83]
    v_mfma_f32_16x16x32_bf16 a[112:115], v[160:163], a[212:215], a[112:115]
    buffer_load_dwordx4 v[136:139], v8, s[8:11], s37 offen
    v_mfma_f32_16x16x32_bf16 a[144:147], v[160:163], a[216:219], a[144:147]
    ds_read_b128 a[176:179], v15 offset:57344
    v_mfma_f32_16x16x32_bf16 a[20:23], v[152:155], a[200:203], a[20:23]
    v_perm_b32 v156, v31, v27, s42
    v_perm_b32 v157, v39, v35, s42
    v_mfma_f32_16x16x32_bf16 a[52:55], v[152:155], a[204:207], a[52:55]
    v_perm_b32 v158, v47, v43, s42
    v_perm_b32 v159, v55, v51, s42
    v_mfma_f32_16x16x32_bf16 a[84:87], v[152:155], a[208:211], a[84:87]
    v_mfma_f32_16x16x32_bf16 a[116:119], v[152:155], a[212:215], a[116:119]
    buffer_load_dwordx4 v[140:143], v9, s[8:11], s37 offen
    v_mfma_f32_16x16x32_bf16 a[148:151], v[152:155], a[216:219], a[148:151]
    v_mfma_f32_16x16x32_bf16 a[24:27], v[156:159], a[200:203], a[24:27]
    v_perm_b32 v160, v31, v27, s43
    v_perm_b32 v161, v39, v35, s43
    v_mfma_f32_16x16x32_bf16 a[56:59], v[156:159], a[204:207], a[56:59]
    v_perm_b32 v162, v47, v43, s43
    v_perm_b32 v163, v55, v51, s43
    v_mfma_f32_16x16x32_bf16 a[88:91], v[156:159], a[208:211], a[88:91]
    v_mfma_f32_16x16x32_bf16 a[120:123], v[156:159], a[212:215], a[120:123]
    buffer_load_dwordx4 v[144:147], v10, s[8:11], s37 offen
    v_mfma_f32_16x16x32_bf16 a[152:155], v[156:159], a[216:219], a[152:155]
    v_mfma_f32_16x16x32_bf16 a[28:31], v[160:163], a[200:203], a[28:31]
    s_waitcnt vmcnt(21)
    v_perm_b32 v152, v60, v56, s42
    v_perm_b32 v153, v68, v64, s42
    v_mfma_f32_16x16x32_bf16 a[60:63], v[160:163], a[204:207], a[60:63]
    v_perm_b32 v154, v76, v72, s42
    v_perm_b32 v155, v84, v80, s42
    v_mfma_f32_16x16x32_bf16 a[92:95], v[160:163], a[208:211], a[92:95]
    v_mfma_f32_16x16x32_bf16 a[124:127], v[160:163], a[212:215], a[124:127]
    buffer_load_dwordx4 v[148:151], v11, s[8:11], s37 offen
    v_mfma_f32_16x16x32_bf16 a[156:159], v[160:163], a[216:219], a[156:159]
    s_waitcnt lgkmcnt(0)
    s_barrier
    v_mfma_f32_16x16x32_bf16 a[0:3], v[152:155], a[160:163], a[0:3]
    v_perm_b32 v156, v60, v56, s43
    v_perm_b32 v157, v68, v64, s43
    v_mfma_f32_16x16x32_bf16 a[32:35], v[152:155], a[164:167], a[32:35]
    v_perm_b32 v158, v76, v72, s43
    v_perm_b32 v159, v84, v80, s43
    v_mfma_f32_16x16x32_bf16 a[64:67], v[152:155], a[168:171], a[64:67]
    s_add_u32 s37, s87, s88
    buffer_load_dwordx4 v[24:27], v4, s[8:11], s37 offen
    v_mfma_f32_16x16x32_bf16 a[96:99], v[152:155], a[172:175], a[96:99]
    buffer_load_dwordx4 v[28:31], v5, s[8:11], s37 offen
    v_mfma_f32_16x16x32_bf16 a[128:131], v[152:155], a[176:179], a[128:131]
    v_xor_b32 v15, s98, v14
    ds_read_b128 a[180:183], v15 offset:40960
    v_mfma_f32_16x16x32_bf16 a[4:7], v[156:159], a[160:163], a[4:7]
    v_perm_b32 v160, v61, v57, s42
    v_perm_b32 v161, v69, v65, s42
    v_mfma_f32_16x16x32_bf16 a[36:39], v[156:159], a[164:167], a[36:39]
    v_perm_b32 v162, v77, v73, s42
    v_perm_b32 v163, v85, v81, s42
    v_mfma_f32_16x16x32_bf16 a[68:71], v[156:159], a[168:171], a[68:71]
    buffer_load_dwordx4 v[32:35], v6, s[8:11], s37 offen
    v_mfma_f32_16x16x32_bf16 a[100:103], v[156:159], a[172:175], a[100:103]
    buffer_load_dwordx4 v[36:39], v7, s[8:11], s37 offen
    v_mfma_f32_16x16x32_bf16 a[132:135], v[156:159], a[176:179], a[132:135]
    ds_read_b128 a[184:187], v15 offset:45056
    v_mfma_f32_16x16x32_bf16 a[8:11], v[160:163], a[160:163], a[8:11]
    v_perm_b32 v152, v61, v57, s43
    v_perm_b32 v153, v69, v65, s43
    v_mfma_f32_16x16x32_bf16 a[40:43], v[160:163], a[164:167], a[40:43]
    v_perm_b32 v154, v77, v73, s43
    v_perm_b32 v155, v85, v81, s43
    v_mfma_f32_16x16x32_bf16 a[72:75], v[160:163], a[168:171], a[72:75]
    buffer_load_dwordx4 v[40:43], v8, s[8:11], s37 offen
    v_mfma_f32_16x16x32_bf16 a[104:107], v[160:163], a[172:175], a[104:107]
    buffer_load_dwordx4 v[44:47], v9, s[8:11], s37 offen
    v_mfma_f32_16x16x32_bf16 a[136:139], v[160:163], a[176:179], a[136:139]
    ds_read_b128 a[188:191], v15 offset:49152
    v_mfma_f32_16x16x32_bf16 a[12:15], v[152:155], a[160:163], a[12:15]
    v_perm_b32 v156, v62, v58, s42
    v_perm_b32 v157, v70, v66, s42
    v_mfma_f32_16x16x32_bf16 a[44:47], v[152:155], a[164:167], a[44:47]
    v_perm_b32 v158, v78, v74, s42
    v_perm_b32 v159, v86, v82, s42
    v_mfma_f32_16x16x32_bf16 a[76:79], v[152:155], a[168:171], a[76:79]
    buffer_load_dwordx4 v[48:51], v10, s[8:11], s37 offen
    v_mfma_f32_16x16x32_bf16 a[108:111], v[152:155], a[172:175], a[108:111]
    buffer_load_dwordx4 v[52:55], v11, s[8:11], s37 offen
    v_mfma_f32_16x16x32_bf16 a[140:143], v[152:155], a[176:179], a[140:143]
    ds_read_b128 a[192:195], v15 offset:53248
    v_mfma_f32_16x16x32_bf16 a[16:19], v[156:159], a[160:163], a[16:19]
    v_perm_b32 v160, v62, v58, s43
    v_perm_b32 v161, v70, v66, s43
    v_mfma_f32_16x16x32_bf16 a[48:51], v[156:159], a[164:167], a[48:51]
    v_perm_b32 v162, v78, v74, s43
    v_perm_b32 v163, v86, v82, s43
    v_mfma_f32_16x16x32_bf16 a[80:83], v[156:159], a[168:171], a[80:83]
    s_add_u32 m0, s47, 8192
    s_add_u32 s4, s36, 8192
    buffer_load_dwordx4 v17, s[20:23], s4 offen nt lds
    v_mfma_f32_16x16x32_bf16 a[112:115], v[156:159], a[172:175], a[112:115]
    s_add_u32 m0, s47, 8192
    s_add_u32 s4, s36, 8192
    buffer_load_dwordx4 v18, s[20:23], s4 offen offset:1024 nt lds
    v_mfma_f32_16x16x32_bf16 a[144:147], v[156:159], a[176:179], a[144:147]
    ds_read_b128 a[196:199], v15 offset:57344
    v_mfma_f32_16x16x32_bf16 a[20:23], v[160:163], a[160:163], a[20:23]
    v_perm_b32 v152, v63, v59, s42
    v_perm_b32 v153, v71, v67, s42
    v_mfma_f32_16x16x32_bf16 a[52:55], v[160:163], a[164:167], a[52:55]
    v_perm_b32 v154, v79, v75, s42
    v_perm_b32 v155, v87, v83, s42
    v_mfma_f32_16x16x32_bf16 a[84:87], v[160:163], a[168:171], a[84:87]
    s_add_u32 m0, s47, 8192
    s_add_u32 s4, s36, 8192
    buffer_load_dwordx4 v19, s[20:23], s4 offen offset:2048 nt lds
    v_mfma_f32_16x16x32_bf16 a[116:119], v[160:163], a[172:175], a[116:119]
    s_add_u32 m0, s47, 8192
    s_add_u32 s4, s36, 8192
    buffer_load_dwordx4 v20, s[20:23], s4 offen offset:3072 nt lds
    v_mfma_f32_16x16x32_bf16 a[148:151], v[160:163], a[176:179], a[148:151]
    v_mfma_f32_16x16x32_bf16 a[24:27], v[152:155], a[160:163], a[24:27]
    v_perm_b32 v156, v63, v59, s43
    v_perm_b32 v157, v71, v67, s43
    v_mfma_f32_16x16x32_bf16 a[56:59], v[152:155], a[164:167], a[56:59]
    v_perm_b32 v158, v79, v75, s43
    v_perm_b32 v159, v87, v83, s43
    v_mfma_f32_16x16x32_bf16 a[88:91], v[152:155], a[168:171], a[88:91]
    s_add_u32 m0, s47, 12288
    s_add_u32 s4, s36, 12288
    buffer_load_dwordx4 v17, s[20:23], s4 offen nt lds
    v_mfma_f32_16x16x32_bf16 a[120:123], v[152:155], a[172:175], a[120:123]
    s_add_u32 m0, s47, 12288
    s_add_u32 s4, s36, 12288
    buffer_load_dwordx4 v18, s[20:23], s4 offen offset:1024 nt lds
    v_mfma_f32_16x16x32_bf16 a[152:155], v[152:155], a[176:179], a[152:155]
    v_mfma_f32_16x16x32_bf16 a[28:31], v[156:159], a[160:163], a[28:31]
    s_waitcnt vmcnt(28)
    v_perm_b32 v160, v92, v88, s42
    v_perm_b32 v161, v100, v96, s42
    v_mfma_f32_16x16x32_bf16 a[60:63], v[156:159], a[164:167], a[60:63]
    v_perm_b32 v162, v108, v104, s42
    v_perm_b32 v163, v116, v112, s42
    v_mfma_f32_16x16x32_bf16 a[92:95], v[156:159], a[168:171], a[92:95]
    v_mfma_f32_16x16x32_bf16 a[124:127], v[156:159], a[172:175], a[124:127]
    v_mfma_f32_16x16x32_bf16 a[156:159], v[156:159], a[176:179], a[156:159]
    s_waitcnt lgkmcnt(0)
    v_mfma_f32_16x16x32_bf16 a[0:3], v[160:163], a[180:183], a[0:3]
    v_perm_b32 v152, v92, v88, s43
    v_perm_b32 v153, v100, v96, s43
    v_mfma_f32_16x16x32_bf16 a[32:35], v[160:163], a[184:187], a[32:35]
    v_perm_b32 v154, v108, v104, s43
    v_perm_b32 v155, v116, v112, s43
    v_mfma_f32_16x16x32_bf16 a[64:67], v[160:163], a[188:191], a[64:67]
    v_mfma_f32_16x16x32_bf16 a[96:99], v[160:163], a[192:195], a[96:99]
    s_add_u32 s37, s87, s89
    buffer_load_dwordx4 v[56:59], v4, s[8:11], s37 offen
    v_mfma_f32_16x16x32_bf16 a[128:131], v[160:163], a[196:199], a[128:131]
    v_xor_b32 v15, s99, v14
    ds_read_b128 a[200:203], v15 offset:40960
    v_mfma_f32_16x16x32_bf16 a[4:7], v[152:155], a[180:183], a[4:7]
    v_perm_b32 v156, v93, v89, s42
    v_perm_b32 v157, v101, v97, s42
    v_mfma_f32_16x16x32_bf16 a[36:39], v[152:155], a[184:187], a[36:39]
    v_perm_b32 v158, v109, v105, s42
    v_perm_b32 v159, v117, v113, s42
    v_mfma_f32_16x16x32_bf16 a[68:71], v[152:155], a[188:191], a[68:71]
    v_mfma_f32_16x16x32_bf16 a[100:103], v[152:155], a[192:195], a[100:103]
    buffer_load_dwordx4 v[60:63], v5, s[8:11], s37 offen
    v_mfma_f32_16x16x32_bf16 a[132:135], v[152:155], a[196:199], a[132:135]
    ds_read_b128 a[204:207], v15 offset:45056
    v_mfma_f32_16x16x32_bf16 a[8:11], v[156:159], a[180:183], a[8:11]
    v_perm_b32 v160, v93, v89, s43
    v_perm_b32 v161, v101, v97, s43
    v_mfma_f32_16x16x32_bf16 a[40:43], v[156:159], a[184:187], a[40:43]
    v_perm_b32 v162, v109, v105, s43
    v_perm_b32 v163, v117, v113, s43
    v_mfma_f32_16x16x32_bf16 a[72:75], v[156:159], a[188:191], a[72:75]
    v_mfma_f32_16x16x32_bf16 a[104:107], v[156:159], a[192:195], a[104:107]
    buffer_load_dwordx4 v[64:67], v6, s[8:11], s37 offen
    v_mfma_f32_16x16x32_bf16 a[136:139], v[156:159], a[196:199], a[136:139]
    ds_read_b128 a[208:211], v15 offset:49152
    v_mfma_f32_16x16x32_bf16 a[12:15], v[160:163], a[180:183], a[12:15]
    v_perm_b32 v152, v94, v90, s42
    v_perm_b32 v153, v102, v98, s42
    v_mfma_f32_16x16x32_bf16 a[44:47], v[160:163], a[184:187], a[44:47]
    v_perm_b32 v154, v110, v106, s42
    v_perm_b32 v155, v118, v114, s42
    v_mfma_f32_16x16x32_bf16 a[76:79], v[160:163], a[188:191], a[76:79]
    v_mfma_f32_16x16x32_bf16 a[108:111], v[160:163], a[192:195], a[108:111]
    buffer_load_dwordx4 v[68:71], v7, s[8:11], s37 offen
    v_mfma_f32_16x16x32_bf16 a[140:143], v[160:163], a[196:199], a[140:143]
    ds_read_b128 a[212:215], v15 offset:53248
    v_mfma_f32_16x16x32_bf16 a[16:19], v[152:155], a[180:183], a[16:19]
    v_perm_b32 v156, v94, v90, s43
    v_perm_b32 v157, v102, v98, s43
    v_mfma_f32_16x16x32_bf16 a[48:51], v[152:155], a[184:187], a[48:51]
    v_perm_b32 v158, v110, v106, s43
    v_perm_b32 v159, v118, v114, s43
    v_mfma_f32_16x16x32_bf16 a[80:83], v[152:155], a[188:191], a[80:83]
    v_mfma_f32_16x16x32_bf16 a[112:115], v[152:155], a[192:195], a[112:115]
    buffer_load_dwordx4 v[72:75], v8, s[8:11], s37 offen
    v_mfma_f32_16x16x32_bf16 a[144:147], v[152:155], a[196:199], a[144:147]
    ds_read_b128 a[216:219], v15 offset:57344
    v_mfma_f32_16x16x32_bf16 a[20:23], v[156:159], a[180:183], a[20:23]
    v_perm_b32 v160, v95, v91, s42
    v_perm_b32 v161, v103, v99, s42
    v_mfma_f32_16x16x32_bf16 a[52:55], v[156:159], a[184:187], a[52:55]
    v_perm_b32 v162, v111, v107, s42
    v_perm_b32 v163, v119, v115, s42
    v_mfma_f32_16x16x32_bf16 a[84:87], v[156:159], a[188:191], a[84:87]
    v_mfma_f32_16x16x32_bf16 a[116:119], v[156:159], a[192:195], a[116:119]
    buffer_load_dwordx4 v[76:79], v9, s[8:11], s37 offen
    v_mfma_f32_16x16x32_bf16 a[148:151], v[156:159], a[196:199], a[148:151]
    v_mfma_f32_16x16x32_bf16 a[24:27], v[160:163], a[180:183], a[24:27]
    v_perm_b32 v152, v95, v91, s43
    v_perm_b32 v153, v103, v99, s43
    v_mfma_f32_16x16x32_bf16 a[56:59], v[160:163], a[184:187], a[56:59]
    v_perm_b32 v154, v111, v107, s43
    v_perm_b32 v155, v119, v115, s43
    v_mfma_f32_16x16x32_bf16 a[88:91], v[160:163], a[188:191], a[88:91]
    v_mfma_f32_16x16x32_bf16 a[120:123], v[160:163], a[192:195], a[120:123]
    buffer_load_dwordx4 v[80:83], v10, s[8:11], s37 offen
    v_mfma_f32_16x16x32_bf16 a[152:155], v[160:163], a[196:199], a[152:155]
    v_mfma_f32_16x16x32_bf16 a[28:31], v[152:155], a[180:183], a[28:31]
    s_waitcnt vmcnt(21)
    v_perm_b32 v156, v124, v120, s42
    v_perm_b32 v157, v132, v128, s42
    v_mfma_f32_16x16x32_bf16 a[60:63], v[152:155], a[184:187], a[60:63]
    v_perm_b32 v158, v140, v136, s42
    v_perm_b32 v159, v148, v144, s42
    v_mfma_f32_16x16x32_bf16 a[92:95], v[152:155], a[188:191], a[92:95]
    v_mfma_f32_16x16x32_bf16 a[124:127], v[152:155], a[192:195], a[124:127]
    buffer_load_dwordx4 v[84:87], v11, s[8:11], s37 offen
    v_mfma_f32_16x16x32_bf16 a[156:159], v[152:155], a[196:199], a[156:159]
    s_waitcnt lgkmcnt(0)
    s_barrier
    v_mfma_f32_16x16x32_bf16 a[0:3], v[156:159], a[200:203], a[0:3]
    v_perm_b32 v160, v124, v120, s43
    v_perm_b32 v161, v132, v128, s43
    v_mfma_f32_16x16x32_bf16 a[32:35], v[156:159], a[204:207], a[32:35]
    v_perm_b32 v162, v140, v136, s43
    v_perm_b32 v163, v148, v144, s43
    v_mfma_f32_16x16x32_bf16 a[64:67], v[156:159], a[208:211], a[64:67]
    s_add_u32 s37, s87, s90
    buffer_load_dwordx4 v[88:91], v4, s[8:11], s37 offen
    v_mfma_f32_16x16x32_bf16 a[96:99], v[156:159], a[212:215], a[96:99]
    buffer_load_dwordx4 v[92:95], v5, s[8:11], s37 offen
    v_mfma_f32_16x16x32_bf16 a[128:131], v[156:159], a[216:219], a[128:131]
    v_xor_b32 v15, s96, v14
    v_add_u32 v15, s95, v15
    ds_read_b128 a[160:163], v15
    v_mfma_f32_16x16x32_bf16 a[4:7], v[160:163], a[200:203], a[4:7]
    v_perm_b32 v152, v125, v121, s42
    v_perm_b32 v153, v133, v129, s42
    v_mfma_f32_16x16x32_bf16 a[36:39], v[160:163], a[204:207], a[36:39]
    v_perm_b32 v154, v141, v137, s42
    v_perm_b32 v155, v149, v145, s42
    v_mfma_f32_16x16x32_bf16 a[68:71], v[160:163], a[208:211], a[68:71]
    buffer_load_dwordx4 v[96:99], v6, s[8:11], s37 offen
    v_mfma_f32_16x16x32_bf16 a[100:103], v[160:163], a[212:215], a[100:103]
    buffer_load_dwordx4 v[100:103], v7, s[8:11], s37 offen
    v_mfma_f32_16x16x32_bf16 a[132:135], v[160:163], a[216:219], a[132:135]
    ds_read_b128 a[164:167], v15 offset:4096
    v_mfma_f32_16x16x32_bf16 a[8:11], v[152:155], a[200:203], a[8:11]
    v_perm_b32 v156, v125, v121, s43
    v_perm_b32 v157, v133, v129, s43
    v_mfma_f32_16x16x32_bf16 a[40:43], v[152:155], a[204:207], a[40:43]
    v_perm_b32 v158, v141, v137, s43
    v_perm_b32 v159, v149, v145, s43
    v_mfma_f32_16x16x32_bf16 a[72:75], v[152:155], a[208:211], a[72:75]
    buffer_load_dwordx4 v[104:107], v8, s[8:11], s37 offen
    v_mfma_f32_16x16x32_bf16 a[104:107], v[152:155], a[212:215], a[104:107]
    buffer_load_dwordx4 v[108:111], v9, s[8:11], s37 offen
    v_mfma_f32_16x16x32_bf16 a[136:139], v[152:155], a[216:219], a[136:139]
    ds_read_b128 a[168:171], v15 offset:8192
    v_mfma_f32_16x16x32_bf16 a[12:15], v[156:159], a[200:203], a[12:15]
    v_perm_b32 v160, v126, v122, s42
    v_perm_b32 v161, v134, v130, s42
    v_mfma_f32_16x16x32_bf16 a[44:47], v[156:159], a[204:207], a[44:47]
    v_perm_b32 v162, v142, v138, s42
    v_perm_b32 v163, v150, v146, s42
    v_mfma_f32_16x16x32_bf16 a[76:79], v[156:159], a[208:211], a[76:79]
    buffer_load_dwordx4 v[112:115], v10, s[8:11], s37 offen
    v_mfma_f32_16x16x32_bf16 a[108:111], v[156:159], a[212:215], a[108:111]
    buffer_load_dwordx4 v[116:119], v11, s[8:11], s37 offen
    v_mfma_f32_16x16x32_bf16 a[140:143], v[156:159], a[216:219], a[140:143]
    ds_read_b128 a[172:175], v15 offset:12288
    v_mfma_f32_16x16x32_bf16 a[16:19], v[160:163], a[200:203], a[16:19]
    v_perm_b32 v152, v126, v122, s43
    v_perm_b32 v153, v134, v130, s43
    v_mfma_f32_16x16x32_bf16 a[48:51], v[160:163], a[204:207], a[48:51]
    v_perm_b32 v154, v142, v138, s43
    v_perm_b32 v155, v150, v146, s43
    v_mfma_f32_16x16x32_bf16 a[80:83], v[160:163], a[208:211], a[80:83]
    s_add_u32 m0, s47, 12288
    s_add_u32 s4, s36, 12288
    buffer_load_dwordx4 v19, s[20:23], s4 offen offset:2048 nt lds
    v_mfma_f32_16x16x32_bf16 a[112:115], v[160:163], a[212:215], a[112:115]
    s_add_u32 m0, s47, 12288
    s_add_u32 s4, s36, 12288
    buffer_load_dwordx4 v20, s[20:23], s4 offen offset:3072 nt lds
    v_mfma_f32_16x16x32_bf16 a[144:147], v[160:163], a[216:219], a[144:147]
    ds_read_b128 a[176:179], v15 offset:16384
    v_mfma_f32_16x16x32_bf16 a[20:23], v[152:155], a[200:203], a[20:23]
    v_perm_b32 v156, v127, v123, s42
    v_perm_b32 v157, v135, v131, s42
    v_mfma_f32_16x16x32_bf16 a[52:55], v[152:155], a[204:207], a[52:55]
    v_perm_b32 v158, v143, v139, s42
    v_perm_b32 v159, v151, v147, s42
    v_mfma_f32_16x16x32_bf16 a[84:87], v[152:155], a[208:211], a[84:87]
    s_add_u32 m0, s47, 16384
    s_add_u32 s4, s36, 16384
    buffer_load_dwordx4 v17, s[20:23], s4 offen nt lds
    v_mfma_f32_16x16x32_bf16 a[116:119], v[152:155], a[212:215], a[116:119]
    s_add_u32 m0, s47, 16384
    s_add_u32 s4, s36, 16384
    buffer_load_dwordx4 v18, s[20:23], s4 offen offset:1024 nt lds
    v_mfma_f32_16x16x32_bf16 a[148:151], v[152:155], a[216:219], a[148:151]
    v_mfma_f32_16x16x32_bf16 a[24:27], v[156:159], a[200:203], a[24:27]
    v_perm_b32 v160, v127, v123, s43
    v_perm_b32 v161, v135, v131, s43
    v_mfma_f32_16x16x32_bf16 a[56:59], v[156:159], a[204:207], a[56:59]
    v_perm_b32 v162, v143, v139, s43
    v_perm_b32 v163, v151, v147, s43
    v_mfma_f32_16x16x32_bf16 a[88:91], v[156:159], a[208:211], a[88:91]
    s_add_u32 m0, s47, 16384
    s_add_u32 s4, s36, 16384
    buffer_load_dwordx4 v19, s[20:23], s4 offen offset:2048 nt lds
    v_mfma_f32_16x16x32_bf16 a[120:123], v[156:159], a[212:215], a[120:123]
    s_add_u32 m0, s47, 16384
    s_add_u32 s4, s36, 16384
    buffer_load_dwordx4 v20, s[20:23], s4 offen offset:3072 nt lds
    v_mfma_f32_16x16x32_bf16 a[152:155], v[156:159], a[216:219], a[152:155]
    v_mfma_f32_16x16x32_bf16 a[28:31], v[160:163], a[200:203], a[28:31]
    s_waitcnt vmcnt(28)
    v_perm_b32 v152, v28, v24, s42
    v_perm_b32 v153, v36, v32, s42
    v_mfma_f32_16x16x32_bf16 a[60:63], v[160:163], a[204:207], a[60:63]
    v_perm_b32 v154, v44, v40, s42
    v_perm_b32 v155, v52, v48, s42
    v_mfma_f32_16x16x32_bf16 a[92:95], v[160:163], a[208:211], a[92:95]
    v_mfma_f32_16x16x32_bf16 a[124:127], v[160:163], a[212:215], a[124:127]
    v_mfma_f32_16x16x32_bf16 a[156:159], v[160:163], a[216:219], a[156:159]
    s_waitcnt lgkmcnt(0)
    v_mfma_f32_16x16x32_bf16 a[0:3], v[152:155], a[160:163], a[0:3]
    v_perm_b32 v156, v28, v24, s43
    v_perm_b32 v157, v36, v32, s43
    v_mfma_f32_16x16x32_bf16 a[32:35], v[152:155], a[164:167], a[32:35]
    v_perm_b32 v158, v44, v40, s43
    v_perm_b32 v159, v52, v48, s43
    v_mfma_f32_16x16x32_bf16 a[64:67], v[152:155], a[168:171], a[64:67]
    v_mfma_f32_16x16x32_bf16 a[96:99], v[152:155], a[172:175], a[96:99]
    s_add_u32 s37, s87, s91
    buffer_load_dwordx4 v[120:123], v4, s[8:11], s37 offen
    v_mfma_f32_16x16x32_bf16 a[128:131], v[152:155], a[176:179], a[128:131]
    v_xor_b32 v15, s97, v14
    v_add_u32 v15, s95, v15
    ds_read_b128 a[180:183], v15
    ds_read_b128 a[184:187], v15 offset:4096
    v_mfma_f32_16x16x32_bf16 a[4:7], v[156:159], a[160:163], a[4:7]
    v_perm_b32 v160, v29, v25, s42
    v_perm_b32 v161, v37, v33, s42
    v_mfma_f32_16x16x32_bf16 a[36:39], v[156:159], a[164:167], a[36:39]
    v_perm_b32 v162, v45, v41, s42
    v_perm_b32 v163, v53, v49, s42
    v_mfma_f32_16x16x32_bf16 a[68:71], v[156:159], a[168:171], a[68:71]
    v_mfma_f32_16x16x32_bf16 a[100:103], v[156:159], a[172:175], a[100:103]
    buffer_load_dwordx4 v[124:127], v5, s[8:11], s37 offen
    v_mfma_f32_16x16x32_bf16 a[132:135], v[156:159], a[176:179], a[132:135]
    ds_read_b128 a[188:191], v15 offset:8192
    v_mfma_f32_16x16x32_bf16 a[8:11], v[160:163], a[160:163], a[8:11]
    v_perm_b32 v152, v29, v25, s43
    v_perm_b32 v153, v37, v33, s43
    v_mfma_f32_16x16x32_bf16 a[40:43], v[160:163], a[164:167], a[40:43]
    v_perm_b32 v154, v45, v41, s43
    v_perm_b32 v155, v53, v49, s43
    v_mfma_f32_16x16x32_bf16 a[72:75], v[160:163], a[168:171], a[72:75]
    v_mfma_f32_16x16x32_bf16 a[104:107], v[160:163], a[172:175], a[104:107]
    buffer_load_dwordx4 v[128:131], v6, s[8:11], s37 offen
    v_mfma_f32_16x16x32_bf16 a[136:139], v[160:163], a[176:179], a[136:139]
    ds_read_b128 a[192:195], v15 offset:12288
    v_mfma_f32_16x16x32_bf16 a[12:15], v[152:155], a[160:163], a[12:15]
    v_perm_b32 v156, v30, v26, s42
    v_perm_b32 v157, v38, v34, s42
    v_mfma_f32_16x16x32_bf16 a[44:47], v[152:155], a[164:167], a[44:47]
    v_perm_b32 v158, v46, v42, s42
    v_perm_b32 v159, v54, v50, s42
    v_mfma_f32_16x16x32_bf16 a[76:79], v[152:155], a[168:171], a[76:79]
    v_mfma_f32_16x16x32_bf16 a[108:111], v[152:155], a[172:175], a[108:111]
    buffer_load_dwordx4 v[132:135], v7, s[8:11], s37 offen
    v_mfma_f32_16x16x32_bf16 a[140:143], v[152:155], a[176:179], a[140:143]
    ds_read_b128 a[196:199], v15 offset:16384
    v_mfma_f32_16x16x32_bf16 a[16:19], v[156:159], a[160:163], a[16:19]
    v_perm_b32 v160, v30, v26, s43
    v_perm_b32 v161, v38, v34, s43
    v_mfma_f32_16x16x32_bf16 a[48:51], v[156:159], a[164:167], a[48:51]
    v_perm_b32 v162, v46, v42, s43
    v_perm_b32 v163, v54, v50, s43
    v_mfma_f32_16x16x32_bf16 a[80:83], v[156:159], a[168:171], a[80:83]
    v_mfma_f32_16x16x32_bf16 a[112:115], v[156:159], a[172:175], a[112:115]
    buffer_load_dwordx4 v[136:139], v8, s[8:11], s37 offen
    v_mfma_f32_16x16x32_bf16 a[144:147], v[156:159], a[176:179], a[144:147]
    v_xor_b32 v15, s98, v14
    v_add_u32 v15, s95, v15
    ds_read_b128 a[200:203], v15
    ds_read_b128 a[204:207], v15 offset:4096
    v_mfma_f32_16x16x32_bf16 a[20:23], v[160:163], a[160:163], a[20:23]
    v_perm_b32 v152, v31, v27, s42
    v_perm_b32 v153, v39, v35, s42
    v_mfma_f32_16x16x32_bf16 a[52:55], v[160:163], a[164:167], a[52:55]
    v_perm_b32 v154, v47, v43, s42
    v_perm_b32 v155, v55, v51, s42
    v_mfma_f32_16x16x32_bf16 a[84:87], v[160:163], a[168:171], a[84:87]
    v_mfma_f32_16x16x32_bf16 a[116:119], v[160:163], a[172:175], a[116:119]
    buffer_load_dwordx4 v[140:143], v9, s[8:11], s37 offen
    v_mfma_f32_16x16x32_bf16 a[148:151], v[160:163], a[176:179], a[148:151]
    ds_read_b128 a[208:211], v15 offset:8192
    v_mfma_f32_16x16x32_bf16 a[24:27], v[152:155], a[160:163], a[24:27]
    v_perm_b32 v156, v31, v27, s43
    v_perm_b32 v157, v39, v35, s43
    v_mfma_f32_16x16x32_bf16 a[56:59], v[152:155], a[164:167], a[56:59]
    v_perm_b32 v158, v47, v43, s43
    v_perm_b32 v159, v55, v51, s43
    v_mfma_f32_16x16x32_bf16 a[88:91], v[152:155], a[168:171], a[88:91]
    v_mfma_f32_16x16x32_bf16 a[120:123], v[152:155], a[172:175], a[120:123]
    buffer_load_dwordx4 v[144:147], v10, s[8:11], s37 offen
    v_mfma_f32_16x16x32_bf16 a[152:155], v[152:155], a[176:179], a[152:155]
    ds_read_b128 a[212:215], v15 offset:12288
    v_mfma_f32_16x16x32_bf16 a[28:31], v[156:159], a[160:163], a[28:31]
    s_waitcnt vmcnt(21)
    v_perm_b32 v160, v60, v56, s42
    v_perm_b32 v161, v68, v64, s42
    v_mfma_f32_16x16x32_bf16 a[60:63], v[156:159], a[164:167], a[60:63]
    v_perm_b32 v162, v76, v72, s42
    v_perm_b32 v163, v84, v80, s42
    v_mfma_f32_16x16x32_bf16 a[92:95], v[156:159], a[168:171], a[92:95]
    v_mfma_f32_16x16x32_bf16 a[124:127], v[156:159], a[172:175], a[124:127]
    buffer_load_dwordx4 v[148:151], v11, s[8:11], s37 offen
    v_mfma_f32_16x16x32_bf16 a[156:159], v[156:159], a[176:179], a[156:159]
    ds_read_b128 a[216:219], v15 offset:16384
    s_waitcnt lgkmcnt(5)
    v_mfma_f32_16x16x32_bf16 a[0:3], v[160:163], a[180:183], a[0:3]
    s_waitcnt vmcnt(14)
    v_perm_b32 v152, v92, v88, s42
    v_perm_b32 v153, v100, v96, s42
    v_mfma_f32_16x16x32_bf16 a[32:35], v[160:163], a[184:187], a[32:35]
    v_perm_b32 v154, v108, v104, s42
    v_perm_b32 v155, v116, v112, s42
    v_mfma_f32_16x16x32_bf16 a[64:67], v[160:163], a[188:191], a[64:67]
    v_xor_b32 v15, s99, v14
    v_add_u32 v15, s95, v15
    ds_read_b128 a[160:163], v15
    v_mfma_f32_16x16x32_bf16 a[96:99], v[160:163], a[192:195], a[96:99]
    ds_read_b128 a[164:167], v15 offset:4096
    ds_read_b128 a[168:171], v15 offset:8192
    v_mfma_f32_16x16x32_bf16 a[128:131], v[160:163], a[196:199], a[128:131]
    ds_read_b128 a[172:175], v15 offset:12288
    ds_read_b128 a[176:179], v15 offset:16384
    s_add_u32 m0, s3, 0
    s_add_u32 s6, s36, 0
    buffer_load_dwordx4 v21, s[24:27], s6 offen nt lds
    s_waitcnt lgkmcnt(5)
    v_mfma_f32_16x16x32_bf16 a[0:3], v[152:155], a[200:203], a[0:3]
    s_waitcnt vmcnt(1)
    v_perm_b32 v156, v124, v120, s42
    v_perm_b32 v157, v132, v128, s42
    v_mfma_f32_16x16x32_bf16 a[32:35], v[152:155], a[204:207], a[32:35]
    v_perm_b32 v158, v140, v136, s42
    v_perm_b32 v159, v148, v144, s42
    v_mfma_f32_16x16x32_bf16 a[64:67], v[152:155], a[208:211], a[64:67]
    v_mfma_f32_16x16x32_bf16 a[96:99], v[152:155], a[212:215], a[96:99]
    v_mfma_f32_16x16x32_bf16 a[128:131], v[152:155], a[216:219], a[128:131]
    s_add_u32 m0, s3, 0
    s_add_u32 s6, s36, 0
    buffer_load_dwordx4 v23, s[24:27], s6 offen offset:1024 nt lds
    s_waitcnt lgkmcnt(0)
    v_mfma_f32_16x16x32_bf16 a[0:3], v[156:159], a[160:163], a[0:3]
    v_perm_b32 v160, v60, v56, s43
    v_perm_b32 v161, v68, v64, s43
    v_mfma_f32_16x16x32_bf16 a[32:35], v[156:159], a[164:167], a[32:35]
    v_perm_b32 v162, v76, v72, s43
    v_perm_b32 v163, v84, v80, s43
    v_mfma_f32_16x16x32_bf16 a[64:67], v[156:159], a[168:171], a[64:67]
    v_mfma_f32_16x16x32_bf16 a[96:99], v[156:159], a[172:175], a[96:99]
    v_mfma_f32_16x16x32_bf16 a[128:131], v[156:159], a[176:179], a[128:131]
    v_mfma_f32_16x16x32_bf16 a[4:7], v[160:163], a[180:183], a[4:7]
    v_perm_b32 v152, v92, v88, s43
    v_perm_b32 v153, v100, v96, s43
    v_mfma_f32_16x16x32_bf16 a[36:39], v[160:163], a[184:187], a[36:39]
    v_perm_b32 v154, v108, v104, s43
    v_perm_b32 v155, v116, v112, s43
    v_mfma_f32_16x16x32_bf16 a[68:71], v[160:163], a[188:191], a[68:71]
    v_mfma_f32_16x16x32_bf16 a[100:103], v[160:163], a[192:195], a[100:103]
    v_mfma_f32_16x16x32_bf16 a[132:135], v[160:163], a[196:199], a[132:135]
    s_add_u32 m0, s3, 0
    s_add_u32 s6, s36, 0
    buffer_load_dwordx4 v21, s[24:27], s6 offen offset:2048 nt lds
    v_mfma_f32_16x16x32_bf16 a[4:7], v[152:155], a[200:203], a[4:7]
    v_perm_b32 v156, v124, v120, s43
    v_perm_b32 v157, v132, v128, s43
    v_mfma_f32_16x16x32_bf16 a[36:39], v[152:155], a[204:207], a[36:39]
    v_perm_b32 v158, v140, v136, s43
    v_perm_b32 v159, v148, v144, s43
    v_mfma_f32_16x16x32_bf16 a[68:71], v[152:155], a[208:211], a[68:71]
    v_mfma_f32_16x16x32_bf16 a[100:103], v[152:155], a[212:215], a[100:103]
    v_mfma_f32_16x16x32_bf16 a[132:135], v[152:155], a[216:219], a[132:135]
    s_add_u32 m0, s3, 0
    s_add_u32 s6, s36, 0
    buffer_load_dwordx4 v23, s[24:27], s6 offen offset:3072 nt lds
    v_mfma_f32_16x16x32_bf16 a[4:7], v[156:159], a[160:163], a[4:7]
    v_perm_b32 v160, v61, v57, s42
    v_perm_b32 v161, v69, v65, s42
    v_mfma_f32_16x16x32_bf16 a[36:39], v[156:159], a[164:167], a[36:39]
    v_perm_b32 v162, v77, v73, s42
    v_perm_b32 v163, v85, v81, s42
    v_mfma_f32_16x16x32_bf16 a[68:71], v[156:159], a[168:171], a[68:71]
    v_mfma_f32_16x16x32_bf16 a[100:103], v[156:159], a[172:175], a[100:103]
    v_mfma_f32_16x16x32_bf16 a[132:135], v[156:159], a[176:179], a[132:135]
    v_mfma_f32_16x16x32_bf16 a[8:11], v[160:163], a[180:183], a[8:11]
    v_perm_b32 v152, v93, v89, s42
    v_perm_b32 v153, v101, v97, s42
    v_mfma_f32_16x16x32_bf16 a[40:43], v[160:163], a[184:187], a[40:43]
    v_perm_b32 v154, v109, v105, s42
    v_perm_b32 v155, v117, v113, s42
    v_mfma_f32_16x16x32_bf16 a[72:75], v[160:163], a[188:191], a[72:75]
    v_mfma_f32_16x16x32_bf16 a[104:107], v[160:163], a[192:195], a[104:107]
    v_accvgpr_read_b32 v164, a0
    v_accvgpr_read_b32 v165, a4
    v_accvgpr_read_b32 v166, a1
    v_accvgpr_read_b32 v167, a5
    v_mfma_f32_16x16x32_bf16 a[136:139], v[160:163], a[196:199], a[136:139]
    v_cvt_pk_bf16_f32 v176, v164, v165
    v_cvt_pk_bf16_f32 v180, v166, v167
    v_accvgpr_read_b32 v168, a2
    v_accvgpr_read_b32 v169, a6
    s_add_u32 m0, s3, 16384
    s_add_u32 s6, s36, 4096
    buffer_load_dwordx4 v21, s[24:27], s6 offen nt lds
    v_mfma_f32_16x16x32_bf16 a[8:11], v[152:155], a[200:203], a[8:11]
    v_perm_b32 v156, v125, v121, s42
    v_perm_b32 v157, v133, v129, s42
    v_mfma_f32_16x16x32_bf16 a[40:43], v[152:155], a[204:207], a[40:43]
    v_perm_b32 v158, v141, v137, s42
    v_perm_b32 v159, v149, v145, s42
    v_mfma_f32_16x16x32_bf16 a[72:75], v[152:155], a[208:211], a[72:75]
    v_accvgpr_read_b32 v170, a3
    v_accvgpr_read_b32 v171, a7
    v_cvt_pk_bf16_f32 v184, v168, v169
    v_mfma_f32_16x16x32_bf16 a[104:107], v[152:155], a[212:215], a[104:107]
    v_cvt_pk_bf16_f32 v188, v170, v171
    v_accvgpr_read_b32 v172, a32
    v_accvgpr_read_b32 v173, a36
    v_accvgpr_read_b32 v174, a33
    v_mfma_f32_16x16x32_bf16 a[136:139], v[152:155], a[216:219], a[136:139]
    v_accvgpr_read_b32 v175, a37
    v_cvt_pk_bf16_f32 v192, v172, v173
    v_cvt_pk_bf16_f32 v196, v174, v175
    s_add_u32 m0, s3, 16384
    s_add_u32 s6, s36, 4096
    buffer_load_dwordx4 v23, s[24:27], s6 offen offset:1024 nt lds
    v_mfma_f32_16x16x32_bf16 a[8:11], v[156:159], a[160:163], a[8:11]
    v_perm_b32 v160, v61, v57, s43
    v_perm_b32 v161, v69, v65, s43
    v_mfma_f32_16x16x32_bf16 a[40:43], v[156:159], a[164:167], a[40:43]
    v_perm_b32 v162, v77, v73, s43
    v_perm_b32 v163, v85, v81, s43
    v_mfma_f32_16x16x32_bf16 a[72:75], v[156:159], a[168:171], a[72:75]
    v_accvgpr_read_b32 v164, a34
    v_accvgpr_read_b32 v165, a38
    v_accvgpr_read_b32 v166, a35
    v_accvgpr_read_b32 v167, a39
    v_mfma_f32_16x16x32_bf16 a[104:107], v[156:159], a[172:175], a[104:107]
    v_cvt_pk_bf16_f32 v200, v164, v165
    v_cvt_pk_bf16_f32 v204, v166, v167
    v_accvgpr_read_b32 v168, a64
    v_mfma_f32_16x16x32_bf16 a[136:139], v[156:159], a[176:179], a[136:139]
    v_accvgpr_read_b32 v169, a68
    v_accvgpr_read_b32 v170, a65
    v_accvgpr_read_b32 v171, a69
    v_cvt_pk_bf16_f32 v208, v168, v169
    v_mfma_f32_16x16x32_bf16 a[12:15], v[160:163], a[180:183], a[12:15]
    v_perm_b32 v152, v93, v89, s43
    v_perm_b32 v153, v101, v97, s43
    v_mfma_f32_16x16x32_bf16 a[44:47], v[160:163], a[184:187], a[44:47]
    v_perm_b32 v154, v109, v105, s43
    v_perm_b32 v155, v117, v113, s43
    v_mfma_f32_16x16x32_bf16 a[76:79], v[160:163], a[188:191], a[76:79]
    v_cvt_pk_bf16_f32 v212, v170, v171
    v_accvgpr_read_b32 v172, a66
    v_accvgpr_read_b32 v173, a70
    v_mfma_f32_16x16x32_bf16 a[108:111], v[160:163], a[192:195], a[108:111]
    v_accvgpr_read_b32 v174, a67
    v_accvgpr_read_b32 v175, a71
    v_cvt_pk_bf16_f32 v216, v172, v173
    v_cvt_pk_bf16_f32 v220, v174, v175
    v_mfma_f32_16x16x32_bf16 a[140:143], v[160:163], a[196:199], a[140:143]
    v_accvgpr_read_b32 v164, a96
    v_accvgpr_read_b32 v165, a100
    v_accvgpr_read_b32 v166, a97
    s_add_u32 m0, s3, 16384
    s_add_u32 s6, s36, 4096
    buffer_load_dwordx4 v21, s[24:27], s6 offen offset:2048 nt lds
    v_mfma_f32_16x16x32_bf16 a[12:15], v[152:155], a[200:203], a[12:15]
    v_perm_b32 v156, v125, v121, s43
    v_perm_b32 v157, v133, v129, s43
    v_mfma_f32_16x16x32_bf16 a[44:47], v[152:155], a[204:207], a[44:47]
    v_perm_b32 v158, v141, v137, s43
    v_perm_b32 v159, v149, v145, s43
    v_mfma_f32_16x16x32_bf16 a[76:79], v[152:155], a[208:211], a[76:79]
    v_accvgpr_read_b32 v167, a101
    v_cvt_pk_bf16_f32 v224, v164, v165
    v_cvt_pk_bf16_f32 v228, v166, v167
    v_accvgpr_read_b32 v168, a98
    v_mfma_f32_16x16x32_bf16 a[108:111], v[152:155], a[212:215], a[108:111]
    v_accvgpr_read_b32 v169, a102
    v_accvgpr_read_b32 v170, a99
    v_accvgpr_read_b32 v171, a103
    v_mfma_f32_16x16x32_bf16 a[140:143], v[152:155], a[216:219], a[140:143]
    v_cvt_pk_bf16_f32 v232, v168, v169
    v_cvt_pk_bf16_f32 v236, v170, v171
    v_accvgpr_read_b32 v172, a128
    v_accvgpr_read_b32 v173, a132
    s_add_u32 m0, s3, 16384
    s_add_u32 s6, s36, 4096
    buffer_load_dwordx4 v23, s[24:27], s6 offen offset:3072 nt lds
    v_mfma_f32_16x16x32_bf16 a[12:15], v[156:159], a[160:163], a[12:15]
    v_perm_b32 v160, v62, v58, s42
    v_perm_b32 v161, v70, v66, s42
    v_mfma_f32_16x16x32_bf16 a[44:47], v[156:159], a[164:167], a[44:47]
    v_perm_b32 v162, v78, v74, s42
    v_perm_b32 v163, v86, v82, s42
    v_mfma_f32_16x16x32_bf16 a[76:79], v[156:159], a[168:171], a[76:79]
    v_accvgpr_read_b32 v174, a129
    v_accvgpr_read_b32 v175, a133
    v_cvt_pk_bf16_f32 v240, v172, v173
    v_mfma_f32_16x16x32_bf16 a[108:111], v[156:159], a[172:175], a[108:111]
    v_cvt_pk_bf16_f32 v244, v174, v175
    v_accvgpr_read_b32 v164, a130
    v_accvgpr_read_b32 v165, a134
    v_accvgpr_read_b32 v166, a131
    v_mfma_f32_16x16x32_bf16 a[140:143], v[156:159], a[176:179], a[140:143]
    v_accvgpr_read_b32 v167, a135
    v_cvt_pk_bf16_f32 v248, v164, v165
    v_cvt_pk_bf16_f32 v252, v166, v167
    v_mfma_f32_16x16x32_bf16 a[16:19], v[160:163], a[180:183], a[16:19]
    v_perm_b32 v152, v94, v90, s42
    v_perm_b32 v153, v102, v98, s42
    v_mfma_f32_16x16x32_bf16 a[48:51], v[160:163], a[184:187], a[48:51]
    v_perm_b32 v154, v110, v106, s42
    v_perm_b32 v155, v118, v114, s42
    v_mfma_f32_16x16x32_bf16 a[80:83], v[160:163], a[188:191], a[80:83]
    v_mfma_f32_16x16x32_bf16 a[112:115], v[160:163], a[192:195], a[112:115]
    v_accvgpr_read_b32 v164, a8
    v_accvgpr_read_b32 v165, a12
    v_accvgpr_read_b32 v166, a9
    v_accvgpr_read_b32 v167, a13
    v_mfma_f32_16x16x32_bf16 a[144:147], v[160:163], a[196:199], a[144:147]
    v_cvt_pk_bf16_f32 v177, v164, v165
    v_cvt_pk_bf16_f32 v181, v166, v167
    v_accvgpr_read_b32 v168, a10
    v_accvgpr_read_b32 v169, a14
    s_add_u32 m0, s3, 32768
    s_add_u32 s6, s36, 8192
    buffer_load_dwordx4 v21, s[24:27], s6 offen nt lds
    v_mfma_f32_16x16x32_bf16 a[16:19], v[152:155], a[200:203], a[16:19]
    v_perm_b32 v156, v126, v122, s42
    v_perm_b32 v157, v134, v130, s42
    v_mfma_f32_16x16x32_bf16 a[48:51], v[152:155], a[204:207], a[48:51]
    v_perm_b32 v158, v142, v138, s42
    v_perm_b32 v159, v150, v146, s42
    v_mfma_f32_16x16x32_bf16 a[80:83], v[152:155], a[208:211], a[80:83]
    v_accvgpr_read_b32 v170, a11
    v_accvgpr_read_b32 v171, a15
    v_cvt_pk_bf16_f32 v185, v168, v169
    v_mfma_f32_16x16x32_bf16 a[112:115], v[152:155], a[212:215], a[112:115]
    v_cvt_pk_bf16_f32 v189, v170, v171
    v_accvgpr_read_b32 v172, a40
    v_accvgpr_read_b32 v173, a44
    v_accvgpr_read_b32 v174, a41
    v_mfma_f32_16x16x32_bf16 a[144:147], v[152:155], a[216:219], a[144:147]
    v_accvgpr_read_b32 v175, a45
    v_cvt_pk_bf16_f32 v193, v172, v173
    v_cvt_pk_bf16_f32 v197, v174, v175
    s_add_u32 m0, s3, 32768
    s_add_u32 s6, s36, 8192
    buffer_load_dwordx4 v23, s[24:27], s6 offen offset:1024 nt lds
    v_mfma_f32_16x16x32_bf16 a[16:19], v[156:159], a[160:163], a[16:19]
    v_perm_b32 v160, v62, v58, s43
    v_perm_b32 v161, v70, v66, s43
    v_mfma_f32_16x16x32_bf16 a[48:51], v[156:159], a[164:167], a[48:51]
    v_perm_b32 v162, v78, v74, s43
    v_perm_b32 v163, v86, v82, s43
    v_mfma_f32_16x16x32_bf16 a[80:83], v[156:159], a[168:171], a[80:83]
    v_accvgpr_read_b32 v164, a42
    v_accvgpr_read_b32 v165, a46
    v_accvgpr_read_b32 v166, a43
    v_accvgpr_read_b32 v167, a47
    v_mfma_f32_16x16x32_bf16 a[112:115], v[156:159], a[172:175], a[112:115]
    v_cvt_pk_bf16_f32 v201, v164, v165
    v_cvt_pk_bf16_f32 v205, v166, v167
    v_accvgpr_read_b32 v168, a72
    v_mfma_f32_16x16x32_bf16 a[144:147], v[156:159], a[176:179], a[144:147]
    v_accvgpr_read_b32 v169, a76
    v_accvgpr_read_b32 v170, a73
    v_accvgpr_read_b32 v171, a77
    v_cvt_pk_bf16_f32 v209, v168, v169
    v_and_b32 v22, 3, v2
    v_xor_b32 v22, v22, v3
    v_lshlrev_b32 v22, 2, v22
    v_mfma_f32_16x16x32_bf16 a[20:23], v[160:163], a[180:183], a[20:23]
    v_perm_b32 v152, v94, v90, s43
    v_perm_b32 v153, v102, v98, s43
    v_mfma_f32_16x16x32_bf16 a[52:55], v[160:163], a[184:187], a[52:55]
    v_perm_b32 v154, v110, v106, s43
    v_perm_b32 v155, v118, v114, s43
    v_mfma_f32_16x16x32_bf16 a[84:87], v[160:163], a[188:191], a[84:87]
    v_cvt_pk_bf16_f32 v213, v170, v171
    v_accvgpr_read_b32 v172, a74
    v_accvgpr_read_b32 v173, a78
    v_mfma_f32_16x16x32_bf16 a[116:119], v[160:163], a[192:195], a[116:119]
    v_accvgpr_read_b32 v174, a75
    v_accvgpr_read_b32 v175, a79
    v_cvt_pk_bf16_f32 v217, v172, v173
    v_cvt_pk_bf16_f32 v221, v174, v175
    v_mfma_f32_16x16x32_bf16 a[148:151], v[160:163], a[196:199], a[148:151]
    v_accvgpr_read_b32 v164, a104
    v_accvgpr_read_b32 v165, a108
    v_accvgpr_read_b32 v166, a105
    v_lshrrev_b32 v16, 2, v2
    v_or_b32 v22, v22, v16
    v_lshlrev_b32 v22, 4, v22
    s_add_u32 m0, s3, 32768
    s_add_u32 s6, s36, 8192
    buffer_load_dwordx4 v21, s[24:27], s6 offen offset:2048 nt lds
    v_mfma_f32_16x16x32_bf16 a[20:23], v[152:155], a[200:203], a[20:23]
    v_perm_b32 v156, v126, v122, s43
    v_perm_b32 v157, v134, v130, s43
    v_mfma_f32_16x16x32_bf16 a[52:55], v[152:155], a[204:207], a[52:55]
    v_perm_b32 v158, v142, v138, s43
    v_perm_b32 v159, v150, v146, s43
    v_mfma_f32_16x16x32_bf16 a[84:87], v[152:155], a[208:211], a[84:87]
    v_accvgpr_read_b32 v167, a109
    v_cvt_pk_bf16_f32 v225, v164, v165
    v_cvt_pk_bf16_f32 v229, v166, v167
    v_accvgpr_read_b32 v168, a106
    v_mfma_f32_16x16x32_bf16 a[116:119], v[152:155], a[212:215], a[116:119]
    v_accvgpr_read_b32 v169, a110
    v_accvgpr_read_b32 v170, a107
    v_accvgpr_read_b32 v171, a111
    v_mfma_f32_16x16x32_bf16 a[148:151], v[152:155], a[216:219], a[148:151]
    v_cvt_pk_bf16_f32 v233, v168, v169
    v_cvt_pk_bf16_f32 v237, v170, v171
    v_accvgpr_read_b32 v172, a136
    v_accvgpr_read_b32 v173, a140
    v_lshl_add_u32 v22, v2, 8, v22
    v_add_u32 v17, s47, v22
    s_add_u32 m0, s3, 32768
    s_add_u32 s6, s36, 8192
    buffer_load_dwordx4 v23, s[24:27], s6 offen offset:3072 nt lds
    v_mfma_f32_16x16x32_bf16 a[20:23], v[156:159], a[160:163], a[20:23]
    v_perm_b32 v160, v63, v59, s42
    v_perm_b32 v161, v71, v67, s42
    v_mfma_f32_16x16x32_bf16 a[52:55], v[156:159], a[164:167], a[52:55]
    v_perm_b32 v162, v79, v75, s42
    v_perm_b32 v163, v87, v83, s42
    v_mfma_f32_16x16x32_bf16 a[84:87], v[156:159], a[168:171], a[84:87]
    v_accvgpr_read_b32 v174, a137
    v_accvgpr_read_b32 v175, a141
    v_cvt_pk_bf16_f32 v241, v172, v173
    v_mfma_f32_16x16x32_bf16 a[116:119], v[156:159], a[172:175], a[116:119]
    v_cvt_pk_bf16_f32 v245, v174, v175
    v_accvgpr_read_b32 v164, a138
    v_accvgpr_read_b32 v165, a142
    v_accvgpr_read_b32 v166, a139
    v_mfma_f32_16x16x32_bf16 a[148:151], v[156:159], a[176:179], a[148:151]
    v_accvgpr_read_b32 v167, a143
    v_cvt_pk_bf16_f32 v249, v164, v165
    v_cvt_pk_bf16_f32 v253, v166, v167
    v_xor_b32 v18, 16, v17
    v_xor_b32 v19, 32, v17
    v_xor_b32 v20, 48, v17
    v_mfma_f32_16x16x32_bf16 a[24:27], v[160:163], a[180:183], a[24:27]
    v_perm_b32 v152, v95, v91, s42
    v_perm_b32 v153, v103, v99, s42
    v_mfma_f32_16x16x32_bf16 a[56:59], v[160:163], a[184:187], a[56:59]
    v_perm_b32 v154, v111, v107, s42
    v_perm_b32 v155, v119, v115, s42
    v_mfma_f32_16x16x32_bf16 a[88:91], v[160:163], a[188:191], a[88:91]
    v_mfma_f32_16x16x32_bf16 a[120:123], v[160:163], a[192:195], a[120:123]
    v_accvgpr_read_b32 v164, a16
    v_accvgpr_read_b32 v165, a20
    v_accvgpr_read_b32 v166, a17
    v_accvgpr_read_b32 v167, a21
    v_mfma_f32_16x16x32_bf16 a[152:155], v[160:163], a[196:199], a[152:155]
    v_cvt_pk_bf16_f32 v178, v164, v165
    v_cvt_pk_bf16_f32 v182, v166, v167
    v_accvgpr_read_b32 v168, a18
    v_accvgpr_read_b32 v169, a22
    v_mfma_f32_16x16x32_bf16 a[24:27], v[152:155], a[200:203], a[24:27]
    v_perm_b32 v156, v127, v123, s42
    v_perm_b32 v157, v135, v131, s42
    v_mfma_f32_16x16x32_bf16 a[56:59], v[152:155], a[204:207], a[56:59]
    v_perm_b32 v158, v143, v139, s42
    v_perm_b32 v159, v151, v147, s42
    v_mfma_f32_16x16x32_bf16 a[88:91], v[152:155], a[208:211], a[88:91]
    v_accvgpr_read_b32 v170, a19
    v_accvgpr_read_b32 v171, a23
    v_cvt_pk_bf16_f32 v186, v168, v169
    v_mfma_f32_16x16x32_bf16 a[120:123], v[152:155], a[212:215], a[120:123]
    v_cvt_pk_bf16_f32 v190, v170, v171
    v_accvgpr_read_b32 v172, a48
    v_accvgpr_read_b32 v173, a52
    v_accvgpr_read_b32 v174, a49
    v_mfma_f32_16x16x32_bf16 a[152:155], v[152:155], a[216:219], a[152:155]
    v_accvgpr_read_b32 v175, a53
    v_cvt_pk_bf16_f32 v194, v172, v173
    v_cvt_pk_bf16_f32 v198, v174, v175
    ds_read_b128 a[220:223], v17
    ds_read_b128 a[224:227], v17 offset:4096
    v_mfma_f32_16x16x32_bf16 a[24:27], v[156:159], a[160:163], a[24:27]
    v_perm_b32 v160, v63, v59, s43
    v_perm_b32 v161, v71, v67, s43
    v_mfma_f32_16x16x32_bf16 a[56:59], v[156:159], a[164:167], a[56:59]
    v_perm_b32 v162, v79, v75, s43
    v_perm_b32 v163, v87, v83, s43
    v_mfma_f32_16x16x32_bf16 a[88:91], v[156:159], a[168:171], a[88:91]
    v_accvgpr_read_b32 v164, a50
    v_accvgpr_read_b32 v165, a54
    v_accvgpr_read_b32 v166, a51
    v_accvgpr_read_b32 v167, a55
    v_mfma_f32_16x16x32_bf16 a[120:123], v[156:159], a[172:175], a[120:123]
    v_cvt_pk_bf16_f32 v202, v164, v165
    v_cvt_pk_bf16_f32 v206, v166, v167
    v_accvgpr_read_b32 v168, a80
    v_mfma_f32_16x16x32_bf16 a[152:155], v[156:159], a[176:179], a[152:155]
    v_accvgpr_read_b32 v169, a84
    v_accvgpr_read_b32 v170, a81
    v_accvgpr_read_b32 v171, a85
    v_cvt_pk_bf16_f32 v210, v168, v169
    ds_read_b128 a[228:231], v17 offset:8192
    ds_read_b128 a[232:235], v17 offset:12288
    v_mfma_f32_16x16x32_bf16 a[28:31], v[160:163], a[180:183], a[28:31]
    v_perm_b32 v152, v95, v91, s43
    v_perm_b32 v153, v103, v99, s43
    v_mfma_f32_16x16x32_bf16 a[60:63], v[160:163], a[184:187], a[60:63]
    v_perm_b32 v154, v111, v107, s43
    v_perm_b32 v155, v119, v115, s43
    v_mfma_f32_16x16x32_bf16 a[92:95], v[160:163], a[188:191], a[92:95]
    v_cvt_pk_bf16_f32 v214, v170, v171
    v_accvgpr_read_b32 v172, a82
    v_accvgpr_read_b32 v173, a86
    v_mfma_f32_16x16x32_bf16 a[124:127], v[160:163], a[192:195], a[124:127]
    v_accvgpr_read_b32 v174, a83
    v_accvgpr_read_b32 v175, a87
    v_cvt_pk_bf16_f32 v218, v172, v173
    v_cvt_pk_bf16_f32 v222, v174, v175
    v_mfma_f32_16x16x32_bf16 a[156:159], v[160:163], a[196:199], a[156:159]
    v_accvgpr_read_b32 v164, a112
    v_accvgpr_read_b32 v165, a116
    v_accvgpr_read_b32 v166, a113
    ds_read_b128 a[236:239], v17 offset:16384
    ds_read_b128 a[240:243], v18
    v_mfma_f32_16x16x32_bf16 a[28:31], v[152:155], a[200:203], a[28:31]
    v_perm_b32 v156, v127, v123, s43
    v_perm_b32 v157, v135, v131, s43
    v_mfma_f32_16x16x32_bf16 a[60:63], v[152:155], a[204:207], a[60:63]
    v_perm_b32 v158, v143, v139, s43
    v_perm_b32 v159, v151, v147, s43
    v_mfma_f32_16x16x32_bf16 a[92:95], v[152:155], a[208:211], a[92:95]
    v_accvgpr_read_b32 v167, a117
    v_cvt_pk_bf16_f32 v226, v164, v165
    v_cvt_pk_bf16_f32 v230, v166, v167
    v_accvgpr_read_b32 v168, a114
    v_mfma_f32_16x16x32_bf16 a[124:127], v[152:155], a[212:215], a[124:127]
    v_accvgpr_read_b32 v169, a118
    v_accvgpr_read_b32 v170, a115
    v_accvgpr_read_b32 v171, a119
    v_mfma_f32_16x16x32_bf16 a[156:159], v[152:155], a[216:219], a[156:159]
    v_cvt_pk_bf16_f32 v234, v168, v169
    v_cvt_pk_bf16_f32 v238, v170, v171
    v_accvgpr_read_b32 v172, a144
    v_accvgpr_read_b32 v173, a148
    ds_read_b128 a[244:247], v18 offset:4096
    ds_read_b128 a[248:251], v18 offset:8192
    v_mfma_f32_16x16x32_bf16 a[28:31], v[156:159], a[160:163], a[28:31]
    v_mfma_f32_16x16x32_bf16 a[60:63], v[156:159], a[164:167], a[60:63]
    v_mfma_f32_16x16x32_bf16 a[92:95], v[156:159], a[168:171], a[92:95]
    v_accvgpr_read_b32 v174, a145
    v_accvgpr_read_b32 v175, a149
    v_cvt_pk_bf16_f32 v242, v172, v173
    v_mfma_f32_16x16x32_bf16 a[124:127], v[156:159], a[172:175], a[124:127]
    v_cvt_pk_bf16_f32 v246, v174, v175
    v_accvgpr_read_b32 v164, a146
    v_accvgpr_read_b32 v165, a150
    v_accvgpr_read_b32 v166, a147
    v_mfma_f32_16x16x32_bf16 a[156:159], v[156:159], a[176:179], a[156:159]
    v_accvgpr_read_b32 v167, a151
    v_cvt_pk_bf16_f32 v250, v164, v165
    v_cvt_pk_bf16_f32 v254, v166, v167
    ds_read_b128 a[252:255], v18 offset:12288
    s_branch L_g1e
L_g1b:
    v_xor_b32 v15, s96, v14
    ds_read_b128 a[160:163], v15
    ds_read_b128 a[164:167], v15 offset:4096
    ds_read_b128 a[168:171], v15 offset:8192
    ds_read_b128 a[172:175], v15 offset:12288
    ds_read_b128 a[176:179], v15 offset:16384
    v_perm_b32 v152, v28, v24, s42
    v_perm_b32 v153, v36, v32, s42
    v_perm_b32 v154, v44, v40, s42
    v_perm_b32 v155, v52, v48, s42
    s_nop 0
    s_waitcnt lgkmcnt(0)
    v_mfma_f32_16x16x32_bf16 a[0:3], v[152:155], a[160:163], 0
    v_perm_b32 v156, v28, v24, s43
    v_perm_b32 v157, v36, v32, s43
    v_mfma_f32_16x16x32_bf16 a[32:35], v[152:155], a[164:167], 0
    v_perm_b32 v158, v44, v40, s43
    v_perm_b32 v159, v52, v48, s43
    v_mfma_f32_16x16x32_bf16 a[64:67], v[152:155], a[168:171], 0
    s_add_u32 s37, s84, s90
    buffer_load_dwordx4 v[88:91], v4, s[8:11], s37 offen
    v_mfma_f32_16x16x32_bf16 a[96:99], v[152:155], a[172:175], 0
    buffer_load_dwordx4 v[92:95], v5, s[8:11], s37 offen
    v_mfma_f32_16x16x32_bf16 a[128:131], v[152:155], a[176:179], 0
    v_xor_b32 v15, s97, v14
    ds_read_b128 a[180:183], v15
    v_mfma_f32_16x16x32_bf16 a[4:7], v[156:159], a[160:163], 0
    v_perm_b32 v160, v29, v25, s42
    v_perm_b32 v161, v37, v33, s42
    v_mfma_f32_16x16x32_bf16 a[36:39], v[156:159], a[164:167], 0
    v_perm_b32 v162, v45, v41, s42
    v_perm_b32 v163, v53, v49, s42
    v_mfma_f32_16x16x32_bf16 a[68:71], v[156:159], a[168:171], 0
    buffer_load_dwordx4 v[96:99], v6, s[8:11], s37 offen
    v_mfma_f32_16x16x32_bf16 a[100:103], v[156:159], a[172:175], 0
    buffer_load_dwordx4 v[100:103], v7, s[8:11], s37 offen
    v_mfma_f32_16x16x32_bf16 a[132:135], v[156:159], a[176:179], 0
    ds_read_b128 a[184:187], v15 offset:4096
    v_mfma_f32_16x16x32_bf16 a[8:11], v[160:163], a[160:163], 0
    v_perm_b32 v152, v29, v25, s43
    v_perm_b32 v153, v37, v33, s43
    v_mfma_f32_16x16x32_bf16 a[40:43], v[160:163], a[164:167], 0
    v_perm_b32 v154, v45, v41, s43
    v_perm_b32 v155, v53, v49, s43
    v_mfma_f32_16x16x32_bf16 a[72:75], v[160:163], a[168:171], 0
    buffer_load_dwordx4 v[104:107], v8, s[8:11], s37 offen
    v_mfma_f32_16x16x32_bf16 a[104:107], v[160:163], a[172:175], 0
    buffer_load_dwordx4 v[108:111], v9, s[8:11], s37 offen
    v_mfma_f32_16x16x32_bf16 a[136:139], v[160:163], a[176:179], 0
    ds_read_b128 a[188:191], v15 offset:8192
    v_mfma_f32_16x16x32_bf16 a[12:15], v[152:155], a[160:163], 0
    v_perm_b32 v156, v30, v26, s42
    v_perm_b32 v157, v38, v34, s42
    v_mfma_f32_16x16x32_bf16 a[44:47], v[152:155], a[164:167], 0
    v_perm_b32 v158, v46, v42, s42
    v_perm_b32 v159, v54, v50, s42
    v_mfma_f32_16x16x32_bf16 a[76:79], v[152:155], a[168:171], 0
    buffer_load_dwordx4 v[112:115], v10, s[8:11], s37 offen
    v_mfma_f32_16x16x32_bf16 a[108:111], v[152:155], a[172:175], 0
    buffer_load_dwordx4 v[116:119], v11, s[8:11], s37 offen
    v_mfma_f32_16x16x32_bf16 a[140:143], v[152:155], a[176:179], 0
    ds_read_b128 a[192:195], v15 offset:12288
    v_mfma_f32_16x16x32_bf16 a[16:19], v[156:159], a[160:163], 0
    v_perm_b32 v160, v30, v26, s43
    v_perm_b32 v161, v38, v34, s43
    v_mfma_f32_16x16x32_bf16 a[48:51], v[156:159], a[164:167], 0
    v_perm_b32 v162, v46, v42, s43
    v_perm_b32 v163, v54, v50, s43
    v_mfma_f32_16x16x32_bf16 a[80:83], v[156:159], a[168:171], 0
    s_lshr_b32 s40, s85, 12
    s_add_u32 s40, s40, s100
    v_xor_b32 v22, s70, v0
    s_add_u32 m0, s101, 20480
    s_add_u32 s5, s40, 0
    buffer_load_dwordx4 v22, s[12:15], s5 offen lds
    v_mfma_f32_16x16x32_bf16 a[112:115], v[156:159], a[172:175], 0
    v_xor_b32 v22, s71, v0
    s_add_u32 m0, s101, 21504
    s_add_u32 s5, s40, 4096
    buffer_load_dwordx4 v22, s[12:15], s5 offen lds
    v_mfma_f32_16x16x32_bf16 a[144:147], v[156:159], a[176:179], 0
    ds_read_b128 a[196:199], v15 offset:16384
    v_mfma_f32_16x16x32_bf16 a[20:23], v[160:163], a[160:163], 0
    v_perm_b32 v152, v31, v27, s42
    v_perm_b32 v153, v39, v35, s42
    v_mfma_f32_16x16x32_bf16 a[52:55], v[160:163], a[164:167], 0
    v_perm_b32 v154, v47, v43, s42
    v_perm_b32 v155, v55, v51, s42
    v_mfma_f32_16x16x32_bf16 a[84:87], v[160:163], a[168:171], 0
    v_xor_b32 v22, s72, v0
    s_add_u32 m0, s101, 22528
    s_add_u32 s5, s40, 8192
    buffer_load_dwordx4 v22, s[12:15], s5 offen lds
    v_mfma_f32_16x16x32_bf16 a[116:119], v[160:163], a[172:175], 0
    v_xor_b32 v22, s73, v0
    s_add_u32 m0, s101, 23552
    s_add_u32 s5, s40, 12288
    buffer_load_dwordx4 v22, s[12:15], s5 offen lds
    v_mfma_f32_16x16x32_bf16 a[148:151], v[160:163], a[176:179], 0
    v_mfma_f32_16x16x32_bf16 a[24:27], v[152:155], a[160:163], 0
    v_perm_b32 v156, v31, v27, s43
    v_perm_b32 v157, v39, v35, s43
    v_mfma_f32_16x16x32_bf16 a[56:59], v[152:155], a[164:167], 0
    v_perm_b32 v158, v47, v43, s43
    v_perm_b32 v159, v55, v51, s43
    v_mfma_f32_16x16x32_bf16 a[88:91], v[152:155], a[168:171], 0
    v_xor_b32 v22, s74, v0
    s_add_u32 m0, s101, 24576
    s_add_u32 s5, s40, 16384
    buffer_load_dwordx4 v22, s[12:15], s5 offen lds
    v_mfma_f32_16x16x32_bf16 a[120:123], v[152:155], a[172:175], 0
    v_mfma_f32_16x16x32_bf16 a[152:155], v[152:155], a[176:179], 0
    v_mfma_f32_16x16x32_bf16 a[28:31], v[156:159], a[160:163], 0
    s_waitcnt vmcnt(14)
    v_perm_b32 v160, v60, v56, s42
    v_perm_b32 v161, v68, v64, s42
    v_mfma_f32_16x16x32_bf16 a[60:63], v[156:159], a[164:167], 0
    v_perm_b32 v162, v76, v72, s42
    v_perm_b32 v163, v84, v80, s42
    v_mfma_f32_16x16x32_bf16 a[92:95], v[156:159], a[168:171], 0
    v_mfma_f32_16x16x32_bf16 a[124:127], v[156:159], a[172:175], 0
    v_mfma_f32_16x16x32_bf16 a[156:159], v[156:159], a[176:179], 0
    s_waitcnt lgkmcnt(0)
    v_mfma_f32_16x16x32_bf16 a[0:3], v[160:163], a[180:183], a[0:3]
    v_perm_b32 v152, v60, v56, s43
    v_perm_b32 v153, v68, v64, s43
    v_mfma_f32_16x16x32_bf16 a[32:35], v[160:163], a[184:187], a[32:35]
    v_perm_b32 v154, v76, v72, s43
    v_perm_b32 v155, v84, v80, s43
    v_mfma_f32_16x16x32_bf16 a[64:67], v[160:163], a[188:191], a[64:67]
    s_add_u32 s37, s84, s91
    buffer_load_dwordx4 v[120:123], v4, s[8:11], s37 offen
    v_mfma_f32_16x16x32_bf16 a[96:99], v[160:163], a[192:195], a[96:99]
    buffer_load_dwordx4 v[124:127], v5, s[8:11], s37 offen
    v_mfma_f32_16x16x32_bf16 a[128:131], v[160:163], a[196:199], a[128:131]
    v_xor_b32 v15, s98, v14
    ds_read_b128 a[200:203], v15
    v_mfma_f32_16x16x32_bf16 a[4:7], v[152:155], a[180:183], a[4:7]
    v_perm_b32 v156, v61, v57, s42
    v_perm_b32 v157, v69, v65, s42
    v_mfma_f32_16x16x32_bf16 a[36:39], v[152:155], a[184:187], a[36:39]
    v_perm_b32 v158, v77, v73, s42
    v_perm_b32 v159, v85, v81, s42
    v_mfma_f32_16x16x32_bf16 a[68:71], v[152:155], a[188:191], a[68:71]
    buffer_load_dwordx4 v[128:131], v6, s[8:11], s37 offen
    v_mfma_f32_16x16x32_bf16 a[100:103], v[152:155], a[192:195], a[100:103]
    buffer_load_dwordx4 v[132:135], v7, s[8:11], s37 offen
    v_mfma_f32_16x16x32_bf16 a[132:135], v[152:155], a[196:199], a[132:135]
    ds_read_b128 a[204:207], v15 offset:4096
    v_mfma_f32_16x16x32_bf16 a[8:11], v[156:159], a[180:183], a[8:11]
    v_perm_b32 v160, v61, v57, s43
    v_perm_b32 v161, v69, v65, s43
    v_mfma_f32_16x16x32_bf16 a[40:43], v[156:159], a[184:187], a[40:43]
    v_perm_b32 v162, v77, v73, s43
    v_perm_b32 v163, v85, v81, s43
    v_mfma_f32_16x16x32_bf16 a[72:75], v[156:159], a[188:191], a[72:75]
    buffer_load_dwordx4 v[136:139], v8, s[8:11], s37 offen
    v_mfma_f32_16x16x32_bf16 a[104:107], v[156:159], a[192:195], a[104:107]
    buffer_load_dwordx4 v[140:143], v9, s[8:11], s37 offen
    v_mfma_f32_16x16x32_bf16 a[136:139], v[156:159], a[196:199], a[136:139]
    ds_read_b128 a[208:211], v15 offset:8192
    v_mfma_f32_16x16x32_bf16 a[12:15], v[160:163], a[180:183], a[12:15]
    v_perm_b32 v152, v62, v58, s42
    v_perm_b32 v153, v70, v66, s42
    v_mfma_f32_16x16x32_bf16 a[44:47], v[160:163], a[184:187], a[44:47]
    v_perm_b32 v154, v78, v74, s42
    v_perm_b32 v155, v86, v82, s42
    v_mfma_f32_16x16x32_bf16 a[76:79], v[160:163], a[188:191], a[76:79]
    buffer_load_dwordx4 v[144:147], v10, s[8:11], s37 offen
    v_mfma_f32_16x16x32_bf16 a[108:111], v[160:163], a[192:195], a[108:111]
    buffer_load_dwordx4 v[148:151], v11, s[8:11], s37 offen
    v_mfma_f32_16x16x32_bf16 a[140:143], v[160:163], a[196:199], a[140:143]
    ds_read_b128 a[212:215], v15 offset:12288
    v_mfma_f32_16x16x32_bf16 a[16:19], v[152:155], a[180:183], a[16:19]
    v_perm_b32 v156, v62, v58, s43
    v_perm_b32 v157, v70, v66, s43
    v_mfma_f32_16x16x32_bf16 a[48:51], v[152:155], a[184:187], a[48:51]
    v_perm_b32 v158, v78, v74, s43
    v_perm_b32 v159, v86, v82, s43
    v_mfma_f32_16x16x32_bf16 a[80:83], v[152:155], a[188:191], a[80:83]
    s_add_u32 s37, s85, s88
    buffer_load_dwordx4 v[24:27], v4, s[8:11], s37 offen
    v_mfma_f32_16x16x32_bf16 a[112:115], v[152:155], a[192:195], a[112:115]
    buffer_load_dwordx4 v[28:31], v5, s[8:11], s37 offen
    v_mfma_f32_16x16x32_bf16 a[144:147], v[152:155], a[196:199], a[144:147]
    ds_read_b128 a[216:219], v15 offset:16384
    v_mfma_f32_16x16x32_bf16 a[20:23], v[156:159], a[180:183], a[20:23]
    v_perm_b32 v160, v63, v59, s42
    v_perm_b32 v161, v71, v67, s42
    v_mfma_f32_16x16x32_bf16 a[52:55], v[156:159], a[184:187], a[52:55]
    v_perm_b32 v162, v79, v75, s42
    v_perm_b32 v163, v87, v83, s42
    v_mfma_f32_16x16x32_bf16 a[84:87], v[156:159], a[188:191], a[84:87]
    buffer_load_dwordx4 v[32:35], v6, s[8:11], s37 offen
    v_mfma_f32_16x16x32_bf16 a[116:119], v[156:159], a[192:195], a[116:119]
    buffer_load_dwordx4 v[36:39], v7, s[8:11], s37 offen
    v_mfma_f32_16x16x32_bf16 a[148:151], v[156:159], a[196:199], a[148:151]
    v_mfma_f32_16x16x32_bf16 a[24:27], v[160:163], a[180:183], a[24:27]
    v_perm_b32 v152, v63, v59, s43
    v_perm_b32 v153, v71, v67, s43
    v_mfma_f32_16x16x32_bf16 a[56:59], v[160:163], a[184:187], a[56:59]
    v_perm_b32 v154, v79, v75, s43
    v_perm_b32 v155, v87, v83, s43
    v_mfma_f32_16x16x32_bf16 a[88:91], v[160:163], a[188:191], a[88:91]
    buffer_load_dwordx4 v[40:43], v8, s[8:11], s37 offen
    v_mfma_f32_16x16x32_bf16 a[120:123], v[160:163], a[192:195], a[120:123]
    buffer_load_dwordx4 v[44:47], v9, s[8:11], s37 offen
    v_mfma_f32_16x16x32_bf16 a[152:155], v[160:163], a[196:199], a[152:155]
    v_mfma_f32_16x16x32_bf16 a[28:31], v[152:155], a[180:183], a[28:31]
    s_waitcnt vmcnt(19)
    v_perm_b32 v156, v92, v88, s42
    v_perm_b32 v157, v100, v96, s42
    v_mfma_f32_16x16x32_bf16 a[60:63], v[152:155], a[184:187], a[60:63]
    v_perm_b32 v158, v108, v104, s42
    v_perm_b32 v159, v116, v112, s42
    v_mfma_f32_16x16x32_bf16 a[92:95], v[152:155], a[188:191], a[92:95]
    buffer_load_dwordx4 v[48:51], v10, s[8:11], s37 offen
    v_mfma_f32_16x16x32_bf16 a[124:127], v[152:155], a[192:195], a[124:127]
    buffer_load_dwordx4 v[52:55], v11, s[8:11], s37 offen
    v_mfma_f32_16x16x32_bf16 a[156:159], v[152:155], a[196:199], a[156:159]
    s_waitcnt lgkmcnt(0)
    s_barrier
    v_mfma_f32_16x16x32_bf16 a[0:3], v[156:159], a[200:203], a[0:3]
    v_perm_b32 v160, v92, v88, s43
    v_perm_b32 v161, v100, v96, s43
    v_mfma_f32_16x16x32_bf16 a[32:35], v[156:159], a[204:207], a[32:35]
    v_perm_b32 v162, v108, v104, s43
    v_perm_b32 v163, v116, v112, s43
    v_mfma_f32_16x16x32_bf16 a[64:67], v[156:159], a[208:211], a[64:67]
    s_add_u32 s37, s85, s89
    buffer_load_dwordx4 v[56:59], v4, s[8:11], s37 offen
    v_mfma_f32_16x16x32_bf16 a[96:99], v[156:159], a[212:215], a[96:99]
    buffer_load_dwordx4 v[60:63], v5, s[8:11], s37 offen
    v_mfma_f32_16x16x32_bf16 a[128:131], v[156:159], a[216:219], a[128:131]
    v_xor_b32 v15, s99, v14
    ds_read_b128 a[160:163], v15
    v_mfma_f32_16x16x32_bf16 a[4:7], v[160:163], a[200:203], a[4:7]
    v_perm_b32 v152, v93, v89, s42
    v_perm_b32 v153, v101, v97, s42
    v_mfma_f32_16x16x32_bf16 a[36:39], v[160:163], a[204:207], a[36:39]
    v_perm_b32 v154, v109, v105, s42
    v_perm_b32 v155, v117, v113, s42
    v_mfma_f32_16x16x32_bf16 a[68:71], v[160:163], a[208:211], a[68:71]
    buffer_load_dwordx4 v[64:67], v6, s[8:11], s37 offen
    v_mfma_f32_16x16x32_bf16 a[100:103], v[160:163], a[212:215], a[100:103]
    buffer_load_dwordx4 v[68:71], v7, s[8:11], s37 offen
    v_mfma_f32_16x16x32_bf16 a[132:135], v[160:163], a[216:219], a[132:135]
    ds_read_b128 a[164:167], v15 offset:4096
    v_mfma_f32_16x16x32_bf16 a[8:11], v[152:155], a[200:203], a[8:11]
    v_perm_b32 v156, v93, v89, s43
    v_perm_b32 v157, v101, v97, s43
    v_mfma_f32_16x16x32_bf16 a[40:43], v[152:155], a[204:207], a[40:43]
    v_perm_b32 v158, v109, v105, s43
    v_perm_b32 v159, v117, v113, s43
    v_mfma_f32_16x16x32_bf16 a[72:75], v[152:155], a[208:211], a[72:75]
    buffer_load_dwordx4 v[72:75], v8, s[8:11], s37 offen
    v_mfma_f32_16x16x32_bf16 a[104:107], v[152:155], a[212:215], a[104:107]
    buffer_load_dwordx4 v[76:79], v9, s[8:11], s37 offen
    v_mfma_f32_16x16x32_bf16 a[136:139], v[152:155], a[216:219], a[136:139]
    ds_read_b128 a[168:171], v15 offset:8192
    v_mfma_f32_16x16x32_bf16 a[12:15], v[156:159], a[200:203], a[12:15]
    v_perm_b32 v160, v94, v90, s42
    v_perm_b32 v161, v102, v98, s42
    v_mfma_f32_16x16x32_bf16 a[44:47], v[156:159], a[204:207], a[44:47]
    v_perm_b32 v162, v110, v106, s42
    v_perm_b32 v163, v118, v114, s42
    v_mfma_f32_16x16x32_bf16 a[76:79], v[156:159], a[208:211], a[76:79]
    buffer_load_dwordx4 v[80:83], v10, s[8:11], s37 offen
    v_mfma_f32_16x16x32_bf16 a[108:111], v[156:159], a[212:215], a[108:111]
    buffer_load_dwordx4 v[84:87], v11, s[8:11], s37 offen
    v_mfma_f32_16x16x32_bf16 a[140:143], v[156:159], a[216:219], a[140:143]
    ds_read_b128 a[172:175], v15 offset:12288
    v_mfma_f32_16x16x32_bf16 a[16:19], v[160:163], a[200:203], a[16:19]
    v_perm_b32 v152, v94, v90, s43
    v_perm_b32 v153, v102, v98, s43
    v_mfma_f32_16x16x32_bf16 a[48:51], v[160:163], a[204:207], a[48:51]
    v_perm_b32 v154, v110, v106, s43
    v_perm_b32 v155, v118, v114, s43
    v_mfma_f32_16x16x32_bf16 a[80:83], v[160:163], a[208:211], a[80:83]
    s_add_u32 m0, s47, 0
    s_add_u32 s4, s36, 0
    buffer_load_dwordx4 v17, s[20:23], s4 offen nt lds
    v_mfma_f32_16x16x32_bf16 a[112:115], v[160:163], a[212:215], a[112:115]
    s_add_u32 m0, s47, 0
    s_add_u32 s4, s36, 0
    buffer_load_dwordx4 v18, s[20:23], s4 offen offset:1024 nt lds
    v_mfma_f32_16x16x32_bf16 a[144:147], v[160:163], a[216:219], a[144:147]
    ds_read_b128 a[176:179], v15 offset:16384
    v_mfma_f32_16x16x32_bf16 a[20:23], v[152:155], a[200:203], a[20:23]
    v_perm_b32 v156, v95, v91, s42
    v_perm_b32 v157, v103, v99, s42
    v_mfma_f32_16x16x32_bf16 a[52:55], v[152:155], a[204:207], a[52:55]
    v_perm_b32 v158, v111, v107, s42
    v_perm_b32 v159, v119, v115, s42
    v_mfma_f32_16x16x32_bf16 a[84:87], v[152:155], a[208:211], a[84:87]
    s_add_u32 m0, s47, 0
    s_add_u32 s4, s36, 0
    buffer_load_dwordx4 v19, s[20:23], s4 offen offset:2048 nt lds
    v_mfma_f32_16x16x32_bf16 a[116:119], v[152:155], a[212:215], a[116:119]
    s_add_u32 m0, s47, 0
    s_add_u32 s4, s36, 0
    buffer_load_dwordx4 v20, s[20:23], s4 offen offset:3072 nt lds
    v_mfma_f32_16x16x32_bf16 a[148:151], v[152:155], a[216:219], a[148:151]
    v_mfma_f32_16x16x32_bf16 a[24:27], v[156:159], a[200:203], a[24:27]
    v_perm_b32 v160, v95, v91, s43
    v_perm_b32 v161, v103, v99, s43
    v_mfma_f32_16x16x32_bf16 a[56:59], v[156:159], a[204:207], a[56:59]
    v_perm_b32 v162, v111, v107, s43
    v_perm_b32 v163, v119, v115, s43
    v_mfma_f32_16x16x32_bf16 a[88:91], v[156:159], a[208:211], a[88:91]
    s_add_u32 m0, s47, 4096
    s_add_u32 s4, s36, 4096
    buffer_load_dwordx4 v17, s[20:23], s4 offen nt lds
    v_mfma_f32_16x16x32_bf16 a[120:123], v[156:159], a[212:215], a[120:123]
    s_add_u32 m0, s47, 4096
    s_add_u32 s4, s36, 4096
    buffer_load_dwordx4 v18, s[20:23], s4 offen offset:1024 nt lds
    v_mfma_f32_16x16x32_bf16 a[152:155], v[156:159], a[216:219], a[152:155]
    v_mfma_f32_16x16x32_bf16 a[28:31], v[160:163], a[200:203], a[28:31]
    s_waitcnt vmcnt(22)
    v_perm_b32 v152, v124, v120, s42
    v_perm_b32 v153, v132, v128, s42
    v_mfma_f32_16x16x32_bf16 a[60:63], v[160:163], a[204:207], a[60:63]
    v_perm_b32 v154, v140, v136, s42
    v_perm_b32 v155, v148, v144, s42
    v_mfma_f32_16x16x32_bf16 a[92:95], v[160:163], a[208:211], a[92:95]
    v_mfma_f32_16x16x32_bf16 a[124:127], v[160:163], a[212:215], a[124:127]
    v_mfma_f32_16x16x32_bf16 a[156:159], v[160:163], a[216:219], a[156:159]
    s_waitcnt lgkmcnt(0)
    s_barrier
    v_mfma_f32_16x16x32_bf16 a[0:3], v[152:155], a[160:163], a[0:3]
    v_perm_b32 v156, v124, v120, s43
    v_perm_b32 v157, v132, v128, s43
    v_mfma_f32_16x16x32_bf16 a[32:35], v[152:155], a[164:167], a[32:35]
    v_perm_b32 v158, v140, v136, s43
    v_perm_b32 v159, v148, v144, s43
    v_mfma_f32_16x16x32_bf16 a[64:67], v[152:155], a[168:171], a[64:67]
    v_mfma_f32_16x16x32_bf16 a[96:99], v[152:155], a[172:175], a[96:99]
    s_add_u32 s37, s85, s90
    buffer_load_dwordx4 v[88:91], v4, s[8:11], s37 offen
    v_mfma_f32_16x16x32_bf16 a[128:131], v[152:155], a[176:179], a[128:131]
    v_xor_b32 v15, s96, v14
    ds_read_b128 a[180:183], v15 offset:20480
    v_mfma_f32_16x16x32_bf16 a[4:7], v[156:159], a[160:163], a[4:7]
    v_perm_b32 v160, v125, v121, s42
    v_perm_b32 v161, v133, v129, s42
    v_mfma_f32_16x16x32_bf16 a[36:39], v[156:159], a[164:167], a[36:39]
    v_perm_b32 v162, v141, v137, s42
    v_perm_b32 v163, v149, v145, s42
    v_mfma_f32_16x16x32_bf16 a[68:71], v[156:159], a[168:171], a[68:71]
    v_mfma_f32_16x16x32_bf16 a[100:103], v[156:159], a[172:175], a[100:103]
    buffer_load_dwordx4 v[92:95], v5, s[8:11], s37 offen
    v_mfma_f32_16x16x32_bf16 a[132:135], v[156:159], a[176:179], a[132:135]
    ds_read_b128 a[184:187], v15 offset:24576
    v_mfma_f32_16x16x32_bf16 a[8:11], v[160:163], a[160:163], a[8:11]
    v_perm_b32 v152, v125, v121, s43
    v_perm_b32 v153, v133, v129, s43
    v_mfma_f32_16x16x32_bf16 a[40:43], v[160:163], a[164:167], a[40:43]
    v_perm_b32 v154, v141, v137, s43
    v_perm_b32 v155, v149, v145, s43
    v_mfma_f32_16x16x32_bf16 a[72:75], v[160:163], a[168:171], a[72:75]
    v_mfma_f32_16x16x32_bf16 a[104:107], v[160:163], a[172:175], a[104:107]
    buffer_load_dwordx4 v[96:99], v6, s[8:11], s37 offen
    v_mfma_f32_16x16x32_bf16 a[136:139], v[160:163], a[176:179], a[136:139]
    ds_read_b128 a[188:191], v15 offset:28672
    v_mfma_f32_16x16x32_bf16 a[12:15], v[152:155], a[160:163], a[12:15]
    v_perm_b32 v156, v126, v122, s42
    v_perm_b32 v157, v134, v130, s42
    v_mfma_f32_16x16x32_bf16 a[44:47], v[152:155], a[164:167], a[44:47]
    v_perm_b32 v158, v142, v138, s42
    v_perm_b32 v159, v150, v146, s42
    v_mfma_f32_16x16x32_bf16 a[76:79], v[152:155], a[168:171], a[76:79]
    v_mfma_f32_16x16x32_bf16 a[108:111], v[152:155], a[172:175], a[108:111]
    buffer_load_dwordx4 v[100:103], v7, s[8:11], s37 offen
    v_mfma_f32_16x16x32_bf16 a[140:143], v[152:155], a[176:179], a[140:143]
    ds_read_b128 a[192:195], v15 offset:32768
    v_mfma_f32_16x16x32_bf16 a[16:19], v[156:159], a[160:163], a[16:19]
    v_perm_b32 v160, v126, v122, s43
    v_perm_b32 v161, v134, v130, s43
    v_mfma_f32_16x16x32_bf16 a[48:51], v[156:159], a[164:167], a[48:51]
    v_perm_b32 v162, v142, v138, s43
    v_perm_b32 v163, v150, v146, s43
    v_mfma_f32_16x16x32_bf16 a[80:83], v[156:159], a[168:171], a[80:83]
    v_mfma_f32_16x16x32_bf16 a[112:115], v[156:159], a[172:175], a[112:115]
    buffer_load_dwordx4 v[104:107], v8, s[8:11], s37 offen
    v_mfma_f32_16x16x32_bf16 a[144:147], v[156:159], a[176:179], a[144:147]
    ds_read_b128 a[196:199], v15 offset:36864
    v_mfma_f32_16x16x32_bf16 a[20:23], v[160:163], a[160:163], a[20:23]
    v_perm_b32 v152, v127, v123, s42
    v_perm_b32 v153, v135, v131, s42
    v_mfma_f32_16x16x32_bf16 a[52:55], v[160:163], a[164:167], a[52:55]
    v_perm_b32 v154, v143, v139, s42
    v_perm_b32 v155, v151, v147, s42
    v_mfma_f32_16x16x32_bf16 a[84:87], v[160:163], a[168:171], a[84:87]
    v_mfma_f32_16x16x32_bf16 a[116:119], v[160:163], a[172:175], a[116:119]
    buffer_load_dwordx4 v[108:111], v9, s[8:11], s37 offen
    v_mfma_f32_16x16x32_bf16 a[148:151], v[160:163], a[176:179], a[148:151]
    v_mfma_f32_16x16x32_bf16 a[24:27], v[152:155], a[160:163], a[24:27]
    v_perm_b32 v156, v127, v123, s43
    v_perm_b32 v157, v135, v131, s43
    v_mfma_f32_16x16x32_bf16 a[56:59], v[152:155], a[164:167], a[56:59]
    v_perm_b32 v158, v143, v139, s43
    v_perm_b32 v159, v151, v147, s43
    v_mfma_f32_16x16x32_bf16 a[88:91], v[152:155], a[168:171], a[88:91]
    v_mfma_f32_16x16x32_bf16 a[120:123], v[152:155], a[172:175], a[120:123]
    buffer_load_dwordx4 v[112:115], v10, s[8:11], s37 offen
    v_mfma_f32_16x16x32_bf16 a[152:155], v[152:155], a[176:179], a[152:155]
    v_mfma_f32_16x16x32_bf16 a[28:31], v[156:159], a[160:163], a[28:31]
    s_waitcnt vmcnt(21)
    v_perm_b32 v160, v28, v24, s42
    v_perm_b32 v161, v36, v32, s42
    v_mfma_f32_16x16x32_bf16 a[60:63], v[156:159], a[164:167], a[60:63]
    v_perm_b32 v162, v44, v40, s42
    v_perm_b32 v163, v52, v48, s42
    v_mfma_f32_16x16x32_bf16 a[92:95], v[156:159], a[168:171], a[92:95]
    v_mfma_f32_16x16x32_bf16 a[124:127], v[156:159], a[172:175], a[124:127]
    buffer_load_dwordx4 v[116:119], v11, s[8:11], s37 offen
    v_mfma_f32_16x16x32_bf16 a[156:159], v[156:159], a[176:179], a[156:159]
    s_waitcnt lgkmcnt(0)
    s_barrier
    v_mfma_f32_16x16x32_bf16 a[0:3], v[160:163], a[180:183], a[0:3]
    v_perm_b32 v152, v28, v24, s43
    v_perm_b32 v153, v36, v32, s43
    v_mfma_f32_16x16x32_bf16 a[32:35], v[160:163], a[184:187], a[32:35]
    v_perm_b32 v154, v44, v40, s43
    v_perm_b32 v155, v52, v48, s43
    v_mfma_f32_16x16x32_bf16 a[64:67], v[160:163], a[188:191], a[64:67]
    s_add_u32 s37, s85, s91
    buffer_load_dwordx4 v[120:123], v4, s[8:11], s37 offen
    v_mfma_f32_16x16x32_bf16 a[96:99], v[160:163], a[192:195], a[96:99]
    buffer_load_dwordx4 v[124:127], v5, s[8:11], s37 offen
    v_mfma_f32_16x16x32_bf16 a[128:131], v[160:163], a[196:199], a[128:131]
    v_xor_b32 v15, s97, v14
    ds_read_b128 a[200:203], v15 offset:20480
    v_mfma_f32_16x16x32_bf16 a[4:7], v[152:155], a[180:183], a[4:7]
    v_perm_b32 v156, v29, v25, s42
    v_perm_b32 v157, v37, v33, s42
    v_mfma_f32_16x16x32_bf16 a[36:39], v[152:155], a[184:187], a[36:39]
    v_perm_b32 v158, v45, v41, s42
    v_perm_b32 v159, v53, v49, s42
    v_mfma_f32_16x16x32_bf16 a[68:71], v[152:155], a[188:191], a[68:71]
    buffer_load_dwordx4 v[128:131], v6, s[8:11], s37 offen
    v_mfma_f32_16x16x32_bf16 a[100:103], v[152:155], a[192:195], a[100:103]
    buffer_load_dwordx4 v[132:135], v7, s[8:11], s37 offen
    v_mfma_f32_16x16x32_bf16 a[132:135], v[152:155], a[196:199], a[132:135]
    ds_read_b128 a[204:207], v15 offset:24576
    v_mfma_f32_16x16x32_bf16 a[8:11], v[156:159], a[180:183], a[8:11]
    v_perm_b32 v160, v29, v25, s43
    v_perm_b32 v161, v37, v33, s43
    v_mfma_f32_16x16x32_bf16 a[40:43], v[156:159], a[184:187], a[40:43]
    v_perm_b32 v162, v45, v41, s43
    v_perm_b32 v163, v53, v49, s43
    v_mfma_f32_16x16x32_bf16 a[72:75], v[156:159], a[188:191], a[72:75]
    buffer_load_dwordx4 v[136:139], v8, s[8:11], s37 offen
    v_mfma_f32_16x16x32_bf16 a[104:107], v[156:159], a[192:195], a[104:107]
    buffer_load_dwordx4 v[140:143], v9, s[8:11], s37 offen
    v_mfma_f32_16x16x32_bf16 a[136:139], v[156:159], a[196:199], a[136:139]
    ds_read_b128 a[208:211], v15 offset:28672
    v_mfma_f32_16x16x32_bf16 a[12:15], v[160:163], a[180:183], a[12:15]
    v_perm_b32 v152, v30, v26, s42
    v_perm_b32 v153, v38, v34, s42
    v_mfma_f32_16x16x32_bf16 a[44:47], v[160:163], a[184:187], a[44:47]
    v_perm_b32 v154, v46, v42, s42
    v_perm_b32 v155, v54, v50, s42
    v_mfma_f32_16x16x32_bf16 a[76:79], v[160:163], a[188:191], a[76:79]
    buffer_load_dwordx4 v[144:147], v10, s[8:11], s37 offen
    v_mfma_f32_16x16x32_bf16 a[108:111], v[160:163], a[192:195], a[108:111]
    buffer_load_dwordx4 v[148:151], v11, s[8:11], s37 offen
    v_mfma_f32_16x16x32_bf16 a[140:143], v[160:163], a[196:199], a[140:143]
    ds_read_b128 a[212:215], v15 offset:32768
    v_mfma_f32_16x16x32_bf16 a[16:19], v[152:155], a[180:183], a[16:19]
    v_perm_b32 v156, v30, v26, s43
    v_perm_b32 v157, v38, v34, s43
    v_mfma_f32_16x16x32_bf16 a[48:51], v[152:155], a[184:187], a[48:51]
    v_perm_b32 v158, v46, v42, s43
    v_perm_b32 v159, v54, v50, s43
    v_mfma_f32_16x16x32_bf16 a[80:83], v[152:155], a[188:191], a[80:83]
    s_lshr_b32 s40, s86, 12
    s_add_u32 s40, s40, s100
    v_xor_b32 v22, s70, v0
    s_add_u32 m0, s101, 40960
    s_add_u32 s5, s40, 0
    buffer_load_dwordx4 v22, s[12:15], s5 offen lds
    v_mfma_f32_16x16x32_bf16 a[112:115], v[152:155], a[192:195], a[112:115]
    v_xor_b32 v22, s71, v0
    s_add_u32 m0, s101, 41984
    s_add_u32 s5, s40, 4096
    buffer_load_dwordx4 v22, s[12:15], s5 offen lds
    v_mfma_f32_16x16x32_bf16 a[144:147], v[152:155], a[196:199], a[144:147]
    ds_read_b128 a[216:219], v15 offset:36864
    v_mfma_f32_16x16x32_bf16 a[20:23], v[156:159], a[180:183], a[20:23]
    v_perm_b32 v160, v31, v27, s42
    v_perm_b32 v161, v39, v35, s42
    v_mfma_f32_16x16x32_bf16 a[52:55], v[156:159], a[184:187], a[52:55]
    v_perm_b32 v162, v47, v43, s42
    v_perm_b32 v163, v55, v51, s42
    v_mfma_f32_16x16x32_bf16 a[84:87], v[156:159], a[188:191], a[84:87]
    v_xor_b32 v22, s72, v0
    s_add_u32 m0, s101, 43008
    s_add_u32 s5, s40, 8192
    buffer_load_dwordx4 v22, s[12:15], s5 offen lds
    v_mfma_f32_16x16x32_bf16 a[116:119], v[156:159], a[192:195], a[116:119]
    v_xor_b32 v22, s73, v0
    s_add_u32 m0, s101, 44032
    s_add_u32 s5, s40, 12288
    buffer_load_dwordx4 v22, s[12:15], s5 offen lds
    v_mfma_f32_16x16x32_bf16 a[148:151], v[156:159], a[196:199], a[148:151]
    v_mfma_f32_16x16x32_bf16 a[24:27], v[160:163], a[180:183], a[24:27]
    v_perm_b32 v152, v31, v27, s43
    v_perm_b32 v153, v39, v35, s43
    v_mfma_f32_16x16x32_bf16 a[56:59], v[160:163], a[184:187], a[56:59]
    v_perm_b32 v154, v47, v43, s43
    v_perm_b32 v155, v55, v51, s43
    v_mfma_f32_16x16x32_bf16 a[88:91], v[160:163], a[188:191], a[88:91]
    v_xor_b32 v22, s74, v0
    s_add_u32 m0, s101, 45056
    s_add_u32 s5, s40, 16384
    buffer_load_dwordx4 v22, s[12:15], s5 offen lds
    v_mfma_f32_16x16x32_bf16 a[120:123], v[160:163], a[192:195], a[120:123]
    s_add_u32 m0, s47, 4096
    s_add_u32 s4, s36, 4096
    buffer_load_dwordx4 v19, s[20:23], s4 offen offset:2048 nt lds
    v_mfma_f32_16x16x32_bf16 a[152:155], v[160:163], a[196:199], a[152:155]
    v_mfma_f32_16x16x32_bf16 a[28:31], v[152:155], a[180:183], a[28:31]
    s_waitcnt vmcnt(28)
    v_perm_b32 v156, v60, v56, s42
    v_perm_b32 v157, v68, v64, s42
    v_mfma_f32_16x16x32_bf16 a[60:63], v[152:155], a[184:187], a[60:63]
    v_perm_b32 v158, v76, v72, s42
    v_perm_b32 v159, v84, v80, s42
    v_mfma_f32_16x16x32_bf16 a[92:95], v[152:155], a[188:191], a[92:95]
    s_add_u32 m0, s47, 4096
    s_add_u32 s4, s36, 4096
    buffer_load_dwordx4 v20, s[20:23], s4 offen offset:3072 nt lds
    v_mfma_f32_16x16x32_bf16 a[124:127], v[152:155], a[192:195], a[124:127]
    v_mfma_f32_16x16x32_bf16 a[156:159], v[152:155], a[196:199], a[156:159]
    s_waitcnt lgkmcnt(0)
    v_mfma_f32_16x16x32_bf16 a[0:3], v[156:159], a[200:203], a[0:3]
    v_perm_b32 v160, v60, v56, s43
    v_perm_b32 v161, v68, v64, s43
    v_mfma_f32_16x16x32_bf16 a[32:35], v[156:159], a[204:207], a[32:35]
    v_perm_b32 v162, v76, v72, s43
    v_perm_b32 v163, v84, v80, s43
    v_mfma_f32_16x16x32_bf16 a[64:67], v[156:159], a[208:211], a[64:67]
    v_mfma_f32_16x16x32_bf16 a[96:99], v[156:159], a[212:215], a[96:99]
    s_add_u32 s37, s86, s88
    buffer_load_dwordx4 v[24:27], v4, s[8:11], s37 offen
    v_mfma_f32_16x16x32_bf16 a[128:131], v[156:159], a[216:219], a[128:131]
    v_xor_b32 v15, s98, v14
    ds_read_b128 a[160:163], v15 offset:20480
    v_mfma_f32_16x16x32_bf16 a[4:7], v[160:163], a[200:203], a[4:7]
    v_perm_b32 v152, v61, v57, s42
    v_perm_b32 v153, v69, v65, s42
    v_mfma_f32_16x16x32_bf16 a[36:39], v[160:163], a[204:207], a[36:39]
    v_perm_b32 v154, v77, v73, s42
    v_perm_b32 v155, v85, v81, s42
    v_mfma_f32_16x16x32_bf16 a[68:71], v[160:163], a[208:211], a[68:71]
    v_mfma_f32_16x16x32_bf16 a[100:103], v[160:163], a[212:215], a[100:103]
    buffer_load_dwordx4 v[28:31], v5, s[8:11], s37 offen
    v_mfma_f32_16x16x32_bf16 a[132:135], v[160:163], a[216:219], a[132:135]
    ds_read_b128 a[164:167], v15 offset:24576
    v_mfma_f32_16x16x32_bf16 a[8:11], v[152:155], a[200:203], a[8:11]
    v_perm_b32 v156, v61, v57, s43
    v_perm_b32 v157, v69, v65, s43
    v_mfma_f32_16x16x32_bf16 a[40:43], v[152:155], a[204:207], a[40:43]
    v_perm_b32 v158, v77, v73, s43
    v_perm_b32 v159, v85, v81, s43
    v_mfma_f32_16x16x32_bf16 a[72:75], v[152:155], a[208:211], a[72:75]
    v_mfma_f32_16x16x32_bf16 a[104:107], v[152:155], a[212:215], a[104:107]
    buffer_load_dwordx4 v[32:35], v6, s[8:11], s37 offen
    v_mfma_f32_16x16x32_bf16 a[136:139], v[152:155], a[216:219], a[136:139]
    ds_read_b128 a[168:171], v15 offset:28672
    v_mfma_f32_16x16x32_bf16 a[12:15], v[156:159], a[200:203], a[12:15]
    v_perm_b32 v160, v62, v58, s42
    v_perm_b32 v161, v70, v66, s42
    v_mfma_f32_16x16x32_bf16 a[44:47], v[156:159], a[204:207], a[44:47]
    v_perm_b32 v162, v78, v74, s42
    v_perm_b32 v163, v86, v82, s42
    v_mfma_f32_16x16x32_bf16 a[76:79], v[156:159], a[208:211], a[76:79]
    v_mfma_f32_16x16x32_bf16 a[108:111], v[156:159], a[212:215], a[108:111]
    buffer_load_dwordx4 v[36:39], v7, s[8:11], s37 offen
    v_mfma_f32_16x16x32_bf16 a[140:143], v[156:159], a[216:219], a[140:143]
    ds_read_b128 a[172:175], v15 offset:32768
    v_mfma_f32_16x16x32_bf16 a[16:19], v[160:163], a[200:203], a[16:19]
    v_perm_b32 v152, v62, v58, s43
    v_perm_b32 v153, v70, v66, s43
    v_mfma_f32_16x16x32_bf16 a[48:51], v[160:163], a[204:207], a[48:51]
    v_perm_b32 v154, v78, v74, s43
    v_perm_b32 v155, v86, v82, s43
    v_mfma_f32_16x16x32_bf16 a[80:83], v[160:163], a[208:211], a[80:83]
    v_mfma_f32_16x16x32_bf16 a[112:115], v[160:163], a[212:215], a[112:115]
    buffer_load_dwordx4 v[40:43], v8, s[8:11], s37 offen
    v_mfma_f32_16x16x32_bf16 a[144:147], v[160:163], a[216:219], a[144:147]
    ds_read_b128 a[176:179], v15 offset:36864
    v_mfma_f32_16x16x32_bf16 a[20:23], v[152:155], a[200:203], a[20:23]
    v_perm_b32 v156, v63, v59, s42
    v_perm_b32 v157, v71, v67, s42
    v_mfma_f32_16x16x32_bf16 a[52:55], v[152:155], a[204:207], a[52:55]
    v_perm_b32 v158, v79, v75, s42
    v_perm_b32 v159, v87, v83, s42
    v_mfma_f32_16x16x32_bf16 a[84:87], v[152:155], a[208:211], a[84:87]
    v_mfma_f32_16x16x32_bf16 a[116:119], v[152:155], a[212:215], a[116:119]
    buffer_load_dwordx4 v[44:47], v9, s[8:11], s37 offen
    v_mfma_f32_16x16x32_bf16 a[148:151], v[152:155], a[216:219], a[148:151]
    v_mfma_f32_16x16x32_bf16 a[24:27], v[156:159], a[200:203], a[24:27]
    v_perm_b32 v160, v63, v59, s43
    v_perm_b32 v161, v71, v67, s43
    v_mfma_f32_16x16x32_bf16 a[56:59], v[156:159], a[204:207], a[56:59]
    v_perm_b32 v162, v79, v75, s43
    v_perm_b32 v163, v87, v83, s43
    v_mfma_f32_16x16x32_bf16 a[88:91], v[156:159], a[208:211], a[88:91]
    v_mfma_f32_16x16x32_bf16 a[120:123], v[156:159], a[212:215], a[120:123]
    buffer_load_dwordx4 v[48:51], v10, s[8:11], s37 offen
    v_mfma_f32_16x16x32_bf16 a[152:155], v[156:159], a[216:219], a[152:155]
    v_mfma_f32_16x16x32_bf16 a[28:31], v[160:163], a[200:203], a[28:31]
    s_waitcnt vmcnt(22)
    v_perm_b32 v152, v92, v88, s42
    v_perm_b32 v153, v100, v96, s42
    v_mfma_f32_16x16x32_bf16 a[60:63], v[160:163], a[204:207], a[60:63]
    v_perm_b32 v154, v108, v104, s42
    v_perm_b32 v155, v116, v112, s42
    v_mfma_f32_16x16x32_bf16 a[92:95], v[160:163], a[208:211], a[92:95]
    v_mfma_f32_16x16x32_bf16 a[124:127], v[160:163], a[212:215], a[124:127]
    buffer_load_dwordx4 v[52:55], v11, s[8:11], s37 offen
    v_mfma_f32_16x16x32_bf16 a[156:159], v[160:163], a[216:219], a[156:159]
    s_waitcnt lgkmcnt(0)
    s_barrier
    v_mfma_f32_16x16x32_bf16 a[0:3], v[152:155], a[160:163], a[0:3]
    v_perm_b32 v156, v92, v88, s43
    v_perm_b32 v157, v100, v96, s43
    v_mfma_f32_16x16x32_bf16 a[32:35], v[152:155], a[164:167], a[32:35]
    v_perm_b32 v158, v108, v104, s43
    v_perm_b32 v159, v116, v112, s43
    v_mfma_f32_16x16x32_bf16 a[64:67], v[152:155], a[168:171], a[64:67]
    s_add_u32 s37, s86, s89
    buffer_load_dwordx4 v[56:59], v4, s[8:11], s37 offen
    v_mfma_f32_16x16x32_bf16 a[96:99], v[152:155], a[172:175], a[96:99]
    buffer_load_dwordx4 v[60:63], v5, s[8:11], s37 offen
    v_mfma_f32_16x16x32_bf16 a[128:131], v[152:155], a[176:179], a[128:131]
    v_xor_b32 v15, s99, v14
    ds_read_b128 a[180:183], v15 offset:20480
    v_mfma_f32_16x16x32_bf16 a[4:7], v[156:159], a[160:163], a[4:7]
    v_perm_b32 v160, v93, v89, s42
    v_perm_b32 v161, v101, v97, s42
    v_mfma_f32_16x16x32_bf16 a[36:39], v[156:159], a[164:167], a[36:39]
    v_perm_b32 v162, v109, v105, s42
    v_perm_b32 v163, v117, v113, s42
    v_mfma_f32_16x16x32_bf16 a[68:71], v[156:159], a[168:171], a[68:71]
    buffer_load_dwordx4 v[64:67], v6, s[8:11], s37 offen
    v_mfma_f32_16x16x32_bf16 a[100:103], v[156:159], a[172:175], a[100:103]
    buffer_load_dwordx4 v[68:71], v7, s[8:11], s37 offen
    v_mfma_f32_16x16x32_bf16 a[132:135], v[156:159], a[176:179], a[132:135]
    ds_read_b128 a[184:187], v15 offset:24576
    v_mfma_f32_16x16x32_bf16 a[8:11], v[160:163], a[160:163], a[8:11]
    v_perm_b32 v152, v93, v89, s43
    v_perm_b32 v153, v101, v97, s43
    v_mfma_f32_16x16x32_bf16 a[40:43], v[160:163], a[164:167], a[40:43]
    v_perm_b32 v154, v109, v105, s43
    v_perm_b32 v155, v117, v113, s43
    v_mfma_f32_16x16x32_bf16 a[72:75], v[160:163], a[168:171], a[72:75]
    buffer_load_dwordx4 v[72:75], v8, s[8:11], s37 offen
    v_mfma_f32_16x16x32_bf16 a[104:107], v[160:163], a[172:175], a[104:107]
    buffer_load_dwordx4 v[76:79], v9, s[8:11], s37 offen
    v_mfma_f32_16x16x32_bf16 a[136:139], v[160:163], a[176:179], a[136:139]
    ds_read_b128 a[188:191], v15 offset:28672
    v_mfma_f32_16x16x32_bf16 a[12:15], v[152:155], a[160:163], a[12:15]
    v_perm_b32 v156, v94, v90, s42
    v_perm_b32 v157, v102, v98, s42
    v_mfma_f32_16x16x32_bf16 a[44:47], v[152:155], a[164:167], a[44:47]
    v_perm_b32 v158, v110, v106, s42
    v_perm_b32 v159, v118, v114, s42
    v_mfma_f32_16x16x32_bf16 a[76:79], v[152:155], a[168:171], a[76:79]
    buffer_load_dwordx4 v[80:83], v10, s[8:11], s37 offen
    v_mfma_f32_16x16x32_bf16 a[108:111], v[152:155], a[172:175], a[108:111]
    buffer_load_dwordx4 v[84:87], v11, s[8:11], s37 offen
    v_mfma_f32_16x16x32_bf16 a[140:143], v[152:155], a[176:179], a[140:143]
    ds_read_b128 a[192:195], v15 offset:32768
    v_mfma_f32_16x16x32_bf16 a[16:19], v[156:159], a[160:163], a[16:19]
    v_perm_b32 v160, v94, v90, s43
    v_perm_b32 v161, v102, v98, s43
    v_mfma_f32_16x16x32_bf16 a[48:51], v[156:159], a[164:167], a[48:51]
    v_perm_b32 v162, v110, v106, s43
    v_perm_b32 v163, v118, v114, s43
    v_mfma_f32_16x16x32_bf16 a[80:83], v[156:159], a[168:171], a[80:83]
    s_add_u32 m0, s47, 8192
    s_add_u32 s4, s36, 8192
    buffer_load_dwordx4 v17, s[20:23], s4 offen nt lds
    v_mfma_f32_16x16x32_bf16 a[112:115], v[156:159], a[172:175], a[112:115]
    s_add_u32 m0, s47, 8192
    s_add_u32 s4, s36, 8192
    buffer_load_dwordx4 v18, s[20:23], s4 offen offset:1024 nt lds
    v_mfma_f32_16x16x32_bf16 a[144:147], v[156:159], a[176:179], a[144:147]
    ds_read_b128 a[196:199], v15 offset:36864
    v_mfma_f32_16x16x32_bf16 a[20:23], v[160:163], a[160:163], a[20:23]
    v_perm_b32 v152, v95, v91, s42
    v_perm_b32 v153, v103, v99, s42
    v_mfma_f32_16x16x32_bf16 a[52:55], v[160:163], a[164:167], a[52:55]
    v_perm_b32 v154, v111, v107, s42
    v_perm_b32 v155, v119, v115, s42
    v_mfma_f32_16x16x32_bf16 a[84:87], v[160:163], a[168:171], a[84:87]
    s_add_u32 m0, s47, 8192
    s_add_u32 s4, s36, 8192
    buffer_load_dwordx4 v19, s[20:23], s4 offen offset:2048 nt lds
    v_mfma_f32_16x16x32_bf16 a[116:119], v[160:163], a[172:175], a[116:119]
    s_add_u32 m0, s47, 8192
    s_add_u32 s4, s36, 8192
    buffer_load_dwordx4 v20, s[20:23], s4 offen offset:3072 nt lds
    v_mfma_f32_16x16x32_bf16 a[148:151], v[160:163], a[176:179], a[148:151]
    v_mfma_f32_16x16x32_bf16 a[24:27], v[152:155], a[160:163], a[24:27]
    v_perm_b32 v156, v95, v91, s43
    v_perm_b32 v157, v103, v99, s43
    v_mfma_f32_16x16x32_bf16 a[56:59], v[152:155], a[164:167], a[56:59]
    v_perm_b32 v158, v111, v107, s43
    v_perm_b32 v159, v119, v115, s43
    v_mfma_f32_16x16x32_bf16 a[88:91], v[152:155], a[168:171], a[88:91]
    s_add_u32 m0, s47, 12288
    s_add_u32 s4, s36, 12288
    buffer_load_dwordx4 v17, s[20:23], s4 offen nt lds
    v_mfma_f32_16x16x32_bf16 a[120:123], v[152:155], a[172:175], a[120:123]
    s_add_u32 m0, s47, 12288
    s_add_u32 s4, s36, 12288
    buffer_load_dwordx4 v18, s[20:23], s4 offen offset:1024 nt lds
    v_mfma_f32_16x16x32_bf16 a[152:155], v[152:155], a[176:179], a[152:155]
    v_mfma_f32_16x16x32_bf16 a[28:31], v[156:159], a[160:163], a[28:31]
    s_waitcnt vmcnt(29)
    v_perm_b32 v160, v124, v120, s42
    v_perm_b32 v161, v132, v128, s42
    v_mfma_f32_16x16x32_bf16 a[60:63], v[156:159], a[164:167], a[60:63]
    v_perm_b32 v162, v140, v136, s42
    v_perm_b32 v163, v148, v144, s42
    v_mfma_f32_16x16x32_bf16 a[92:95], v[156:159], a[168:171], a[92:95]
    v_mfma_f32_16x16x32_bf16 a[124:127], v[156:159], a[172:175], a[124:127]
    v_mfma_f32_16x16x32_bf16 a[156:159], v[156:159], a[176:179], a[156:159]
    s_waitcnt lgkmcnt(0)
    s_waitcnt vmcnt(24)
    s_barrier
    v_mfma_f32_16x16x32_bf16 a[0:3], v[160:163], a[180:183], a[0:3]
    v_perm_b32 v152, v124, v120, s43
    v_perm_b32 v153, v132, v128, s43
    v_mfma_f32_16x16x32_bf16 a[32:35], v[160:163], a[184:187], a[32:35]
    v_perm_b32 v154, v140, v136, s43
    v_perm_b32 v155, v148, v144, s43
    v_mfma_f32_16x16x32_bf16 a[64:67], v[160:163], a[188:191], a[64:67]
    v_mfma_f32_16x16x32_bf16 a[96:99], v[160:163], a[192:195], a[96:99]
    s_add_u32 s37, s86, s90
    buffer_load_dwordx4 v[88:91], v4, s[8:11], s37 offen
    v_mfma_f32_16x16x32_bf16 a[128:131], v[160:163], a[196:199], a[128:131]
    v_xor_b32 v15, s96, v14
    ds_read_b128 a[200:203], v15 offset:40960
    v_mfma_f32_16x16x32_bf16 a[4:7], v[152:155], a[180:183], a[4:7]
    v_perm_b32 v156, v125, v121, s42
    v_perm_b32 v157, v133, v129, s42
    v_mfma_f32_16x16x32_bf16 a[36:39], v[152:155], a[184:187], a[36:39]
    v_perm_b32 v158, v141, v137, s42
    v_perm_b32 v159, v149, v145, s42
    v_mfma_f32_16x16x32_bf16 a[68:71], v[152:155], a[188:191], a[68:71]
    v_mfma_f32_16x16x32_bf16 a[100:103], v[152:155], a[192:195], a[100:103]
    buffer_load_dwordx4 v[92:95], v5, s[8:11], s37 offen
    v_mfma_f32_16x16x32_bf16 a[132:135], v[152:155], a[196:199], a[132:135]
    ds_read_b128 a[204:207], v15 offset:45056
    v_mfma_f32_16x16x32_bf16 a[8:11], v[156:159], a[180:183], a[8:11]
    v_perm_b32 v160, v125, v121, s43
    v_perm_b32 v161, v133, v129, s43
    v_mfma_f32_16x16x32_bf16 a[40:43], v[156:159], a[184:187], a[40:43]
    v_perm_b32 v162, v141, v137, s43
    v_perm_b32 v163, v149, v145, s43
    v_mfma_f32_16x16x32_bf16 a[72:75], v[156:159], a[188:191], a[72:75]
    v_mfma_f32_16x16x32_bf16 a[104:107], v[156:159], a[192:195], a[104:107]
    buffer_load_dwordx4 v[96:99], v6, s[8:11], s37 offen
    v_mfma_f32_16x16x32_bf16 a[136:139], v[156:159], a[196:199], a[136:139]
    ds_read_b128 a[208:211], v15 offset:49152
    v_mfma_f32_16x16x32_bf16 a[12:15], v[160:163], a[180:183], a[12:15]
    v_perm_b32 v152, v126, v122, s42
    v_perm_b32 v153, v134, v130, s42
    v_mfma_f32_16x16x32_bf16 a[44:47], v[160:163], a[184:187], a[44:47]
    v_perm_b32 v154, v142, v138, s42
    v_perm_b32 v155, v150, v146, s42
    v_mfma_f32_16x16x32_bf16 a[76:79], v[160:163], a[188:191], a[76:79]
    v_mfma_f32_16x16x32_bf16 a[108:111], v[160:163], a[192:195], a[108:111]
    buffer_load_dwordx4 v[100:103], v7, s[8:11], s37 offen
    v_mfma_f32_16x16x32_bf16 a[140:143], v[160:163], a[196:199], a[140:143]
    ds_read_b128 a[212:215], v15 offset:53248
    v_mfma_f32_16x16x32_bf16 a[16:19], v[152:155], a[180:183], a[16:19]
    v_perm_b32 v156, v126, v122, s43
    v_perm_b32 v157, v134, v130, s43
    v_mfma_f32_16x16x32_bf16 a[48:51], v[152:155], a[184:187], a[48:51]
    v_perm_b32 v158, v142, v138, s43
    v_perm_b32 v159, v150, v146, s43
    v_mfma_f32_16x16x32_bf16 a[80:83], v[152:155], a[188:191], a[80:83]
    v_mfma_f32_16x16x32_bf16 a[112:115], v[152:155], a[192:195], a[112:115]
    buffer_load_dwordx4 v[104:107], v8, s[8:11], s37 offen
    v_mfma_f32_16x16x32_bf16 a[144:147], v[152:155], a[196:199], a[144:147]
    ds_read_b128 a[216:219], v15 offset:57344
    v_mfma_f32_16x16x32_bf16 a[20:23], v[156:159], a[180:183], a[20:23]
    v_perm_b32 v160, v127, v123, s42
    v_perm_b32 v161, v135, v131, s42
    v_mfma_f32_16x16x32_bf16 a[52:55], v[156:159], a[184:187], a[52:55]
    v_perm_b32 v162, v143, v139, s42
    v_perm_b32 v163, v151, v147, s42
    v_mfma_f32_16x16x32_bf16 a[84:87], v[156:159], a[188:191], a[84:87]
    v_mfma_f32_16x16x32_bf16 a[116:119], v[156:159], a[192:195], a[116:119]
    buffer_load_dwordx4 v[108:111], v9, s[8:11], s37 offen
    v_mfma_f32_16x16x32_bf16 a[148:151], v[156:159], a[196:199], a[148:151]
    v_mfma_f32_16x16x32_bf16 a[24:27], v[160:163], a[180:183], a[24:27]
    v_perm_b32 v152, v127, v123, s43
    v_perm_b32 v153, v135, v131, s43
    v_mfma_f32_16x16x32_bf16 a[56:59], v[160:163], a[184:187], a[56:59]
    v_perm_b32 v154, v143, v139, s43
    v_perm_b32 v155, v151, v147, s43
    v_mfma_f32_16x16x32_bf16 a[88:91], v[160:163], a[188:191], a[88:91]
    v_mfma_f32_16x16x32_bf16 a[120:123], v[160:163], a[192:195], a[120:123]
    buffer_load_dwordx4 v[112:115], v10, s[8:11], s37 offen
    v_mfma_f32_16x16x32_bf16 a[152:155], v[160:163], a[196:199], a[152:155]
    v_mfma_f32_16x16x32_bf16 a[28:31], v[152:155], a[180:183], a[28:31]
    s_waitcnt vmcnt(21)
    v_perm_b32 v156, v28, v24, s42
    v_perm_b32 v157, v36, v32, s42
    v_mfma_f32_16x16x32_bf16 a[60:63], v[152:155], a[184:187], a[60:63]
    v_perm_b32 v158, v44, v40, s42
    v_perm_b32 v159, v52, v48, s42
    v_mfma_f32_16x16x32_bf16 a[92:95], v[152:155], a[188:191], a[92:95]
    v_mfma_f32_16x16x32_bf16 a[124:127], v[152:155], a[192:195], a[124:127]
    buffer_load_dwordx4 v[116:119], v11, s[8:11], s37 offen
    v_mfma_f32_16x16x32_bf16 a[156:159], v[152:155], a[196:199], a[156:159]
    s_waitcnt lgkmcnt(0)
    s_barrier
    v_mfma_f32_16x16x32_bf16 a[0:3], v[156:159], a[200:203], a[0:3]
    v_perm_b32 v160, v28, v24, s43
    v_perm_b32 v161, v36, v32, s43
    v_mfma_f32_16x16x32_bf16 a[32:35], v[156:159], a[204:207], a[32:35]
    v_perm_b32 v162, v44, v40, s43
    v_perm_b32 v163, v52, v48, s43
    v_mfma_f32_16x16x32_bf16 a[64:67], v[156:159], a[208:211], a[64:67]
    s_add_u32 s37, s86, s91
    buffer_load_dwordx4 v[120:123], v4, s[8:11], s37 offen
    v_mfma_f32_16x16x32_bf16 a[96:99], v[156:159], a[212:215], a[96:99]
    buffer_load_dwordx4 v[124:127], v5, s[8:11], s37 offen
    v_mfma_f32_16x16x32_bf16 a[128:131], v[156:159], a[216:219], a[128:131]
    v_xor_b32 v15, s97, v14
    ds_read_b128 a[160:163], v15 offset:40960
    v_mfma_f32_16x16x32_bf16 a[4:7], v[160:163], a[200:203], a[4:7]
    v_perm_b32 v152, v29, v25, s42
    v_perm_b32 v153, v37, v33, s42
    v_mfma_f32_16x16x32_bf16 a[36:39], v[160:163], a[204:207], a[36:39]
    v_perm_b32 v154, v45, v41, s42
    v_perm_b32 v155, v53, v49, s42
    v_mfma_f32_16x16x32_bf16 a[68:71], v[160:163], a[208:211], a[68:71]
    buffer_load_dwordx4 v[128:131], v6, s[8:11], s37 offen
    v_mfma_f32_16x16x32_bf16 a[100:103], v[160:163], a[212:215], a[100:103]
    buffer_load_dwordx4 v[132:135], v7, s[8:11], s37 offen
    v_mfma_f32_16x16x32_bf16 a[132:135], v[160:163], a[216:219], a[132:135]
    ds_read_b128 a[164:167], v15 offset:45056
    v_mfma_f32_16x16x32_bf16 a[8:11], v[152:155], a[200:203], a[8:11]
    v_perm_b32 v156, v29, v25, s43
    v_perm_b32 v157, v37, v33, s43
    v_mfma_f32_16x16x32_bf16 a[40:43], v[152:155], a[204:207], a[40:43]
    v_perm_b32 v158, v45, v41, s43
    v_perm_b32 v159, v53, v49, s43
    v_mfma_f32_16x16x32_bf16 a[72:75], v[152:155], a[208:211], a[72:75]
    buffer_load_dwordx4 v[136:139], v8, s[8:11], s37 offen
    v_mfma_f32_16x16x32_bf16 a[104:107], v[152:155], a[212:215], a[104:107]
    buffer_load_dwordx4 v[140:143], v9, s[8:11], s37 offen
    v_mfma_f32_16x16x32_bf16 a[136:139], v[152:155], a[216:219], a[136:139]
    ds_read_b128 a[168:171], v15 offset:49152
    v_mfma_f32_16x16x32_bf16 a[12:15], v[156:159], a[200:203], a[12:15]
    v_perm_b32 v160, v30, v26, s42
    v_perm_b32 v161, v38, v34, s42
    v_mfma_f32_16x16x32_bf16 a[44:47], v[156:159], a[204:207], a[44:47]
    v_perm_b32 v162, v46, v42, s42
    v_perm_b32 v163, v54, v50, s42
    v_mfma_f32_16x16x32_bf16 a[76:79], v[156:159], a[208:211], a[76:79]
    buffer_load_dwordx4 v[144:147], v10, s[8:11], s37 offen
    v_mfma_f32_16x16x32_bf16 a[108:111], v[156:159], a[212:215], a[108:111]
    buffer_load_dwordx4 v[148:151], v11, s[8:11], s37 offen
    v_mfma_f32_16x16x32_bf16 a[140:143], v[156:159], a[216:219], a[140:143]
    ds_read_b128 a[172:175], v15 offset:53248
    v_mfma_f32_16x16x32_bf16 a[16:19], v[160:163], a[200:203], a[16:19]
    v_perm_b32 v152, v30, v26, s43
    v_perm_b32 v153, v38, v34, s43
    v_mfma_f32_16x16x32_bf16 a[48:51], v[160:163], a[204:207], a[48:51]
    v_perm_b32 v154, v46, v42, s43
    v_perm_b32 v155, v54, v50, s43
    v_mfma_f32_16x16x32_bf16 a[80:83], v[160:163], a[208:211], a[80:83]
    s_lshr_b32 s40, s87, 12
    s_add_u32 s40, s40, s100
    v_xor_b32 v22, s70, v0
    s_add_u32 m0, s101, 61440
    s_add_u32 s5, s40, 0
    buffer_load_dwordx4 v22, s[12:15], s5 offen lds
    v_mfma_f32_16x16x32_bf16 a[112:115], v[160:163], a[212:215], a[112:115]
    v_xor_b32 v22, s71, v0
    s_add_u32 m0, s101, 62464
    s_add_u32 s5, s40, 4096
    buffer_load_dwordx4 v22, s[12:15], s5 offen lds
    v_mfma_f32_16x16x32_bf16 a[144:147], v[160:163], a[216:219], a[144:147]
    ds_read_b128 a[176:179], v15 offset:57344
    v_mfma_f32_16x16x32_bf16 a[20:23], v[152:155], a[200:203], a[20:23]
    v_perm_b32 v156, v31, v27, s42
    v_perm_b32 v157, v39, v35, s42
    v_mfma_f32_16x16x32_bf16 a[52:55], v[152:155], a[204:207], a[52:55]
    v_perm_b32 v158, v47, v43, s42
    v_perm_b32 v159, v55, v51, s42
    v_mfma_f32_16x16x32_bf16 a[84:87], v[152:155], a[208:211], a[84:87]
    v_xor_b32 v22, s72, v0
    s_add_u32 m0, s101, 63488
    s_add_u32 s5, s40, 8192
    buffer_load_dwordx4 v22, s[12:15], s5 offen lds
    v_mfma_f32_16x16x32_bf16 a[116:119], v[152:155], a[212:215], a[116:119]
    v_xor_b32 v22, s73, v0
    s_add_u32 m0, s101, 64512
    s_add_u32 s5, s40, 12288
    buffer_load_dwordx4 v22, s[12:15], s5 offen lds
    v_mfma_f32_16x16x32_bf16 a[148:151], v[152:155], a[216:219], a[148:151]
    v_mfma_f32_16x16x32_bf16 a[24:27], v[156:159], a[200:203], a[24:27]
    v_perm_b32 v160, v31, v27, s43
    v_perm_b32 v161, v39, v35, s43
    v_mfma_f32_16x16x32_bf16 a[56:59], v[156:159], a[204:207], a[56:59]
    v_perm_b32 v162, v47, v43, s43
    v_perm_b32 v163, v55, v51, s43
    v_mfma_f32_16x16x32_bf16 a[88:91], v[156:159], a[208:211], a[88:91]
    v_xor_b32 v22, s74, v0
    s_add_u32 m0, s101, 65536
    s_add_u32 s5, s40, 16384
    buffer_load_dwordx4 v22, s[12:15], s5 offen lds
    v_mfma_f32_16x16x32_bf16 a[120:123], v[156:159], a[212:215], a[120:123]
    s_add_u32 m0, s47, 12288
    s_add_u32 s4, s36, 12288
    buffer_load_dwordx4 v19, s[20:23], s4 offen offset:2048 nt lds
    v_mfma_f32_16x16x32_bf16 a[152:155], v[156:159], a[216:219], a[152:155]
    v_mfma_f32_16x16x32_bf16 a[28:31], v[160:163], a[200:203], a[28:31]
    s_waitcnt vmcnt(28)
    v_perm_b32 v152, v60, v56, s42
    v_perm_b32 v153, v68, v64, s42
    v_mfma_f32_16x16x32_bf16 a[60:63], v[160:163], a[204:207], a[60:63]
    v_perm_b32 v154, v76, v72, s42
    v_perm_b32 v155, v84, v80, s42
    v_mfma_f32_16x16x32_bf16 a[92:95], v[160:163], a[208:211], a[92:95]
    v_mfma_f32_16x16x32_bf16 a[124:127], v[160:163], a[212:215], a[124:127]
    v_mfma_f32_16x16x32_bf16 a[156:159], v[160:163], a[216:219], a[156:159]
    s_waitcnt lgkmcnt(0)
    v_mfma_f32_16x16x32_bf16 a[0:3], v[152:155], a[160:163], a[0:3]
    v_perm_b32 v156, v60, v56, s43
    v_perm_b32 v157, v68, v64, s43
    v_mfma_f32_16x16x32_bf16 a[32:35], v[152:155], a[164:167], a[32:35]
    v_perm_b32 v158, v76, v72, s43
    v_perm_b32 v159, v84, v80, s43
    v_mfma_f32_16x16x32_bf16 a[64:67], v[152:155], a[168:171], a[64:67]
    v_mfma_f32_16x16x32_bf16 a[96:99], v[152:155], a[172:175], a[96:99]
    s_add_u32 s37, s87, s88
    buffer_load_dwordx4 v[24:27], v4, s[8:11], s37 offen
    v_mfma_f32_16x16x32_bf16 a[128:131], v[152:155], a[176:179], a[128:131]
    v_xor_b32 v15, s98, v14
    ds_read_b128 a[180:183], v15 offset:40960
    v_mfma_f32_16x16x32_bf16 a[4:7], v[156:159], a[160:163], a[4:7]
    v_perm_b32 v160, v61, v57, s42
    v_perm_b32 v161, v69, v65, s42
    v_mfma_f32_16x16x32_bf16 a[36:39], v[156:159], a[164:167], a[36:39]
    v_perm_b32 v162, v77, v73, s42
    v_perm_b32 v163, v85, v81, s42
    v_mfma_f32_16x16x32_bf16 a[68:71], v[156:159], a[168:171], a[68:71]
    v_mfma_f32_16x16x32_bf16 a[100:103], v[156:159], a[172:175], a[100:103]
    buffer_load_dwordx4 v[28:31], v5, s[8:11], s37 offen
    v_mfma_f32_16x16x32_bf16 a[132:135], v[156:159], a[176:179], a[132:135]
    ds_read_b128 a[184:187], v15 offset:45056
    v_mfma_f32_16x16x32_bf16 a[8:11], v[160:163], a[160:163], a[8:11]
    v_perm_b32 v152, v61, v57, s43
    v_perm_b32 v153, v69, v65, s43
    v_mfma_f32_16x16x32_bf16 a[40:43], v[160:163], a[164:167], a[40:43]
    v_perm_b32 v154, v77, v73, s43
    v_perm_b32 v155, v85, v81, s43
    v_mfma_f32_16x16x32_bf16 a[72:75], v[160:163], a[168:171], a[72:75]
    v_mfma_f32_16x16x32_bf16 a[104:107], v[160:163], a[172:175], a[104:107]
    buffer_load_dwordx4 v[32:35], v6, s[8:11], s37 offen
    v_mfma_f32_16x16x32_bf16 a[136:139], v[160:163], a[176:179], a[136:139]
    ds_read_b128 a[188:191], v15 offset:49152
    v_mfma_f32_16x16x32_bf16 a[12:15], v[152:155], a[160:163], a[12:15]
    v_perm_b32 v156, v62, v58, s42
    v_perm_b32 v157, v70, v66, s42
    v_mfma_f32_16x16x32_bf16 a[44:47], v[152:155], a[164:167], a[44:47]
    v_perm_b32 v158, v78, v74, s42
    v_perm_b32 v159, v86, v82, s42
    v_mfma_f32_16x16x32_bf16 a[76:79], v[152:155], a[168:171], a[76:79]
    v_mfma_f32_16x16x32_bf16 a[108:111], v[152:155], a[172:175], a[108:111]
    buffer_load_dwordx4 v[36:39], v7, s[8:11], s37 offen
    v_mfma_f32_16x16x32_bf16 a[140:143], v[152:155], a[176:179], a[140:143]
    ds_read_b128 a[192:195], v15 offset:53248
    v_mfma_f32_16x16x32_bf16 a[16:19], v[156:159], a[160:163], a[16:19]
    v_perm_b32 v160, v62, v58, s43
    v_perm_b32 v161, v70, v66, s43
    v_mfma_f32_16x16x32_bf16 a[48:51], v[156:159], a[164:167], a[48:51]
    v_perm_b32 v162, v78, v74, s43
    v_perm_b32 v163, v86, v82, s43
    v_mfma_f32_16x16x32_bf16 a[80:83], v[156:159], a[168:171], a[80:83]
    v_mfma_f32_16x16x32_bf16 a[112:115], v[156:159], a[172:175], a[112:115]
    buffer_load_dwordx4 v[40:43], v8, s[8:11], s37 offen
    v_mfma_f32_16x16x32_bf16 a[144:147], v[156:159], a[176:179], a[144:147]
    ds_read_b128 a[196:199], v15 offset:57344
    v_mfma_f32_16x16x32_bf16 a[20:23], v[160:163], a[160:163], a[20:23]
    v_perm_b32 v152, v63, v59, s42
    v_perm_b32 v153, v71, v67, s42
    v_mfma_f32_16x16x32_bf16 a[52:55], v[160:163], a[164:167], a[52:55]
    v_perm_b32 v154, v79, v75, s42
    v_perm_b32 v155, v87, v83, s42
    v_mfma_f32_16x16x32_bf16 a[84:87], v[160:163], a[168:171], a[84:87]
    v_mfma_f32_16x16x32_bf16 a[116:119], v[160:163], a[172:175], a[116:119]
    buffer_load_dwordx4 v[44:47], v9, s[8:11], s37 offen
    v_mfma_f32_16x16x32_bf16 a[148:151], v[160:163], a[176:179], a[148:151]
    v_mfma_f32_16x16x32_bf16 a[24:27], v[152:155], a[160:163], a[24:27]
    v_perm_b32 v156, v63, v59, s43
    v_perm_b32 v157, v71, v67, s43
    v_mfma_f32_16x16x32_bf16 a[56:59], v[152:155], a[164:167], a[56:59]
    v_perm_b32 v158, v79, v75, s43
    v_perm_b32 v159, v87, v83, s43
    v_mfma_f32_16x16x32_bf16 a[88:91], v[152:155], a[168:171], a[88:91]
    v_mfma_f32_16x16x32_bf16 a[120:123], v[152:155], a[172:175], a[120:123]
    buffer_load_dwordx4 v[48:51], v10, s[8:11], s37 offen
    v_mfma_f32_16x16x32_bf16 a[152:155], v[152:155], a[176:179], a[152:155]
    v_mfma_f32_16x16x32_bf16 a[28:31], v[156:159], a[160:163], a[28:31]
    s_waitcnt vmcnt(21)
    v_perm_b32 v160, v92, v88, s42
    v_perm_b32 v161, v100, v96, s42
    v_mfma_f32_16x16x32_bf16 a[60:63], v[156:159], a[164:167], a[60:63]
    v_perm_b32 v162, v108, v104, s42
    v_perm_b32 v163, v116, v112, s42
    v_mfma_f32_16x16x32_bf16 a[92:95], v[156:159], a[168:171], a[92:95]
    v_mfma_f32_16x16x32_bf16 a[124:127], v[156:159], a[172:175], a[124:127]
    buffer_load_dwordx4 v[52:55], v11, s[8:11], s37 offen
    v_mfma_f32_16x16x32_bf16 a[156:159], v[156:159], a[176:179], a[156:159]
    s_waitcnt lgkmcnt(0)
    s_barrier
    v_mfma_f32_16x16x32_bf16 a[0:3], v[160:163], a[180:183], a[0:3]
    v_perm_b32 v152, v92, v88, s43
    v_perm_b32 v153, v100, v96, s43
    v_mfma_f32_16x16x32_bf16 a[32:35], v[160:163], a[184:187], a[32:35]
    v_perm_b32 v154, v108, v104, s43
    v_perm_b32 v155, v116, v112, s43
    v_mfma_f32_16x16x32_bf16 a[64:67], v[160:163], a[188:191], a[64:67]
    s_add_u32 s37, s87, s89
    buffer_load_dwordx4 v[56:59], v4, s[8:11], s37 offen
    v_mfma_f32_16x16x32_bf16 a[96:99], v[160:163], a[192:195], a[96:99]
    buffer_load_dwordx4 v[60:63], v5, s[8:11], s37 offen
    v_mfma_f32_16x16x32_bf16 a[128:131], v[160:163], a[196:199], a[128:131]
    v_xor_b32 v15, s99, v14
    ds_read_b128 a[200:203], v15 offset:40960
    v_mfma_f32_16x16x32_bf16 a[4:7], v[152:155], a[180:183], a[4:7]
    v_perm_b32 v156, v93, v89, s42
    v_perm_b32 v157, v101, v97, s42
    v_mfma_f32_16x16x32_bf16 a[36:39], v[152:155], a[184:187], a[36:39]
    v_perm_b32 v158, v109, v105, s42
    v_perm_b32 v159, v117, v113, s42
    v_mfma_f32_16x16x32_bf16 a[68:71], v[152:155], a[188:191], a[68:71]
    buffer_load_dwordx4 v[64:67], v6, s[8:11], s37 offen
    v_mfma_f32_16x16x32_bf16 a[100:103], v[152:155], a[192:195], a[100:103]
    buffer_load_dwordx4 v[68:71], v7, s[8:11], s37 offen
    v_mfma_f32_16x16x32_bf16 a[132:135], v[152:155], a[196:199], a[132:135]
    ds_read_b128 a[204:207], v15 offset:45056
    v_mfma_f32_16x16x32_bf16 a[8:11], v[156:159], a[180:183], a[8:11]
    v_perm_b32 v160, v93, v89, s43
    v_perm_b32 v161, v101, v97, s43
    v_mfma_f32_16x16x32_bf16 a[40:43], v[156:159], a[184:187], a[40:43]
    v_perm_b32 v162, v109, v105, s43
    v_perm_b32 v163, v117, v113, s43
    v_mfma_f32_16x16x32_bf16 a[72:75], v[156:159], a[188:191], a[72:75]
    buffer_load_dwordx4 v[72:75], v8, s[8:11], s37 offen
    v_mfma_f32_16x16x32_bf16 a[104:107], v[156:159], a[192:195], a[104:107]
    buffer_load_dwordx4 v[76:79], v9, s[8:11], s37 offen
    v_mfma_f32_16x16x32_bf16 a[136:139], v[156:159], a[196:199], a[136:139]
    ds_read_b128 a[208:211], v15 offset:49152
    v_mfma_f32_16x16x32_bf16 a[12:15], v[160:163], a[180:183], a[12:15]
    v_perm_b32 v152, v94, v90, s42
    v_perm_b32 v153, v102, v98, s42
    v_mfma_f32_16x16x32_bf16 a[44:47], v[160:163], a[184:187], a[44:47]
    v_perm_b32 v154, v110, v106, s42
    v_perm_b32 v155, v118, v114, s42
    v_mfma_f32_16x16x32_bf16 a[76:79], v[160:163], a[188:191], a[76:79]
    buffer_load_dwordx4 v[80:83], v10, s[8:11], s37 offen
    v_mfma_f32_16x16x32_bf16 a[108:111], v[160:163], a[192:195], a[108:111]
    buffer_load_dwordx4 v[84:87], v11, s[8:11], s37 offen
    v_mfma_f32_16x16x32_bf16 a[140:143], v[160:163], a[196:199], a[140:143]
    ds_read_b128 a[212:215], v15 offset:53248
    v_mfma_f32_16x16x32_bf16 a[16:19], v[152:155], a[180:183], a[16:19]
    v_perm_b32 v156, v94, v90, s43
    v_perm_b32 v157, v102, v98, s43
    v_mfma_f32_16x16x32_bf16 a[48:51], v[152:155], a[184:187], a[48:51]
    v_perm_b32 v158, v110, v106, s43
    v_perm_b32 v159, v118, v114, s43
    v_mfma_f32_16x16x32_bf16 a[80:83], v[152:155], a[188:191], a[80:83]
    s_add_u32 m0, s47, 12288
    s_add_u32 s4, s36, 12288
    buffer_load_dwordx4 v20, s[20:23], s4 offen offset:3072 nt lds
    v_mfma_f32_16x16x32_bf16 a[112:115], v[152:155], a[192:195], a[112:115]
    s_add_u32 m0, s47, 16384
    s_add_u32 s4, s36, 16384
    buffer_load_dwordx4 v17, s[20:23], s4 offen nt lds
    v_mfma_f32_16x16x32_bf16 a[144:147], v[152:155], a[196:199], a[144:147]
    ds_read_b128 a[216:219], v15 offset:57344
    v_mfma_f32_16x16x32_bf16 a[20:23], v[156:159], a[180:183], a[20:23]
    v_perm_b32 v160, v95, v91, s42
    v_perm_b32 v161, v103, v99, s42
    v_mfma_f32_16x16x32_bf16 a[52:55], v[156:159], a[184:187], a[52:55]
    v_perm_b32 v162, v111, v107, s42
    v_perm_b32 v163, v119, v115, s42
    v_mfma_f32_16x16x32_bf16 a[84:87], v[156:159], a[188:191], a[84:87]
    s_add_u32 m0, s47, 16384
    s_add_u32 s4, s36, 16384
    buffer_load_dwordx4 v18, s[20:23], s4 offen offset:1024 nt lds
    v_mfma_f32_16x16x32_bf16 a[116:119], v[156:159], a[192:195], a[116:119]
    s_add_u32 m0, s47, 16384
    s_add_u32 s4, s36, 16384
    buffer_load_dwordx4 v19, s[20:23], s4 offen offset:2048 nt lds
    v_mfma_f32_16x16x32_bf16 a[148:151], v[156:159], a[196:199], a[148:151]
    v_mfma_f32_16x16x32_bf16 a[24:27], v[160:163], a[180:183], a[24:27]
    v_perm_b32 v152, v95, v91, s43
    v_perm_b32 v153, v103, v99, s43
    v_mfma_f32_16x16x32_bf16 a[56:59], v[160:163], a[184:187], a[56:59]
    v_perm_b32 v154, v111, v107, s43
    v_perm_b32 v155, v119, v115, s43
    v_mfma_f32_16x16x32_bf16 a[88:91], v[160:163], a[188:191], a[88:91]
    s_add_u32 m0, s47, 16384
    s_add_u32 s4, s36, 16384
    buffer_load_dwordx4 v20, s[20:23], s4 offen offset:3072 nt lds
    v_mfma_f32_16x16x32_bf16 a[120:123], v[160:163], a[192:195], a[120:123]
    s_add_u32 m0, s3, 0
    s_add_u32 s6, s36, 0
    buffer_load_dwordx4 v21, s[24:27], s6 offen nt lds
    v_mfma_f32_16x16x32_bf16 a[152:155], v[160:163], a[196:199], a[152:155]
    v_mfma_f32_16x16x32_bf16 a[28:31], v[152:155], a[180:183], a[28:31]
    s_waitcnt vmcnt(28)
    v_perm_b32 v156, v124, v120, s42
    v_perm_b32 v157, v132, v128, s42
    v_mfma_f32_16x16x32_bf16 a[60:63], v[152:155], a[184:187], a[60:63]
    v_perm_b32 v158, v140, v136, s42
    v_perm_b32 v159, v148, v144, s42
    v_mfma_f32_16x16x32_bf16 a[92:95], v[152:155], a[188:191], a[92:95]
    s_add_u32 m0, s3, 0
    s_add_u32 s6, s36, 0
    buffer_load_dwordx4 v23, s[24:27], s6 offen offset:1024 nt lds
    v_mfma_f32_16x16x32_bf16 a[124:127], v[152:155], a[192:195], a[124:127]
    v_mfma_f32_16x16x32_bf16 a[156:159], v[152:155], a[196:199], a[156:159]
    s_waitcnt lgkmcnt(0)
    s_waitcnt vmcnt(24)
    s_barrier
    v_mfma_f32_16x16x32_bf16 a[0:3], v[156:159], a[200:203], a[0:3]
    v_perm_b32 v160, v124, v120, s43
    v_perm_b32 v161, v132, v128, s43
    v_mfma_f32_16x16x32_bf16 a[32:35], v[156:159], a[204:207], a[32:35]
    v_perm_b32 v162, v140, v136, s43
    v_perm_b32 v163, v148, v144, s43
    v_mfma_f32_16x16x32_bf16 a[64:67], v[156:159], a[208:211], a[64:67]
    v_mfma_f32_16x16x32_bf16 a[96:99], v[156:159], a[212:215], a[96:99]
    s_add_u32 s37, s87, s90
    buffer_load_dwordx4 v[88:91], v4, s[8:11], s37 offen
    v_mfma_f32_16x16x32_bf16 a[128:131], v[156:159], a[216:219], a[128:131]
    v_xor_b32 v15, s96, v14
    v_add_u32 v15, s95, v15
    ds_read_b128 a[160:163], v15
    v_mfma_f32_16x16x32_bf16 a[4:7], v[160:163], a[200:203], a[4:7]
    v_perm_b32 v152, v125, v121, s42
    v_perm_b32 v153, v133, v129, s42
    v_mfma_f32_16x16x32_bf16 a[36:39], v[160:163], a[204:207], a[36:39]
    v_perm_b32 v154, v141, v137, s42
    v_perm_b32 v155, v149, v145, s42
    v_mfma_f32_16x16x32_bf16 a[68:71], v[160:163], a[208:211], a[68:71]
    v_mfma_f32_16x16x32_bf16 a[100:103], v[160:163], a[212:215], a[100:103]
    buffer_load_dwordx4 v[92:95], v5, s[8:11], s37 offen
    v_mfma_f32_16x16x32_bf16 a[132:135], v[160:163], a[216:219], a[132:135]
    ds_read_b128 a[164:167], v15 offset:4096
    v_mfma_f32_16x16x32_bf16 a[8:11], v[152:155], a[200:203], a[8:11]
    v_perm_b32 v156, v125, v121, s43
    v_perm_b32 v157, v133, v129, s43
    v_mfma_f32_16x16x32_bf16 a[40:43], v[152:155], a[204:207], a[40:43]
    v_perm_b32 v158, v141, v137, s43
    v_perm_b32 v159, v149, v145, s43
    v_mfma_f32_16x16x32_bf16 a[72:75], v[152:155], a[208:211], a[72:75]
    v_mfma_f32_16x16x32_bf16 a[104:107], v[152:155], a[212:215], a[104:107]
    buffer_load_dwordx4 v[96:99], v6, s[8:11], s37 offen
    v_mfma_f32_16x16x32_bf16 a[136:139], v[152:155], a[216:219], a[136:139]
    ds_read_b128 a[168:171], v15 offset:8192
    v_mfma_f32_16x16x32_bf16 a[12:15], v[156:159], a[200:203], a[12:15]
    v_perm_b32 v160, v126, v122, s42
    v_perm_b32 v161, v134, v130, s42
    v_mfma_f32_16x16x32_bf16 a[44:47], v[156:159], a[204:207], a[44:47]
    v_perm_b32 v162, v142, v138, s42
    v_perm_b32 v163, v150, v146, s42
    v_mfma_f32_16x16x32_bf16 a[76:79], v[156:159], a[208:211], a[76:79]
    v_mfma_f32_16x16x32_bf16 a[108:111], v[156:159], a[212:215], a[108:111]
    buffer_load_dwordx4 v[100:103], v7, s[8:11], s37 offen
    v_mfma_f32_16x16x32_bf16 a[140:143], v[156:159], a[216:219], a[140:143]
    ds_read_b128 a[172:175], v15 offset:12288
    v_mfma_f32_16x16x32_bf16 a[16:19], v[160:163], a[200:203], a[16:19]
    v_perm_b32 v152, v126, v122, s43
    v_perm_b32 v153, v134, v130, s43
    v_mfma_f32_16x16x32_bf16 a[48:51], v[160:163], a[204:207], a[48:51]
    v_perm_b32 v154, v142, v138, s43
    v_perm_b32 v155, v150, v146, s43
    v_mfma_f32_16x16x32_bf16 a[80:83], v[160:163], a[208:211], a[80:83]
    v_mfma_f32_16x16x32_bf16 a[112:115], v[160:163], a[212:215], a[112:115]
    buffer_load_dwordx4 v[104:107], v8, s[8:11], s37 offen
    v_mfma_f32_16x16x32_bf16 a[144:147], v[160:163], a[216:219], a[144:147]
    ds_read_b128 a[176:179], v15 offset:16384
    v_mfma_f32_16x16x32_bf16 a[20:23], v[152:155], a[200:203], a[20:23]
    v_perm_b32 v156, v127, v123, s42
    v_perm_b32 v157, v135, v131, s42
    v_mfma_f32_16x16x32_bf16 a[52:55], v[152:155], a[204:207], a[52:55]
    v_perm_b32 v158, v143, v139, s42
    v_perm_b32 v159, v151, v147, s42
    v_mfma_f32_16x16x32_bf16 a[84:87], v[152:155], a[208:211], a[84:87]
    v_mfma_f32_16x16x32_bf16 a[116:119], v[152:155], a[212:215], a[116:119]
    buffer_load_dwordx4 v[108:111], v9, s[8:11], s37 offen
    v_mfma_f32_16x16x32_bf16 a[148:151], v[152:155], a[216:219], a[148:151]
    v_mfma_f32_16x16x32_bf16 a[24:27], v[156:159], a[200:203], a[24:27]
    v_perm_b32 v160, v127, v123, s43
    v_perm_b32 v161, v135, v131, s43
    v_mfma_f32_16x16x32_bf16 a[56:59], v[156:159], a[204:207], a[56:59]
    v_perm_b32 v162, v143, v139, s43
    v_perm_b32 v163, v151, v147, s43
    v_mfma_f32_16x16x32_bf16 a[88:91], v[156:159], a[208:211], a[88:91]
    v_mfma_f32_16x16x32_bf16 a[120:123], v[156:159], a[212:215], a[120:123]
    buffer_load_dwordx4 v[112:115], v10, s[8:11], s37 offen
    v_mfma_f32_16x16x32_bf16 a[152:155], v[156:159], a[216:219], a[152:155]
    v_mfma_f32_16x16x32_bf16 a[28:31], v[160:163], a[200:203], a[28:31]
    s_waitcnt vmcnt(22)
    v_perm_b32 v152, v28, v24, s42
    v_perm_b32 v153, v36, v32, s42
    v_mfma_f32_16x16x32_bf16 a[60:63], v[160:163], a[204:207], a[60:63]
    v_perm_b32 v154, v44, v40, s42
    v_perm_b32 v155, v52, v48, s42
    v_mfma_f32_16x16x32_bf16 a[92:95], v[160:163], a[208:211], a[92:95]
    v_mfma_f32_16x16x32_bf16 a[124:127], v[160:163], a[212:215], a[124:127]
    buffer_load_dwordx4 v[116:119], v11, s[8:11], s37 offen
    v_mfma_f32_16x16x32_bf16 a[156:159], v[160:163], a[216:219], a[156:159]
    s_waitcnt lgkmcnt(0)
    s_barrier
    v_mfma_f32_16x16x32_bf16 a[0:3], v[152:155], a[160:163], a[0:3]
    v_perm_b32 v156, v28, v24, s43
    v_perm_b32 v157, v36, v32, s43
    v_mfma_f32_16x16x32_bf16 a[32:35], v[152:155], a[164:167], a[32:35]
    v_perm_b32 v158, v44, v40, s43
    v_perm_b32 v159, v52, v48, s43
    v_mfma_f32_16x16x32_bf16 a[64:67], v[152:155], a[168:171], a[64:67]
    s_add_u32 s37, s87, s91
    buffer_load_dwordx4 v[120:123], v4, s[8:11], s37 offen
    v_mfma_f32_16x16x32_bf16 a[96:99], v[152:155], a[172:175], a[96:99]
    buffer_load_dwordx4 v[124:127], v5, s[8:11], s37 offen
    v_mfma_f32_16x16x32_bf16 a[128:131], v[152:155], a[176:179], a[128:131]
    v_xor_b32 v15, s97, v14
    v_add_u32 v15, s95, v15
    ds_read_b128 a[180:183], v15
    ds_read_b128 a[184:187], v15 offset:4096
    v_mfma_f32_16x16x32_bf16 a[4:7], v[156:159], a[160:163], a[4:7]
    v_perm_b32 v160, v29, v25, s42
    v_perm_b32 v161, v37, v33, s42
    v_mfma_f32_16x16x32_bf16 a[36:39], v[156:159], a[164:167], a[36:39]
    v_perm_b32 v162, v45, v41, s42
    v_perm_b32 v163, v53, v49, s42
    v_mfma_f32_16x16x32_bf16 a[68:71], v[156:159], a[168:171], a[68:71]
    buffer_load_dwordx4 v[128:131], v6, s[8:11], s37 offen
    v_mfma_f32_16x16x32_bf16 a[100:103], v[156:159], a[172:175], a[100:103]
    buffer_load_dwordx4 v[132:135], v7, s[8:11], s37 offen
    v_mfma_f32_16x16x32_bf16 a[132:135], v[156:159], a[176:179], a[132:135]
    ds_read_b128 a[188:191], v15 offset:8192
    v_mfma_f32_16x16x32_bf16 a[8:11], v[160:163], a[160:163], a[8:11]
    v_perm_b32 v152, v29, v25, s43
    v_perm_b32 v153, v37, v33, s43
    v_mfma_f32_16x16x32_bf16 a[40:43], v[160:163], a[164:167], a[40:43]
    v_perm_b32 v154, v45, v41, s43
    v_perm_b32 v155, v53, v49, s43
    v_mfma_f32_16x16x32_bf16 a[72:75], v[160:163], a[168:171], a[72:75]
    buffer_load_dwordx4 v[136:139], v8, s[8:11], s37 offen
    v_mfma_f32_16x16x32_bf16 a[104:107], v[160:163], a[172:175], a[104:107]
    buffer_load_dwordx4 v[140:143], v9, s[8:11], s37 offen
    v_mfma_f32_16x16x32_bf16 a[136:139], v[160:163], a[176:179], a[136:139]
    ds_read_b128 a[192:195], v15 offset:12288
    v_mfma_f32_16x16x32_bf16 a[12:15], v[152:155], a[160:163], a[12:15]
    v_perm_b32 v156, v30, v26, s42
    v_perm_b32 v157, v38, v34, s42
    v_mfma_f32_16x16x32_bf16 a[44:47], v[152:155], a[164:167], a[44:47]
    v_perm_b32 v158, v46, v42, s42
    v_perm_b32 v159, v54, v50, s42
    v_mfma_f32_16x16x32_bf16 a[76:79], v[152:155], a[168:171], a[76:79]
    buffer_load_dwordx4 v[144:147], v10, s[8:11], s37 offen
    v_mfma_f32_16x16x32_bf16 a[108:111], v[152:155], a[172:175], a[108:111]
    buffer_load_dwordx4 v[148:151], v11, s[8:11], s37 offen
    v_mfma_f32_16x16x32_bf16 a[140:143], v[152:155], a[176:179], a[140:143]
    ds_read_b128 a[196:199], v15 offset:16384
    v_mfma_f32_16x16x32_bf16 a[16:19], v[156:159], a[160:163], a[16:19]
    v_perm_b32 v160, v30, v26, s43
    v_perm_b32 v161, v38, v34, s43
    v_mfma_f32_16x16x32_bf16 a[48:51], v[156:159], a[164:167], a[48:51]
    v_perm_b32 v162, v46, v42, s43
    v_perm_b32 v163, v54, v50, s43
    v_mfma_f32_16x16x32_bf16 a[80:83], v[156:159], a[168:171], a[80:83]
    s_add_u32 m0, s3, 0
    s_add_u32 s6, s36, 0
    buffer_load_dwordx4 v21, s[24:27], s6 offen offset:2048 nt lds
    v_mfma_f32_16x16x32_bf16 a[112:115], v[156:159], a[172:175], a[112:115]
    s_add_u32 m0, s3, 0
    s_add_u32 s6, s36, 0
    buffer_load_dwordx4 v23, s[24:27], s6 offen offset:3072 nt lds
    v_mfma_f32_16x16x32_bf16 a[144:147], v[156:159], a[176:179], a[144:147]
    v_xor_b32 v15, s98, v14
    v_add_u32 v15, s95, v15
    ds_read_b128 a[200:203], v15
    ds_read_b128 a[204:207], v15 offset:4096
    v_mfma_f32_16x16x32_bf16 a[20:23], v[160:163], a[160:163], a[20:23]
    v_perm_b32 v152, v31, v27, s42
    v_perm_b32 v153, v39, v35, s42
    v_mfma_f32_16x16x32_bf16 a[52:55], v[160:163], a[164:167], a[52:55]
    v_perm_b32 v154, v47, v43, s42
    v_perm_b32 v155, v55, v51, s42
    v_mfma_f32_16x16x32_bf16 a[84:87], v[160:163], a[168:171], a[84:87]
    s_add_u32 m0, s3, 16384
    s_add_u32 s6, s36, 4096
    buffer_load_dwordx4 v21, s[24:27], s6 offen nt lds
    v_mfma_f32_16x16x32_bf16 a[116:119], v[160:163], a[172:175], a[116:119]
    s_add_u32 m0, s3, 16384
    s_add_u32 s6, s36, 4096
    buffer_load_dwordx4 v23, s[24:27], s6 offen offset:1024 nt lds
    v_mfma_f32_16x16x32_bf16 a[148:151], v[160:163], a[176:179], a[148:151]
    ds_read_b128 a[208:211], v15 offset:8192
    v_mfma_f32_16x16x32_bf16 a[24:27], v[152:155], a[160:163], a[24:27]
    v_perm_b32 v156, v31, v27, s43
    v_perm_b32 v157, v39, v35, s43
    v_mfma_f32_16x16x32_bf16 a[56:59], v[152:155], a[164:167], a[56:59]
    v_perm_b32 v158, v47, v43, s43
    v_perm_b32 v159, v55, v51, s43
    v_mfma_f32_16x16x32_bf16 a[88:91], v[152:155], a[168:171], a[88:91]
    s_add_u32 m0, s3, 16384
    s_add_u32 s6, s36, 4096
    buffer_load_dwordx4 v21, s[24:27], s6 offen offset:2048 nt lds
    v_mfma_f32_16x16x32_bf16 a[120:123], v[152:155], a[172:175], a[120:123]
    s_add_u32 m0, s3, 16384
    s_add_u32 s6, s36, 4096
    buffer_load_dwordx4 v23, s[24:27], s6 offen offset:3072 nt lds
    v_mfma_f32_16x16x32_bf16 a[152:155], v[152:155], a[176:179], a[152:155]
    ds_read_b128 a[212:215], v15 offset:12288
    v_mfma_f32_16x16x32_bf16 a[28:31], v[156:159], a[160:163], a[28:31]
    s_waitcnt vmcnt(29)
    v_perm_b32 v160, v60, v56, s42
    v_perm_b32 v161, v68, v64, s42
    v_mfma_f32_16x16x32_bf16 a[60:63], v[156:159], a[164:167], a[60:63]
    v_perm_b32 v162, v76, v72, s42
    v_perm_b32 v163, v84, v80, s42
    v_mfma_f32_16x16x32_bf16 a[92:95], v[156:159], a[168:171], a[92:95]
    v_mfma_f32_16x16x32_bf16 a[124:127], v[156:159], a[172:175], a[124:127]
    v_mfma_f32_16x16x32_bf16 a[156:159], v[156:159], a[176:179], a[156:159]
    ds_read_b128 a[216:219], v15 offset:16384
    s_waitcnt lgkmcnt(5)
    v_mfma_f32_16x16x32_bf16 a[0:3], v[160:163], a[180:183], a[0:3]
    s_waitcnt vmcnt(14)
    v_perm_b32 v152, v92, v88, s42
    v_perm_b32 v153, v100, v96, s42
    v_mfma_f32_16x16x32_bf16 a[32:35], v[160:163], a[184:187], a[32:35]
    v_perm_b32 v154, v108, v104, s42
    v_perm_b32 v155, v116, v112, s42
    v_mfma_f32_16x16x32_bf16 a[64:67], v[160:163], a[188:191], a[64:67]
    v_xor_b32 v15, s99, v14
    v_add_u32 v15, s95, v15
    ds_read_b128 a[160:163], v15
    v_mfma_f32_16x16x32_bf16 a[96:99], v[160:163], a[192:195], a[96:99]
    ds_read_b128 a[164:167], v15 offset:4096
    ds_read_b128 a[168:171], v15 offset:8192
    v_mfma_f32_16x16x32_bf16 a[128:131], v[160:163], a[196:199], a[128:131]
    ds_read_b128 a[172:175], v15 offset:12288
    ds_read_b128 a[176:179], v15 offset:16384
    s_add_u32 m0, s3, 32768
    s_add_u32 s6, s36, 8192
    buffer_load_dwordx4 v21, s[24:27], s6 offen nt lds
    s_waitcnt lgkmcnt(5)
    v_mfma_f32_16x16x32_bf16 a[0:3], v[152:155], a[200:203], a[0:3]
    s_waitcnt vmcnt(7)
    v_perm_b32 v156, v124, v120, s42
    v_perm_b32 v157, v132, v128, s42
    v_mfma_f32_16x16x32_bf16 a[32:35], v[152:155], a[204:207], a[32:35]
    v_perm_b32 v158, v140, v136, s42
    v_perm_b32 v159, v148, v144, s42
    v_mfma_f32_16x16x32_bf16 a[64:67], v[152:155], a[208:211], a[64:67]
    v_mfma_f32_16x16x32_bf16 a[96:99], v[152:155], a[212:215], a[96:99]
    v_mfma_f32_16x16x32_bf16 a[128:131], v[152:155], a[216:219], a[128:131]
    s_waitcnt lgkmcnt(0)
    v_mfma_f32_16x16x32_bf16 a[0:3], v[156:159], a[160:163], a[0:3]
    v_perm_b32 v160, v60, v56, s43
    v_perm_b32 v161, v68, v64, s43
    v_mfma_f32_16x16x32_bf16 a[32:35], v[156:159], a[164:167], a[32:35]
    v_perm_b32 v162, v76, v72, s43
    v_perm_b32 v163, v84, v80, s43
    v_mfma_f32_16x16x32_bf16 a[64:67], v[156:159], a[168:171], a[64:67]
    v_mfma_f32_16x16x32_bf16 a[96:99], v[156:159], a[172:175], a[96:99]
    v_mfma_f32_16x16x32_bf16 a[128:131], v[156:159], a[176:179], a[128:131]
    v_mfma_f32_16x16x32_bf16 a[4:7], v[160:163], a[180:183], a[4:7]
    v_perm_b32 v152, v92, v88, s43
    v_perm_b32 v153, v100, v96, s43
    v_mfma_f32_16x16x32_bf16 a[36:39], v[160:163], a[184:187], a[36:39]
    v_perm_b32 v154, v108, v104, s43
    v_perm_b32 v155, v116, v112, s43
    v_mfma_f32_16x16x32_bf16 a[68:71], v[160:163], a[188:191], a[68:71]
    v_mfma_f32_16x16x32_bf16 a[100:103], v[160:163], a[192:195], a[100:103]
    v_mfma_f32_16x16x32_bf16 a[132:135], v[160:163], a[196:199], a[132:135]
    v_mfma_f32_16x16x32_bf16 a[4:7], v[152:155], a[200:203], a[4:7]
    v_perm_b32 v156, v124, v120, s43
    v_perm_b32 v157, v132, v128, s43
    v_mfma_f32_16x16x32_bf16 a[36:39], v[152:155], a[204:207], a[36:39]
    v_perm_b32 v158, v140, v136, s43
    v_perm_b32 v159, v148, v144, s43
    v_mfma_f32_16x16x32_bf16 a[68:71], v[152:155], a[208:211], a[68:71]
    v_mfma_f32_16x16x32_bf16 a[100:103], v[152:155], a[212:215], a[100:103]
    v_mfma_f32_16x16x32_bf16 a[132:135], v[152:155], a[216:219], a[132:135]
    s_add_u32 m0, s3, 32768
    s_add_u32 s6, s36, 8192
    buffer_load_dwordx4 v23, s[24:27], s6 offen offset:1024 nt lds
    v_mfma_f32_16x16x32_bf16 a[4:7], v[156:159], a[160:163], a[4:7]
    v_perm_b32 v160, v61, v57, s42
    v_perm_b32 v161, v69, v65, s42
    v_mfma_f32_16x16x32_bf16 a[36:39], v[156:159], a[164:167], a[36:39]
    v_perm_b32 v162, v77, v73, s42
    v_perm_b32 v163, v85, v81, s42
    v_mfma_f32_16x16x32_bf16 a[68:71], v[156:159], a[168:171], a[68:71]
    v_mfma_f32_16x16x32_bf16 a[100:103], v[156:159], a[172:175], a[100:103]
    v_mfma_f32_16x16x32_bf16 a[132:135], v[156:159], a[176:179], a[132:135]
    v_mfma_f32_16x16x32_bf16 a[8:11], v[160:163], a[180:183], a[8:11]
    v_perm_b32 v152, v93, v89, s42
    v_perm_b32 v153, v101, v97, s42
    v_mfma_f32_16x16x32_bf16 a[40:43], v[160:163], a[184:187], a[40:43]
    v_perm_b32 v154, v109, v105, s42
    v_perm_b32 v155, v117, v113, s42
    v_mfma_f32_16x16x32_bf16 a[72:75], v[160:163], a[188:191], a[72:75]
    v_mfma_f32_16x16x32_bf16 a[104:107], v[160:163], a[192:195], a[104:107]
    v_accvgpr_read_b32 v164, a0
    v_accvgpr_read_b32 v165, a4
    v_accvgpr_read_b32 v166, a1
    v_accvgpr_read_b32 v167, a5
    v_mfma_f32_16x16x32_bf16 a[136:139], v[160:163], a[196:199], a[136:139]
    v_cvt_pk_bf16_f32 v176, v164, v165
    v_cvt_pk_bf16_f32 v180, v166, v167
    v_accvgpr_read_b32 v168, a2
    v_accvgpr_read_b32 v169, a6
    v_mfma_f32_16x16x32_bf16 a[8:11], v[152:155], a[200:203], a[8:11]
    v_perm_b32 v156, v125, v121, s42
    v_perm_b32 v157, v133, v129, s42
    v_mfma_f32_16x16x32_bf16 a[40:43], v[152:155], a[204:207], a[40:43]
    v_perm_b32 v158, v141, v137, s42
    v_perm_b32 v159, v149, v145, s42
    v_mfma_f32_16x16x32_bf16 a[72:75], v[152:155], a[208:211], a[72:75]
    v_accvgpr_read_b32 v170, a3
    v_accvgpr_read_b32 v171, a7
    v_cvt_pk_bf16_f32 v184, v168, v169
    v_mfma_f32_16x16x32_bf16 a[104:107], v[152:155], a[212:215], a[104:107]
    v_cvt_pk_bf16_f32 v188, v170, v171
    v_accvgpr_read_b32 v172, a32
    v_accvgpr_read_b32 v173, a36
    v_accvgpr_read_b32 v174, a33
    v_mfma_f32_16x16x32_bf16 a[136:139], v[152:155], a[216:219], a[136:139]
    v_accvgpr_read_b32 v175, a37
    v_cvt_pk_bf16_f32 v192, v172, v173
    v_cvt_pk_bf16_f32 v196, v174, v175
    v_mfma_f32_16x16x32_bf16 a[8:11], v[156:159], a[160:163], a[8:11]
    v_perm_b32 v160, v61, v57, s43
    v_perm_b32 v161, v69, v65, s43
    v_mfma_f32_16x16x32_bf16 a[40:43], v[156:159], a[164:167], a[40:43]
    v_perm_b32 v162, v77, v73, s43
    v_perm_b32 v163, v85, v81, s43
    v_mfma_f32_16x16x32_bf16 a[72:75], v[156:159], a[168:171], a[72:75]
    v_accvgpr_read_b32 v164, a34
    v_accvgpr_read_b32 v165, a38
    v_accvgpr_read_b32 v166, a35
    v_accvgpr_read_b32 v167, a39
    v_mfma_f32_16x16x32_bf16 a[104:107], v[156:159], a[172:175], a[104:107]
    v_cvt_pk_bf16_f32 v200, v164, v165
    v_cvt_pk_bf16_f32 v204, v166, v167
    v_accvgpr_read_b32 v168, a64
    v_mfma_f32_16x16x32_bf16 a[136:139], v[156:159], a[176:179], a[136:139]
    v_accvgpr_read_b32 v169, a68
    v_accvgpr_read_b32 v170, a65
    v_accvgpr_read_b32 v171, a69
    v_cvt_pk_bf16_f32 v208, v168, v169
    v_mfma_f32_16x16x32_bf16 a[12:15], v[160:163], a[180:183], a[12:15]
    v_perm_b32 v152, v93, v89, s43
    v_perm_b32 v153, v101, v97, s43
    v_mfma_f32_16x16x32_bf16 a[44:47], v[160:163], a[184:187], a[44:47]
    v_perm_b32 v154, v109, v105, s43
    v_perm_b32 v155, v117, v113, s43
    v_mfma_f32_16x16x32_bf16 a[76:79], v[160:163], a[188:191], a[76:79]
    v_cvt_pk_bf16_f32 v212, v170, v171
    v_accvgpr_read_b32 v172, a66
    v_accvgpr_read_b32 v173, a70
    v_mfma_f32_16x16x32_bf16 a[108:111], v[160:163], a[192:195], a[108:111]
    v_accvgpr_read_b32 v174, a67
    v_accvgpr_read_b32 v175, a71
    v_cvt_pk_bf16_f32 v216, v172, v173
    v_cvt_pk_bf16_f32 v220, v174, v175
    v_mfma_f32_16x16x32_bf16 a[140:143], v[160:163], a[196:199], a[140:143]
    v_accvgpr_read_b32 v164, a96
    v_accvgpr_read_b32 v165, a100
    v_accvgpr_read_b32 v166, a97
    s_add_u32 m0, s3, 32768
    s_add_u32 s6, s36, 8192
    buffer_load_dwordx4 v21, s[24:27], s6 offen offset:2048 nt lds
    v_mfma_f32_16x16x32_bf16 a[12:15], v[152:155], a[200:203], a[12:15]
    v_perm_b32 v156, v125, v121, s43
    v_perm_b32 v157, v133, v129, s43
    v_mfma_f32_16x16x32_bf16 a[44:47], v[152:155], a[204:207], a[44:47]
    v_perm_b32 v158, v141, v137, s43
    v_perm_b32 v159, v149, v145, s43
    v_mfma_f32_16x16x32_bf16 a[76:79], v[152:155], a[208:211], a[76:79]
    v_accvgpr_read_b32 v167, a101
    v_cvt_pk_bf16_f32 v224, v164, v165
    v_cvt_pk_bf16_f32 v228, v166, v167
    v_accvgpr_read_b32 v168, a98
    v_mfma_f32_16x16x32_bf16 a[108:111], v[152:155], a[212:215], a[108:111]
    v_accvgpr_read_b32 v169, a102
    v_accvgpr_read_b32 v170, a99
    v_accvgpr_read_b32 v171, a103
    v_mfma_f32_16x16x32_bf16 a[140:143], v[152:155], a[216:219], a[140:143]
    v_cvt_pk_bf16_f32 v232, v168, v169
    v_cvt_pk_bf16_f32 v236, v170, v171
    v_accvgpr_read_b32 v172, a128
    v_accvgpr_read_b32 v173, a132
    v_mfma_f32_16x16x32_bf16 a[12:15], v[156:159], a[160:163], a[12:15]
    v_perm_b32 v160, v62, v58, s42
    v_perm_b32 v161, v70, v66, s42
    v_mfma_f32_16x16x32_bf16 a[44:47], v[156:159], a[164:167], a[44:47]
    v_perm_b32 v162, v78, v74, s42
    v_perm_b32 v163, v86, v82, s42
    v_mfma_f32_16x16x32_bf16 a[76:79], v[156:159], a[168:171], a[76:79]
    v_accvgpr_read_b32 v174, a129
    v_accvgpr_read_b32 v175, a133
    v_cvt_pk_bf16_f32 v240, v172, v173
    v_mfma_f32_16x16x32_bf16 a[108:111], v[156:159], a[172:175], a[108:111]
    v_cvt_pk_bf16_f32 v244, v174, v175
    v_accvgpr_read_b32 v164, a130
    v_accvgpr_read_b32 v165, a134
    v_accvgpr_read_b32 v166, a131
    v_mfma_f32_16x16x32_bf16 a[140:143], v[156:159], a[176:179], a[140:143]
    v_accvgpr_read_b32 v167, a135
    v_cvt_pk_bf16_f32 v248, v164, v165
    v_cvt_pk_bf16_f32 v252, v166, v167
    v_mfma_f32_16x16x32_bf16 a[16:19], v[160:163], a[180:183], a[16:19]
    v_perm_b32 v152, v94, v90, s42
    v_perm_b32 v153, v102, v98, s42
    v_mfma_f32_16x16x32_bf16 a[48:51], v[160:163], a[184:187], a[48:51]
    v_perm_b32 v154, v110, v106, s42
    v_perm_b32 v155, v118, v114, s42
    v_mfma_f32_16x16x32_bf16 a[80:83], v[160:163], a[188:191], a[80:83]
    v_mfma_f32_16x16x32_bf16 a[112:115], v[160:163], a[192:195], a[112:115]
    v_accvgpr_read_b32 v164, a8
    v_accvgpr_read_b32 v165, a12
    v_accvgpr_read_b32 v166, a9
    v_accvgpr_read_b32 v167, a13
    v_mfma_f32_16x16x32_bf16 a[144:147], v[160:163], a[196:199], a[144:147]
    v_cvt_pk_bf16_f32 v177, v164, v165
    v_cvt_pk_bf16_f32 v181, v166, v167
    v_accvgpr_read_b32 v168, a10
    v_accvgpr_read_b32 v169, a14
    v_mfma_f32_16x16x32_bf16 a[16:19], v[152:155], a[200:203], a[16:19]
    v_perm_b32 v156, v126, v122, s42
    v_perm_b32 v157, v134, v130, s42
    v_mfma_f32_16x16x32_bf16 a[48:51], v[152:155], a[204:207], a[48:51]
    v_perm_b32 v158, v142, v138, s42
    v_perm_b32 v159, v150, v146, s42
    v_mfma_f32_16x16x32_bf16 a[80:83], v[152:155], a[208:211], a[80:83]
    v_accvgpr_read_b32 v170, a11
    v_accvgpr_read_b32 v171, a15
    v_cvt_pk_bf16_f32 v185, v168, v169
    v_mfma_f32_16x16x32_bf16 a[112:115], v[152:155], a[212:215], a[112:115]
    v_cvt_pk_bf16_f32 v189, v170, v171
    v_accvgpr_read_b32 v172, a40
    v_accvgpr_read_b32 v173, a44
    v_accvgpr_read_b32 v174, a41
    v_mfma_f32_16x16x32_bf16 a[144:147], v[152:155], a[216:219], a[144:147]
    v_accvgpr_read_b32 v175, a45
    v_cvt_pk_bf16_f32 v193, v172, v173
    v_cvt_pk_bf16_f32 v197, v174, v175
    s_add_u32 m0, s3, 32768
    s_add_u32 s6, s36, 8192
    buffer_load_dwordx4 v23, s[24:27], s6 offen offset:3072 nt lds
    v_mfma_f32_16x16x32_bf16 a[16:19], v[156:159], a[160:163], a[16:19]
    v_perm_b32 v160, v62, v58, s43
    v_perm_b32 v161, v70, v66, s43
    v_mfma_f32_16x16x32_bf16 a[48:51], v[156:159], a[164:167], a[48:51]
    v_perm_b32 v162, v78, v74, s43
    v_perm_b32 v163, v86, v82, s43
    v_mfma_f32_16x16x32_bf16 a[80:83], v[156:159], a[168:171], a[80:83]
    v_accvgpr_read_b32 v164, a42
    v_accvgpr_read_b32 v165, a46
    v_accvgpr_read_b32 v166, a43
    v_accvgpr_read_b32 v167, a47
    v_mfma_f32_16x16x32_bf16 a[112:115], v[156:159], a[172:175], a[112:115]
    v_cvt_pk_bf16_f32 v201, v164, v165
    v_cvt_pk_bf16_f32 v205, v166, v167
    v_accvgpr_read_b32 v168, a72
    v_mfma_f32_16x16x32_bf16 a[144:147], v[156:159], a[176:179], a[144:147]
    v_accvgpr_read_b32 v169, a76
    v_accvgpr_read_b32 v170, a73
    v_accvgpr_read_b32 v171, a77
    v_cvt_pk_bf16_f32 v209, v168, v169
    v_and_b32 v22, 3, v2
    v_xor_b32 v22, v22, v3
    v_lshlrev_b32 v22, 2, v22
    v_mfma_f32_16x16x32_bf16 a[20:23], v[160:163], a[180:183], a[20:23]
    v_perm_b32 v152, v94, v90, s43
    v_perm_b32 v153, v102, v98, s43
    v_mfma_f32_16x16x32_bf16 a[52:55], v[160:163], a[184:187], a[52:55]
    v_perm_b32 v154, v110, v106, s43
    v_perm_b32 v155, v118, v114, s43
    v_mfma_f32_16x16x32_bf16 a[84:87], v[160:163], a[188:191], a[84:87]
    v_cvt_pk_bf16_f32 v213, v170, v171
    v_accvgpr_read_b32 v172, a74
    v_accvgpr_read_b32 v173, a78
    v_mfma_f32_16x16x32_bf16 a[116:119], v[160:163], a[192:195], a[116:119]
    v_accvgpr_read_b32 v174, a75
    v_accvgpr_read_b32 v175, a79
    v_cvt_pk_bf16_f32 v217, v172, v173
    v_cvt_pk_bf16_f32 v221, v174, v175
    v_mfma_f32_16x16x32_bf16 a[148:151], v[160:163], a[196:199], a[148:151]
    v_accvgpr_read_b32 v164, a104
    v_accvgpr_read_b32 v165, a108
    v_accvgpr_read_b32 v166, a105
    v_lshrrev_b32 v16, 2, v2
    v_or_b32 v22, v22, v16
    v_lshlrev_b32 v22, 4, v22
    v_mfma_f32_16x16x32_bf16 a[20:23], v[152:155], a[200:203], a[20:23]
    v_perm_b32 v156, v126, v122, s43
    v_perm_b32 v157, v134, v130, s43
    v_mfma_f32_16x16x32_bf16 a[52:55], v[152:155], a[204:207], a[52:55]
    v_perm_b32 v158, v142, v138, s43
    v_perm_b32 v159, v150, v146, s43
    v_mfma_f32_16x16x32_bf16 a[84:87], v[152:155], a[208:211], a[84:87]
    v_accvgpr_read_b32 v167, a109
    v_cvt_pk_bf16_f32 v225, v164, v165
    v_cvt_pk_bf16_f32 v229, v166, v167
    v_accvgpr_read_b32 v168, a106
    v_mfma_f32_16x16x32_bf16 a[116:119], v[152:155], a[212:215], a[116:119]
    v_accvgpr_read_b32 v169, a110
    v_accvgpr_read_b32 v170, a107
    v_accvgpr_read_b32 v171, a111
    v_mfma_f32_16x16x32_bf16 a[148:151], v[152:155], a[216:219], a[148:151]
    v_cvt_pk_bf16_f32 v233, v168, v169
    v_cvt_pk_bf16_f32 v237, v170, v171
    v_accvgpr_read_b32 v172, a136
    v_accvgpr_read_b32 v173, a140
    v_lshl_add_u32 v22, v2, 8, v22
    v_add_u32 v17, s47, v22
    v_mfma_f32_16x16x32_bf16 a[20:23], v[156:159], a[160:163], a[20:23]
    v_perm_b32 v160, v63, v59, s42
    v_perm_b32 v161, v71, v67, s42
    v_mfma_f32_16x16x32_bf16 a[52:55], v[156:159], a[164:167], a[52:55]
    v_perm_b32 v162, v79, v75, s42
    v_perm_b32 v163, v87, v83, s42
    v_mfma_f32_16x16x32_bf16 a[84:87], v[156:159], a[168:171], a[84:87]
    v_accvgpr_read_b32 v174, a137
    v_accvgpr_read_b32 v175, a141
    v_cvt_pk_bf16_f32 v241, v172, v173
    v_mfma_f32_16x16x32_bf16 a[116:119], v[156:159], a[172:175], a[116:119]
    v_cvt_pk_bf16_f32 v245, v174, v175
    v_accvgpr_read_b32 v164, a138
    v_accvgpr_read_b32 v165, a142
    v_accvgpr_read_b32 v166, a139
    v_mfma_f32_16x16x32_bf16 a[148:151], v[156:159], a[176:179], a[148:151]
    v_accvgpr_read_b32 v167, a143
    v_cvt_pk_bf16_f32 v249, v164, v165
    v_cvt_pk_bf16_f32 v253, v166, v167
    v_xor_b32 v18, 16, v17
    v_xor_b32 v19, 32, v17
    v_xor_b32 v20, 48, v17
    v_mfma_f32_16x16x32_bf16 a[24:27], v[160:163], a[180:183], a[24:27]
    v_perm_b32 v152, v95, v91, s42
    v_perm_b32 v153, v103, v99, s42
    v_mfma_f32_16x16x32_bf16 a[56:59], v[160:163], a[184:187], a[56:59]
    v_perm_b32 v154, v111, v107, s42
    v_perm_b32 v155, v119, v115, s42
    v_mfma_f32_16x16x32_bf16 a[88:91], v[160:163], a[188:191], a[88:91]
    v_mfma_f32_16x16x32_bf16 a[120:123], v[160:163], a[192:195], a[120:123]
    v_accvgpr_read_b32 v164, a16
    v_accvgpr_read_b32 v165, a20
    v_accvgpr_read_b32 v166, a17
    v_accvgpr_read_b32 v167, a21
    v_mfma_f32_16x16x32_bf16 a[152:155], v[160:163], a[196:199], a[152:155]
    v_cvt_pk_bf16_f32 v178, v164, v165
    v_cvt_pk_bf16_f32 v182, v166, v167
    v_accvgpr_read_b32 v168, a18
    v_accvgpr_read_b32 v169, a22
    v_mfma_f32_16x16x32_bf16 a[24:27], v[152:155], a[200:203], a[24:27]
    v_perm_b32 v156, v127, v123, s42
    v_perm_b32 v157, v135, v131, s42
    v_mfma_f32_16x16x32_bf16 a[56:59], v[152:155], a[204:207], a[56:59]
    v_perm_b32 v158, v143, v139, s42
    v_perm_b32 v159, v151, v147, s42
    v_mfma_f32_16x16x32_bf16 a[88:91], v[152:155], a[208:211], a[88:91]
    v_accvgpr_read_b32 v170, a19
    v_accvgpr_read_b32 v171, a23
    v_cvt_pk_bf16_f32 v186, v168, v169
    v_mfma_f32_16x16x32_bf16 a[120:123], v[152:155], a[212:215], a[120:123]
    v_cvt_pk_bf16_f32 v190, v170, v171
    v_accvgpr_read_b32 v172, a48
    v_accvgpr_read_b32 v173, a52
    v_accvgpr_read_b32 v174, a49
    v_mfma_f32_16x16x32_bf16 a[152:155], v[152:155], a[216:219], a[152:155]
    v_accvgpr_read_b32 v175, a53
    v_cvt_pk_bf16_f32 v194, v172, v173
    v_cvt_pk_bf16_f32 v198, v174, v175
    ds_read_b128 a[220:223], v17
    ds_read_b128 a[224:227], v17 offset:4096
    v_mfma_f32_16x16x32_bf16 a[24:27], v[156:159], a[160:163], a[24:27]
    v_perm_b32 v160, v63, v59, s43
    v_perm_b32 v161, v71, v67, s43
    v_mfma_f32_16x16x32_bf16 a[56:59], v[156:159], a[164:167], a[56:59]
    v_perm_b32 v162, v79, v75, s43
    v_perm_b32 v163, v87, v83, s43
    v_mfma_f32_16x16x32_bf16 a[88:91], v[156:159], a[168:171], a[88:91]
    v_accvgpr_read_b32 v164, a50
    v_accvgpr_read_b32 v165, a54
    v_accvgpr_read_b32 v166, a51
    v_accvgpr_read_b32 v167, a55
    v_mfma_f32_16x16x32_bf16 a[120:123], v[156:159], a[172:175], a[120:123]
    v_cvt_pk_bf16_f32 v202, v164, v165
    v_cvt_pk_bf16_f32 v206, v166, v167
    v_accvgpr_read_b32 v168, a80
    v_mfma_f32_16x16x32_bf16 a[152:155], v[156:159], a[176:179], a[152:155]
    v_accvgpr_read_b32 v169, a84
    v_accvgpr_read_b32 v170, a81
    v_accvgpr_read_b32 v171, a85
    v_cvt_pk_bf16_f32 v210, v168, v169
    ds_read_b128 a[228:231], v17 offset:8192
    ds_read_b128 a[232:235], v17 offset:12288
    v_mfma_f32_16x16x32_bf16 a[28:31], v[160:163], a[180:183], a[28:31]
    v_perm_b32 v152, v95, v91, s43
    v_perm_b32 v153, v103, v99, s43
    v_mfma_f32_16x16x32_bf16 a[60:63], v[160:163], a[184:187], a[60:63]
    v_perm_b32 v154, v111, v107, s43
    v_perm_b32 v155, v119, v115, s43
    v_mfma_f32_16x16x32_bf16 a[92:95], v[160:163], a[188:191], a[92:95]
    v_cvt_pk_bf16_f32 v214, v170, v171
    v_accvgpr_read_b32 v172, a82
    v_accvgpr_read_b32 v173, a86
    v_mfma_f32_16x16x32_bf16 a[124:127], v[160:163], a[192:195], a[124:127]
    v_accvgpr_read_b32 v174, a83
    v_accvgpr_read_b32 v175, a87
    v_cvt_pk_bf16_f32 v218, v172, v173
    v_cvt_pk_bf16_f32 v222, v174, v175
    v_mfma_f32_16x16x32_bf16 a[156:159], v[160:163], a[196:199], a[156:159]
    v_accvgpr_read_b32 v164, a112
    v_accvgpr_read_b32 v165, a116
    v_accvgpr_read_b32 v166, a113
    ds_read_b128 a[236:239], v17 offset:16384
    ds_read_b128 a[240:243], v18
    v_mfma_f32_16x16x32_bf16 a[28:31], v[152:155], a[200:203], a[28:31]
    v_perm_b32 v156, v127, v123, s43
    v_perm_b32 v157, v135, v131, s43
    v_mfma_f32_16x16x32_bf16 a[60:63], v[152:155], a[204:207], a[60:63]
    v_perm_b32 v158, v143, v139, s43
    v_perm_b32 v159, v151, v147, s43
    v_mfma_f32_16x16x32_bf16 a[92:95], v[152:155], a[208:211], a[92:95]
    v_accvgpr_read_b32 v167, a117
    v_cvt_pk_bf16_f32 v226, v164, v165
    v_cvt_pk_bf16_f32 v230, v166, v167
    v_accvgpr_read_b32 v168, a114
    v_mfma_f32_16x16x32_bf16 a[124:127], v[152:155], a[212:215], a[124:127]
    v_accvgpr_read_b32 v169, a118
    v_accvgpr_read_b32 v170, a115
    v_accvgpr_read_b32 v171, a119
    v_mfma_f32_16x16x32_bf16 a[156:159], v[152:155], a[216:219], a[156:159]
    v_cvt_pk_bf16_f32 v234, v168, v169
    v_cvt_pk_bf16_f32 v238, v170, v171
    v_accvgpr_read_b32 v172, a144
    v_accvgpr_read_b32 v173, a148
    ds_read_b128 a[244:247], v18 offset:4096
    ds_read_b128 a[248:251], v18 offset:8192
    v_mfma_f32_16x16x32_bf16 a[28:31], v[156:159], a[160:163], a[28:31]
    v_mfma_f32_16x16x32_bf16 a[60:63], v[156:159], a[164:167], a[60:63]
    v_mfma_f32_16x16x32_bf16 a[92:95], v[156:159], a[168:171], a[92:95]
    v_accvgpr_read_b32 v174, a145
    v_accvgpr_read_b32 v175, a149
    v_cvt_pk_bf16_f32 v242, v172, v173
    v_mfma_f32_16x16x32_bf16 a[124:127], v[156:159], a[172:175], a[124:127]
    v_cvt_pk_bf16_f32 v246, v174, v175
    v_accvgpr_read_b32 v164, a146
    v_accvgpr_read_b32 v165, a150
    v_accvgpr_read_b32 v166, a147
    v_mfma_f32_16x16x32_bf16 a[156:159], v[156:159], a[176:179], a[156:159]
    v_accvgpr_read_b32 v167, a151
    v_cvt_pk_bf16_f32 v250, v164, v165
    v_cvt_pk_bf16_f32 v254, v166, v167
    ds_read_b128 a[252:255], v18 offset:12288
L_g1e:
    s_barrier
    s_lshl_b32 s38, s7, 3
    s_add_u32 s38, s38, s34
    s_cmp_eq_u32 s32, 0
    s_cselect_b32 s38, s38, 0x1000
    v_mov_b32 v16, 0
    v_mov_b32 v22, 1
    s_mov_b64 exec, 1
    buffer_store_byte v22, v16, s[76:79], s38 offen sc1
    s_mov_b64 exec, -1
    s_add_u32 m0, s3, 49152
    s_add_u32 s6, s36, 12288
    buffer_load_dwordx4 v21, s[24:27], s6 offen nt lds
    ds_read_b128 a[160:163], v18 offset:16384
    ds_read_b128 a[164:167], v19
    ds_read_b128 a[168:171], v19 offset:4096
    ds_read_b128 a[172:175], v19 offset:8192
    ds_read_b128 a[176:179], v19 offset:12288
    ds_read_b128 a[180:183], v19 offset:16384
    ds_read_b128 a[184:187], v20
    ds_read_b128 a[188:191], v20 offset:4096
    ds_read_b128 a[192:195], v20 offset:8192
    ds_read_b128 a[196:199], v20 offset:12288
    ds_read_b128 a[200:203], v20 offset:16384
    v_accvgpr_read_b32 v164, a24
    v_accvgpr_read_b32 v165, a28
    v_accvgpr_read_b32 v166, a25
    v_accvgpr_read_b32 v167, a29
    v_cvt_pk_bf16_f32 v179, v164, v165
    v_cvt_pk_bf16_f32 v183, v166, v167
    v_accvgpr_read_b32 v168, a26
    v_accvgpr_read_b32 v169, a30
    v_accvgpr_read_b32 v170, a27
    v_accvgpr_read_b32 v171, a31
    s_add_u32 m0, s3, 49152
    s_add_u32 s6, s36, 12288
    buffer_load_dwordx4 v23, s[24:27], s6 offen offset:1024 nt lds
    v_cvt_pk_bf16_f32 v187, v168, v169
    v_cvt_pk_bf16_f32 v191, v170, v171
    v_accvgpr_read_b32 v172, a56
    v_accvgpr_read_b32 v173, a60
    s_waitcnt lgkmcnt(15)
    v_mfma_f32_16x16x32_bf16 v[124:127], a[220:223], v[176:179], 0
    v_accvgpr_read_b32 v174, a57
    v_accvgpr_read_b32 v175, a61
    v_mfma_f32_16x16x32_bf16 v[128:131], a[224:227], v[176:179], 0
    v_cvt_pk_bf16_f32 v195, v172, v173
    v_cvt_pk_bf16_f32 v199, v174, v175
    v_mfma_f32_16x16x32_bf16 v[132:135], a[228:231], v[176:179], 0
    v_accvgpr_read_b32 v164, a58
    v_accvgpr_read_b32 v165, a62
    v_mfma_f32_16x16x32_bf16 v[136:139], a[232:235], v[176:179], 0
    v_accvgpr_read_b32 v166, a59
    v_accvgpr_read_b32 v167, a63
    v_mfma_f32_16x16x32_bf16 v[140:143], a[236:239], v[176:179], 0
    v_cvt_pk_bf16_f32 v203, v164, v165
    v_cvt_pk_bf16_f32 v207, v166, v167
    s_waitcnt lgkmcnt(10)
    s_add_u32 m0, s3, 49152
    s_add_u32 s6, s36, 12288
    buffer_load_dwordx4 v21, s[24:27], s6 offen offset:2048 nt lds
    v_mfma_f32_16x16x32_bf16 v[124:127], a[240:243], v[180:183], v[124:127]
    v_accvgpr_read_b32 v168, a88
    v_accvgpr_read_b32 v169, a92
    v_mfma_f32_16x16x32_bf16 v[128:131], a[244:247], v[180:183], v[128:131]
    v_accvgpr_read_b32 v170, a89
    v_accvgpr_read_b32 v171, a93
    v_mfma_f32_16x16x32_bf16 v[132:135], a[248:251], v[180:183], v[132:135]
    v_cvt_pk_bf16_f32 v211, v168, v169
    v_cvt_pk_bf16_f32 v215, v170, v171
    v_mfma_f32_16x16x32_bf16 v[136:139], a[252:255], v[180:183], v[136:139]
    v_accvgpr_read_b32 v172, a90
    v_accvgpr_read_b32 v173, a94
    v_mfma_f32_16x16x32_bf16 v[140:143], a[160:163], v[180:183], v[140:143]
    v_accvgpr_read_b32 v174, a91
    v_accvgpr_read_b32 v175, a95
    s_waitcnt lgkmcnt(5)
    v_mfma_f32_16x16x32_bf16 v[124:127], a[164:167], v[184:187], v[124:127]
    v_cvt_pk_bf16_f32 v219, v172, v173
    v_cvt_pk_bf16_f32 v223, v174, v175
    v_mfma_f32_16x16x32_bf16 v[128:131], a[168:171], v[184:187], v[128:131]
    s_add_u32 m0, s3, 49152
    s_add_u32 s6, s36, 12288
    buffer_load_dwordx4 v23, s[24:27], s6 offen offset:3072 nt lds
    v_accvgpr_read_b32 v164, a120
    v_accvgpr_read_b32 v165, a124
    v_mfma_f32_16x16x32_bf16 v[132:135], a[172:175], v[184:187], v[132:135]
    v_accvgpr_read_b32 v166, a121
    v_accvgpr_read_b32 v167, a125
    v_mfma_f32_16x16x32_bf16 v[136:139], a[176:179], v[184:187], v[136:139]
    v_cvt_pk_bf16_f32 v227, v164, v165
    v_cvt_pk_bf16_f32 v231, v166, v167
    v_mfma_f32_16x16x32_bf16 v[140:143], a[180:183], v[184:187], v[140:143]
    v_accvgpr_read_b32 v168, a122
    v_accvgpr_read_b32 v169, a126
    s_waitcnt lgkmcnt(0)
    v_mfma_f32_16x16x32_bf16 v[124:127], a[184:187], v[188:191], v[124:127]
    v_accvgpr_read_b32 v170, a123
    v_accvgpr_read_b32 v171, a127
    v_cvt_pk_bf16_f32 v235, v168, v169
    v_mfma_f32_16x16x32_bf16 v[128:131], a[188:191], v[188:191], v[128:131]
    v_cvt_pk_bf16_f32 v239, v170, v171
    v_accvgpr_read_b32 v172, a152
    v_accvgpr_read_b32 v173, a156
    v_mfma_f32_16x16x32_bf16 v[132:135], a[192:195], v[188:191], v[132:135]
    s_add_u32 m0, s3, 65536
    s_add_u32 s6, s36, 16384
    buffer_load_dwordx4 v21, s[24:27], s6 offen nt lds
    v_accvgpr_read_b32 v174, a153
    v_accvgpr_read_b32 v175, a157
    v_cvt_pk_bf16_f32 v243, v172, v173
    v_cvt_pk_bf16_f32 v247, v174, v175
    v_mfma_f32_16x16x32_bf16 v[136:139], a[196:199], v[188:191], v[136:139]
    v_accvgpr_read_b32 v164, a154
    v_accvgpr_read_b32 v165, a158
    v_accvgpr_read_b32 v166, a155
    v_mfma_f32_16x16x32_bf16 v[140:143], a[200:203], v[188:191], v[140:143]
    v_accvgpr_read_b32 v167, a159
    v_cvt_pk_bf16_f32 v251, v164, v165
    v_cvt_pk_bf16_f32 v255, v166, v167
    v_mfma_f32_16x16x32_bf16 v[144:147], a[220:223], v[192:195], 0
    v_max3_f32 v120, v124, v125, v126
    v_max3_f32 v122, v127, v128, v129
    v_mfma_f32_16x16x32_bf16 v[148:151], a[224:227], v[192:195], 0
    v_max3_f32 v122, v122, v130, v131
    v_max3_f32 v120, v120, v132, v133
    v_max3_f32 v122, v122, v134, v135
    v_mfma_f32_16x16x32_bf16 v[152:155], a[228:231], v[192:195], 0
    v_max3_f32 v120, v120, v136, v137
    s_add_u32 m0, s3, 65536
    s_add_u32 s6, s36, 16384
    buffer_load_dwordx4 v23, s[24:27], s6 offen offset:1024 nt lds
    v_max3_f32 v122, v122, v138, v139
    v_mfma_f32_16x16x32_bf16 v[156:159], a[232:235], v[192:195], 0
    v_max3_f32 v120, v120, v140, v141
    v_max3_f32 v122, v122, v142, v143
    v_max_f32 v120, v120, v122
    v_mfma_f32_16x16x32_bf16 v[160:163], a[236:239], v[192:195], 0
    v_mov_b32 v122, v120
    s_lshr_b32 s38, s33, 2
    s_lshl_b32 s38, s38, 1
    v_mfma_f32_16x16x32_bf16 v[144:147], a[240:243], v[196:199], v[144:147]
    v_permlane32_swap_b32 v120, v122
    v_max_f32 v120, v120, v122
    v_mfma_f32_16x16x32_bf16 v[148:151], a[244:247], v[196:199], v[148:151]
    v_mov_b32 v122, v120
    s_lshr_b32 s38, 0xe79, s38
    s_lshl_b32 s84, s32, 17
    v_permlane16_swap_b32 v120, v122
    v_mfma_f32_16x16x32_bf16 v[152:155], a[248:251], v[196:199], v[152:155]
    v_max_f32 v120, v120, v122
    v_mul_f32 v120, s45, v120
    s_add_u32 m0, s3, 65536
    s_add_u32 s6, s36, 16384
    buffer_load_dwordx4 v21, s[24:27], s6 offen offset:2048 nt lds
    v_pk_fma_f32 v[124:125], v[124:125], s[44:45], v[120:121] op_sel_hi:[1,1,0] neg_lo:[0,0,1] neg_hi:[0,0,1]
    v_pk_fma_f32 v[126:127], v[126:127], s[44:45], v[120:121] op_sel_hi:[1,1,0] neg_lo:[0,0,1] neg_hi:[0,0,1]
    v_pk_fma_f32 v[128:129], v[128:129], s[44:45], v[120:121] op_sel_hi:[1,1,0] neg_lo:[0,0,1] neg_hi:[0,0,1]
    v_pk_fma_f32 v[130:131], v[130:131], s[44:45], v[120:121] op_sel_hi:[1,1,0] neg_lo:[0,0,1] neg_hi:[0,0,1]
    v_pk_fma_f32 v[132:133], v[132:133], s[44:45], v[120:121] op_sel_hi:[1,1,0] neg_lo:[0,0,1] neg_hi:[0,0,1]
    v_pk_fma_f32 v[134:135], v[134:135], s[44:45], v[120:121] op_sel_hi:[1,1,0] neg_lo:[0,0,1] neg_hi:[0,0,1]
    v_pk_fma_f32 v[136:137], v[136:137], s[44:45], v[120:121] op_sel_hi:[1,1,0] neg_lo:[0,0,1] neg_hi:[0,0,1]
    v_pk_fma_f32 v[138:139], v[138:139], s[44:45], v[120:121] op_sel_hi:[1,1,0] neg_lo:[0,0,1] neg_hi:[0,0,1]
    v_pk_fma_f32 v[140:141], v[140:141], s[44:45], v[120:121] op_sel_hi:[1,1,0] neg_lo:[0,0,1] neg_hi:[0,0,1]
    v_pk_fma_f32 v[142:143], v[142:143], s[44:45], v[120:121] op_sel_hi:[1,1,0] neg_lo:[0,0,1] neg_hi:[0,0,1]
    v_mfma_f32_16x16x32_bf16 v[156:159], a[252:255], v[196:199], v[156:159]
    v_exp_f32 v124, v124
    v_exp_f32 v125, v125
    v_mfma_f32_16x16x32_bf16 v[160:163], a[160:163], v[196:199], v[160:163]
    v_exp_f32 v126, v126
    v_mfma_f32_16x16x32_bf16 v[144:147], a[164:167], v[200:203], v[144:147]
    v_exp_f32 v127, v127
    v_exp_f32 v128, v128
    v_mfma_f32_16x16x32_bf16 v[148:151], a[168:171], v[200:203], v[148:151]
    v_exp_f32 v129, v129
    v_exp_f32 v130, v130
    s_add_u32 m0, s3, 65536
    s_add_u32 s6, s36, 16384
    buffer_load_dwordx4 v23, s[24:27], s6 offen offset:3072 nt lds
    v_mfma_f32_16x16x32_bf16 v[152:155], a[172:175], v[200:203], v[152:155]
    v_exp_f32 v131, v131
    v_mfma_f32_16x16x32_bf16 v[156:159], a[176:179], v[200:203], v[156:159]
    v_exp_f32 v132, v132
    v_exp_f32 v133, v133
    v_mfma_f32_16x16x32_bf16 v[160:163], a[180:183], v[200:203], v[160:163]
    v_exp_f32 v134, v134
    v_exp_f32 v135, v135
    v_mfma_f32_16x16x32_bf16 v[144:147], a[184:187], v[204:207], v[144:147]
    v_exp_f32 v136, v136
    v_mfma_f32_16x16x32_bf16 v[148:151], a[188:191], v[204:207], v[148:151]
    v_exp_f32 v137, v137
    v_exp_f32 v138, v138
    v_mfma_f32_16x16x32_bf16 v[152:155], a[192:195], v[204:207], v[152:155]
    v_exp_f32 v139, v139
    v_exp_f32 v140, v140
    v_mfma_f32_16x16x32_bf16 v[156:159], a[196:199], v[204:207], v[156:159]
    v_exp_f32 v141, v141
    v_mfma_f32_16x16x32_bf16 v[160:163], a[200:203], v[204:207], v[160:163]
    v_exp_f32 v142, v142
    v_exp_f32 v143, v143
    s_mul_i32 s92, s32, 20480
    v_pk_add_f32 v[120:121], v[124:125], v[126:127]
    v_pk_add_f32 v[120:121], v[120:121], v[128:129]
    v_pk_add_f32 v[120:121], v[120:121], v[130:131]
    v_pk_add_f32 v[120:121], v[120:121], v[132:133]
    v_pk_add_f32 v[120:121], v[120:121], v[134:135]
    v_pk_add_f32 v[120:121], v[120:121], v[136:137]
    v_pk_add_f32 v[120:121], v[120:121], v[138:139]
    v_pk_add_f32 v[120:121], v[120:121], v[140:141]
    v_pk_add_f32 v[120:121], v[120:121], v[142:143]
    v_add_f32 v120, v120, v121
    v_mov_b32 v122, v120
    s_add_u32 s92, s92, 81920
    s_add_u32 s39, s33, 0
    v_permlane32_swap_b32 v120, v122
    v_add_f32 v120, v120, v122
    v_mov_b32 v122, v120
    s_and_b32 s39, s39, 3
    s_lshl_b32 s88, s39, 15
    v_permlane16_swap_b32 v120, v122
    v_add_f32 v120, v120, v122
    v_rcp_f32 v120, v120
    s_lshl_b32 s96, s39, 6
    v_pk_mul_f32 v[124:125], v[124:125], v[120:121] op_sel_hi:[1,0]
    v_pk_mul_f32 v[126:127], v[126:127], v[120:121] op_sel_hi:[1,0]
    v_pk_mul_f32 v[128:129], v[128:129], v[120:121] op_sel_hi:[1,0]
    v_pk_mul_f32 v[130:131], v[130:131], v[120:121] op_sel_hi:[1,0]
    v_pk_mul_f32 v[132:133], v[132:133], v[120:121] op_sel_hi:[1,0]
    v_pk_mul_f32 v[134:135], v[134:135], v[120:121] op_sel_hi:[1,0]
    v_pk_mul_f32 v[136:137], v[136:137], v[120:121] op_sel_hi:[1,0]
    v_pk_mul_f32 v[138:139], v[138:139], v[120:121] op_sel_hi:[1,0]
    v_pk_mul_f32 v[140:141], v[140:141], v[120:121] op_sel_hi:[1,0]
    v_pk_mul_f32 v[142:143], v[142:143], v[120:121] op_sel_hi:[1,0]
    v_cvt_pk_bf16_f32 v176, v124, v125
    v_cvt_pk_bf16_f32 v177, v126, v127
    v_cvt_pk_bf16_f32 v178, v128, v129
    v_cvt_pk_bf16_f32 v179, v130, v131
    v_cvt_pk_bf16_f32 v180, v132, v133
    v_cvt_pk_bf16_f32 v181, v134, v135
    v_cvt_pk_bf16_f32 v182, v136, v137
    v_cvt_pk_bf16_f32 v183, v138, v139
    v_cvt_pk_bf16_f32 v184, v140, v141
    v_cvt_pk_bf16_f32 v185, v142, v143
    v_mfma_f32_16x16x32_bf16 v[124:127], a[220:223], v[208:211], 0
    v_max3_f32 v120, v144, v145, v146
    v_max3_f32 v122, v147, v148, v149
    v_mfma_f32_16x16x32_bf16 v[128:131], a[224:227], v[208:211], 0
    v_max3_f32 v122, v122, v150, v151
    v_max3_f32 v120, v120, v152, v153
    v_max3_f32 v122, v122, v154, v155
    v_mfma_f32_16x16x32_bf16 v[132:135], a[228:231], v[208:211], 0
    v_max3_f32 v120, v120, v156, v157
    v_max3_f32 v122, v122, v158, v159
    v_mfma_f32_16x16x32_bf16 v[136:139], a[232:235], v[208:211], 0
    v_max3_f32 v120, v120, v160, v161
    v_max3_f32 v122, v122, v162, v163
    v_max_f32 v120, v120, v122
    v_mfma_f32_16x16x32_bf16 v[140:143], a[236:239], v[208:211], 0
    v_mov_b32 v122, v120
    s_bfe_u32 s39, s38, 0x20000
    s_add_u32 s39, s32, s39
    v_mfma_f32_16x16x32_bf16 v[124:127], a[240:243], v[212:215], v[124:127]
    v_permlane32_swap_b32 v120, v122
    v_max_f32 v120, v120, v122
    v_mfma_f32_16x16x32_bf16 v[128:131], a[244:247], v[212:215], v[128:131]
    v_mov_b32 v122, v120
    s_and_b32 s39, s39, 3
    s_lshl_b32 s85, s39, 17
    v_permlane16_swap_b32 v120, v122
    v_mfma_f32_16x16x32_bf16 v[132:135], a[248:251], v[212:215], v[132:135]
    v_max_f32 v120, v120, v122
    v_mul_f32 v120, s45, v120
    v_pk_fma_f32 v[144:145], v[144:145], s[44:45], v[120:121] op_sel_hi:[1,1,0] neg_lo:[0,0,1] neg_hi:[0,0,1]
    v_pk_fma_f32 v[146:147], v[146:147], s[44:45], v[120:121] op_sel_hi:[1,1,0] neg_lo:[0,0,1] neg_hi:[0,0,1]
    v_pk_fma_f32 v[148:149], v[148:149], s[44:45], v[120:121] op_sel_hi:[1,1,0] neg_lo:[0,0,1] neg_hi:[0,0,1]
    v_pk_fma_f32 v[150:151], v[150:151], s[44:45], v[120:121] op_sel_hi:[1,1,0] neg_lo:[0,0,1] neg_hi:[0,0,1]
    v_pk_fma_f32 v[152:153], v[152:153], s[44:45], v[120:121] op_sel_hi:[1,1,0] neg_lo:[0,0,1] neg_hi:[0,0,1]
    v_pk_fma_f32 v[154:155], v[154:155], s[44:45], v[120:121] op_sel_hi:[1,1,0] neg_lo:[0,0,1] neg_hi:[0,0,1]
    v_pk_fma_f32 v[156:157], v[156:157], s[44:45], v[120:121] op_sel_hi:[1,1,0] neg_lo:[0,0,1] neg_hi:[0,0,1]
    v_pk_fma_f32 v[158:159], v[158:159], s[44:45], v[120:121] op_sel_hi:[1,1,0] neg_lo:[0,0,1] neg_hi:[0,0,1]
    v_pk_fma_f32 v[160:161], v[160:161], s[44:45], v[120:121] op_sel_hi:[1,1,0] neg_lo:[0,0,1] neg_hi:[0,0,1]
    v_pk_fma_f32 v[162:163], v[162:163], s[44:45], v[120:121] op_sel_hi:[1,1,0] neg_lo:[0,0,1] neg_hi:[0,0,1]
    v_mfma_f32_16x16x32_bf16 v[136:139], a[252:255], v[212:215], v[136:139]
    v_exp_f32 v144, v144
    v_exp_f32 v145, v145
    v_mfma_f32_16x16x32_bf16 v[140:143], a[160:163], v[212:215], v[140:143]
    v_exp_f32 v146, v146
    v_mfma_f32_16x16x32_bf16 v[124:127], a[164:167], v[216:219], v[124:127]
    v_exp_f32 v147, v147
    v_exp_f32 v148, v148
    v_mfma_f32_16x16x32_bf16 v[128:131], a[168:171], v[216:219], v[128:131]
    v_exp_f32 v149, v149
    v_exp_f32 v150, v150
    v_mfma_f32_16x16x32_bf16 v[132:135], a[172:175], v[216:219], v[132:135]
    v_exp_f32 v151, v151
    v_mfma_f32_16x16x32_bf16 v[136:139], a[176:179], v[216:219], v[136:139]
    v_exp_f32 v152, v152
    v_exp_f32 v153, v153
    v_mfma_f32_16x16x32_bf16 v[140:143], a[180:183], v[216:219], v[140:143]
    v_exp_f32 v154, v154
    v_exp_f32 v155, v155
    v_mfma_f32_16x16x32_bf16 v[124:127], a[184:187], v[220:223], v[124:127]
    v_exp_f32 v156, v156
    v_mfma_f32_16x16x32_bf16 v[128:131], a[188:191], v[220:223], v[128:131]
    v_exp_f32 v157, v157
    v_exp_f32 v158, v158
    v_mfma_f32_16x16x32_bf16 v[132:135], a[192:195], v[220:223], v[132:135]
    v_exp_f32 v159, v159
    v_exp_f32 v160, v160
    v_mfma_f32_16x16x32_bf16 v[136:139], a[196:199], v[220:223], v[136:139]
    v_exp_f32 v161, v161
    v_mfma_f32_16x16x32_bf16 v[140:143], a[200:203], v[220:223], v[140:143]
    v_exp_f32 v162, v162
    v_exp_f32 v163, v163
    s_mul_i32 s93, s39, 20480
    v_pk_add_f32 v[120:121], v[144:145], v[146:147]
    v_pk_add_f32 v[120:121], v[120:121], v[148:149]
    v_pk_add_f32 v[120:121], v[120:121], v[150:151]
    v_pk_add_f32 v[120:121], v[120:121], v[152:153]
    v_pk_add_f32 v[120:121], v[120:121], v[154:155]
    v_pk_add_f32 v[120:121], v[120:121], v[156:157]
    v_pk_add_f32 v[120:121], v[120:121], v[158:159]
    v_pk_add_f32 v[120:121], v[120:121], v[160:161]
    v_pk_add_f32 v[120:121], v[120:121], v[162:163]
    v_add_f32 v120, v120, v121
    v_mov_b32 v122, v120
    s_add_u32 s93, s93, 81920
    s_add_u32 s39, s33, 1
    v_permlane32_swap_b32 v120, v122
    v_add_f32 v120, v120, v122
    v_mov_b32 v122, v120
    s_and_b32 s39, s39, 3
    s_lshl_b32 s89, s39, 15
    v_permlane16_swap_b32 v120, v122
    v_add_f32 v120, v120, v122
    v_rcp_f32 v120, v120
    s_lshl_b32 s97, s39, 6
    v_pk_mul_f32 v[144:145], v[144:145], v[120:121] op_sel_hi:[1,0]
    v_pk_mul_f32 v[146:147], v[146:147], v[120:121] op_sel_hi:[1,0]
    v_pk_mul_f32 v[148:149], v[148:149], v[120:121] op_sel_hi:[1,0]
    v_pk_mul_f32 v[150:151], v[150:151], v[120:121] op_sel_hi:[1,0]
    v_pk_mul_f32 v[152:153], v[152:153], v[120:121] op_sel_hi:[1,0]
    v_pk_mul_f32 v[154:155], v[154:155], v[120:121] op_sel_hi:[1,0]
    v_pk_mul_f32 v[156:157], v[156:157], v[120:121] op_sel_hi:[1,0]
    v_pk_mul_f32 v[158:159], v[158:159], v[120:121] op_sel_hi:[1,0]
    v_pk_mul_f32 v[160:161], v[160:161], v[120:121] op_sel_hi:[1,0]
    v_pk_mul_f32 v[162:163], v[162:163], v[120:121] op_sel_hi:[1,0]
    v_cvt_pk_bf16_f32 v192, v144, v145
    v_cvt_pk_bf16_f32 v193, v146, v147
    v_cvt_pk_bf16_f32 v194, v148, v149
    v_cvt_pk_bf16_f32 v195, v150, v151
    v_cvt_pk_bf16_f32 v196, v152, v153
    v_cvt_pk_bf16_f32 v197, v154, v155
    v_cvt_pk_bf16_f32 v198, v156, v157
    v_cvt_pk_bf16_f32 v199, v158, v159
    v_cvt_pk_bf16_f32 v200, v160, v161
    v_cvt_pk_bf16_f32 v201, v162, v163
    v_mfma_f32_16x16x32_bf16 v[144:147], a[220:223], v[224:227], 0
    v_max3_f32 v120, v124, v125, v126
    v_max3_f32 v122, v127, v128, v129
    v_mfma_f32_16x16x32_bf16 v[148:151], a[224:227], v[224:227], 0
    v_max3_f32 v122, v122, v130, v131
    v_max3_f32 v120, v120, v132, v133
    v_max3_f32 v122, v122, v134, v135
    v_mfma_f32_16x16x32_bf16 v[152:155], a[228:231], v[224:227], 0
    v_max3_f32 v120, v120, v136, v137
    v_max3_f32 v122, v122, v138, v139
    v_mfma_f32_16x16x32_bf16 v[156:159], a[232:235], v[224:227], 0
    v_max3_f32 v120, v120, v140, v141
    v_max3_f32 v122, v122, v142, v143
    v_max_f32 v120, v120, v122
    v_mfma_f32_16x16x32_bf16 v[160:163], a[236:239], v[224:227], 0
    v_mov_b32 v122, v120
    s_bfe_u32 s39, s38, 0x20002
    s_add_u32 s39, s32, s39
    v_mfma_f32_16x16x32_bf16 v[144:147], a[240:243], v[228:231], v[144:147]
    v_permlane32_swap_b32 v120, v122
    v_max_f32 v120, v120, v122
    v_mfma_f32_16x16x32_bf16 v[148:151], a[244:247], v[228:231], v[148:151]
    v_mov_b32 v122, v120
    s_and_b32 s39, s39, 3
    s_lshl_b32 s86, s39, 17
    v_permlane16_swap_b32 v120, v122
    v_mfma_f32_16x16x32_bf16 v[152:155], a[248:251], v[228:231], v[152:155]
    v_max_f32 v120, v120, v122
    v_mul_f32 v120, s45, v120
    v_pk_fma_f32 v[124:125], v[124:125], s[44:45], v[120:121] op_sel_hi:[1,1,0] neg_lo:[0,0,1] neg_hi:[0,0,1]
    v_pk_fma_f32 v[126:127], v[126:127], s[44:45], v[120:121] op_sel_hi:[1,1,0] neg_lo:[0,0,1] neg_hi:[0,0,1]
    v_pk_fma_f32 v[128:129], v[128:129], s[44:45], v[120:121] op_sel_hi:[1,1,0] neg_lo:[0,0,1] neg_hi:[0,0,1]
    v_pk_fma_f32 v[130:131], v[130:131], s[44:45], v[120:121] op_sel_hi:[1,1,0] neg_lo:[0,0,1] neg_hi:[0,0,1]
    v_pk_fma_f32 v[132:133], v[132:133], s[44:45], v[120:121] op_sel_hi:[1,1,0] neg_lo:[0,0,1] neg_hi:[0,0,1]
    v_pk_fma_f32 v[134:135], v[134:135], s[44:45], v[120:121] op_sel_hi:[1,1,0] neg_lo:[0,0,1] neg_hi:[0,0,1]
    v_pk_fma_f32 v[136:137], v[136:137], s[44:45], v[120:121] op_sel_hi:[1,1,0] neg_lo:[0,0,1] neg_hi:[0,0,1]
    v_pk_fma_f32 v[138:139], v[138:139], s[44:45], v[120:121] op_sel_hi:[1,1,0] neg_lo:[0,0,1] neg_hi:[0,0,1]
    v_pk_fma_f32 v[140:141], v[140:141], s[44:45], v[120:121] op_sel_hi:[1,1,0] neg_lo:[0,0,1] neg_hi:[0,0,1]
    v_pk_fma_f32 v[142:143], v[142:143], s[44:45], v[120:121] op_sel_hi:[1,1,0] neg_lo:[0,0,1] neg_hi:[0,0,1]
    v_mfma_f32_16x16x32_bf16 v[156:159], a[252:255], v[228:231], v[156:159]
    v_exp_f32 v124, v124
    v_exp_f32 v125, v125
    v_mfma_f32_16x16x32_bf16 v[160:163], a[160:163], v[228:231], v[160:163]
    v_exp_f32 v126, v126
    v_mfma_f32_16x16x32_bf16 v[144:147], a[164:167], v[232:235], v[144:147]
    v_exp_f32 v127, v127
    v_exp_f32 v128, v128
    v_mfma_f32_16x16x32_bf16 v[148:151], a[168:171], v[232:235], v[148:151]
    v_exp_f32 v129, v129
    v_exp_f32 v130, v130
    v_mfma_f32_16x16x32_bf16 v[152:155], a[172:175], v[232:235], v[152:155]
    v_exp_f32 v131, v131
    v_mfma_f32_16x16x32_bf16 v[156:159], a[176:179], v[232:235], v[156:159]
    v_exp_f32 v132, v132
    v_exp_f32 v133, v133
    v_mfma_f32_16x16x32_bf16 v[160:163], a[180:183], v[232:235], v[160:163]
    v_exp_f32 v134, v134
    v_exp_f32 v135, v135
    v_mfma_f32_16x16x32_bf16 v[144:147], a[184:187], v[236:239], v[144:147]
    v_exp_f32 v136, v136
    v_mfma_f32_16x16x32_bf16 v[148:151], a[188:191], v[236:239], v[148:151]
    v_exp_f32 v137, v137
    v_exp_f32 v138, v138
    v_mfma_f32_16x16x32_bf16 v[152:155], a[192:195], v[236:239], v[152:155]
    v_exp_f32 v139, v139
    v_exp_f32 v140, v140
    v_mfma_f32_16x16x32_bf16 v[156:159], a[196:199], v[236:239], v[156:159]
    v_exp_f32 v141, v141
    v_mfma_f32_16x16x32_bf16 v[160:163], a[200:203], v[236:239], v[160:163]
    v_exp_f32 v142, v142
    v_exp_f32 v143, v143
    s_mul_i32 s94, s39, 20480
    v_pk_add_f32 v[120:121], v[124:125], v[126:127]
    v_pk_add_f32 v[120:121], v[120:121], v[128:129]
    v_pk_add_f32 v[120:121], v[120:121], v[130:131]
    v_pk_add_f32 v[120:121], v[120:121], v[132:133]
    v_pk_add_f32 v[120:121], v[120:121], v[134:135]
    v_pk_add_f32 v[120:121], v[120:121], v[136:137]
    v_pk_add_f32 v[120:121], v[120:121], v[138:139]
    v_pk_add_f32 v[120:121], v[120:121], v[140:141]
    v_pk_add_f32 v[120:121], v[120:121], v[142:143]
    v_add_f32 v120, v120, v121
    v_mov_b32 v122, v120
    s_add_u32 s94, s94, 81920
    s_add_u32 s39, s33, 2
    v_permlane32_swap_b32 v120, v122
    v_add_f32 v120, v120, v122
    v_mov_b32 v122, v120
    s_and_b32 s39, s39, 3
    s_lshl_b32 s90, s39, 15
    v_permlane16_swap_b32 v120, v122
    v_add_f32 v120, v120, v122
    v_rcp_f32 v120, v120
    s_lshl_b32 s98, s39, 6
    v_pk_mul_f32 v[124:125], v[124:125], v[120:121] op_sel_hi:[1,0]
    v_pk_mul_f32 v[126:127], v[126:127], v[120:121] op_sel_hi:[1,0]
    v_pk_mul_f32 v[128:129], v[128:129], v[120:121] op_sel_hi:[1,0]
    v_pk_mul_f32 v[130:131], v[130:131], v[120:121] op_sel_hi:[1,0]
    v_pk_mul_f32 v[132:133], v[132:133], v[120:121] op_sel_hi:[1,0]
    v_pk_mul_f32 v[134:135], v[134:135], v[120:121] op_sel_hi:[1,0]
    v_pk_mul_f32 v[136:137], v[136:137], v[120:121] op_sel_hi:[1,0]
    v_pk_mul_f32 v[138:139], v[138:139], v[120:121] op_sel_hi:[1,0]
    v_pk_mul_f32 v[140:141], v[140:141], v[120:121] op_sel_hi:[1,0]
    v_pk_mul_f32 v[142:143], v[142:143], v[120:121] op_sel_hi:[1,0]
    v_cvt_pk_bf16_f32 v208, v124, v125
    v_cvt_pk_bf16_f32 v209, v126, v127
    v_cvt_pk_bf16_f32 v210, v128, v129
    v_cvt_pk_bf16_f32 v211, v130, v131
    v_cvt_pk_bf16_f32 v212, v132, v133
    v_cvt_pk_bf16_f32 v213, v134, v135
    v_cvt_pk_bf16_f32 v214, v136, v137
    v_cvt_pk_bf16_f32 v215, v138, v139
    v_cvt_pk_bf16_f32 v216, v140, v141
    v_cvt_pk_bf16_f32 v217, v142, v143
    v_mfma_f32_16x16x32_bf16 v[124:127], a[220:223], v[240:243], 0
    v_max3_f32 v120, v144, v145, v146
    v_max3_f32 v122, v147, v148, v149
    v_mfma_f32_16x16x32_bf16 v[128:131], a[224:227], v[240:243], 0
    v_max3_f32 v122, v122, v150, v151
    v_max3_f32 v120, v120, v152, v153
    v_max3_f32 v122, v122, v154, v155
    v_mfma_f32_16x16x32_bf16 v[132:135], a[228:231], v[240:243], 0
    v_max3_f32 v120, v120, v156, v157
    v_max3_f32 v122, v122, v158, v159
    v_mfma_f32_16x16x32_bf16 v[136:139], a[232:235], v[240:243], 0
    v_max3_f32 v120, v120, v160, v161
    v_max3_f32 v122, v122, v162, v163
    v_max_f32 v120, v120, v122
    v_mfma_f32_16x16x32_bf16 v[140:143], a[236:239], v[240:243], 0
    v_mov_b32 v122, v120
    s_bfe_u32 s39, s38, 0x20004
    s_add_u32 s39, s32, s39
    v_mfma_f32_16x16x32_bf16 v[124:127], a[240:243], v[244:247], v[124:127]
    v_permlane32_swap_b32 v120, v122
    v_max_f32 v120, v120, v122
    v_mfma_f32_16x16x32_bf16 v[128:131], a[244:247], v[244:247], v[128:131]
    v_mov_b32 v122, v120
    s_and_b32 s39, s39, 3
    s_lshl_b32 s87, s39, 17
    v_permlane16_swap_b32 v120, v122
    v_mfma_f32_16x16x32_bf16 v[132:135], a[248:251], v[244:247], v[132:135]
    v_max_f32 v120, v120, v122
    v_mul_f32 v120, s45, v120
    v_pk_fma_f32 v[144:145], v[144:145], s[44:45], v[120:121] op_sel_hi:[1,1,0] neg_lo:[0,0,1] neg_hi:[0,0,1]
    v_pk_fma_f32 v[146:147], v[146:147], s[44:45], v[120:121] op_sel_hi:[1,1,0] neg_lo:[0,0,1] neg_hi:[0,0,1]
    v_pk_fma_f32 v[148:149], v[148:149], s[44:45], v[120:121] op_sel_hi:[1,1,0] neg_lo:[0,0,1] neg_hi:[0,0,1]
    v_pk_fma_f32 v[150:151], v[150:151], s[44:45], v[120:121] op_sel_hi:[1,1,0] neg_lo:[0,0,1] neg_hi:[0,0,1]
    v_pk_fma_f32 v[152:153], v[152:153], s[44:45], v[120:121] op_sel_hi:[1,1,0] neg_lo:[0,0,1] neg_hi:[0,0,1]
    v_pk_fma_f32 v[154:155], v[154:155], s[44:45], v[120:121] op_sel_hi:[1,1,0] neg_lo:[0,0,1] neg_hi:[0,0,1]
    v_pk_fma_f32 v[156:157], v[156:157], s[44:45], v[120:121] op_sel_hi:[1,1,0] neg_lo:[0,0,1] neg_hi:[0,0,1]
    v_pk_fma_f32 v[158:159], v[158:159], s[44:45], v[120:121] op_sel_hi:[1,1,0] neg_lo:[0,0,1] neg_hi:[0,0,1]
    v_pk_fma_f32 v[160:161], v[160:161], s[44:45], v[120:121] op_sel_hi:[1,1,0] neg_lo:[0,0,1] neg_hi:[0,0,1]
    v_pk_fma_f32 v[162:163], v[162:163], s[44:45], v[120:121] op_sel_hi:[1,1,0] neg_lo:[0,0,1] neg_hi:[0,0,1]
    v_mfma_f32_16x16x32_bf16 v[136:139], a[252:255], v[244:247], v[136:139]
    v_exp_f32 v144, v144
    v_exp_f32 v145, v145
    v_mfma_f32_16x16x32_bf16 v[140:143], a[160:163], v[244:247], v[140:143]
    v_exp_f32 v146, v146
    v_mfma_f32_16x16x32_bf16 v[124:127], a[164:167], v[248:251], v[124:127]
    v_exp_f32 v147, v147
    v_exp_f32 v148, v148
    v_mfma_f32_16x16x32_bf16 v[128:131], a[168:171], v[248:251], v[128:131]
    v_exp_f32 v149, v149
    v_exp_f32 v150, v150
    v_mfma_f32_16x16x32_bf16 v[132:135], a[172:175], v[248:251], v[132:135]
    v_exp_f32 v151, v151
    v_mfma_f32_16x16x32_bf16 v[136:139], a[176:179], v[248:251], v[136:139]
    v_exp_f32 v152, v152
    v_exp_f32 v153, v153
    v_mfma_f32_16x16x32_bf16 v[140:143], a[180:183], v[248:251], v[140:143]
    v_exp_f32 v154, v154
    v_exp_f32 v155, v155
    v_mfma_f32_16x16x32_bf16 v[124:127], a[184:187], v[252:255], v[124:127]
    v_exp_f32 v156, v156
    v_mfma_f32_16x16x32_bf16 v[128:131], a[188:191], v[252:255], v[128:131]
    v_exp_f32 v157, v157
    v_exp_f32 v158, v158
    v_mfma_f32_16x16x32_bf16 v[132:135], a[192:195], v[252:255], v[132:135]
    v_exp_f32 v159, v159
    v_exp_f32 v160, v160
    v_mfma_f32_16x16x32_bf16 v[136:139], a[196:199], v[252:255], v[136:139]
    v_exp_f32 v161, v161
    v_mfma_f32_16x16x32_bf16 v[140:143], a[200:203], v[252:255], v[140:143]
    v_exp_f32 v162, v162
    v_exp_f32 v163, v163
    s_mul_i32 s95, s39, 20480
    v_pk_add_f32 v[120:121], v[144:145], v[146:147]
    v_pk_add_f32 v[120:121], v[120:121], v[148:149]
    v_pk_add_f32 v[120:121], v[120:121], v[150:151]
    v_pk_add_f32 v[120:121], v[120:121], v[152:153]
    v_pk_add_f32 v[120:121], v[120:121], v[154:155]
    v_pk_add_f32 v[120:121], v[120:121], v[156:157]
    v_pk_add_f32 v[120:121], v[120:121], v[158:159]
    v_pk_add_f32 v[120:121], v[120:121], v[160:161]
    v_pk_add_f32 v[120:121], v[120:121], v[162:163]
    v_add_f32 v120, v120, v121
    v_mov_b32 v122, v120
    s_add_u32 s95, s95, 81920
    s_add_u32 s39, s33, 3
    v_permlane32_swap_b32 v120, v122
    v_add_f32 v120, v120, v122
    v_mov_b32 v122, v120
    s_and_b32 s39, s39, 3
    s_lshl_b32 s91, s39, 15
    v_permlane16_swap_b32 v120, v122
    v_add_f32 v120, v120, v122
    v_rcp_f32 v120, v120
    s_lshl_b32 s99, s39, 6
    v_pk_mul_f32 v[144:145], v[144:145], v[120:121] op_sel_hi:[1,0]
    v_pk_mul_f32 v[146:147], v[146:147], v[120:121] op_sel_hi:[1,0]
    v_pk_mul_f32 v[148:149], v[148:149], v[120:121] op_sel_hi:[1,0]
    v_pk_mul_f32 v[150:151], v[150:151], v[120:121] op_sel_hi:[1,0]
    v_pk_mul_f32 v[152:153], v[152:153], v[120:121] op_sel_hi:[1,0]
    v_pk_mul_f32 v[154:155], v[154:155], v[120:121] op_sel_hi:[1,0]
    v_pk_mul_f32 v[156:157], v[156:157], v[120:121] op_sel_hi:[1,0]
    v_pk_mul_f32 v[158:159], v[158:159], v[120:121] op_sel_hi:[1,0]
    v_pk_mul_f32 v[160:161], v[160:161], v[120:121] op_sel_hi:[1,0]
    v_pk_mul_f32 v[162:163], v[162:163], v[120:121] op_sel_hi:[1,0]
    v_cvt_pk_bf16_f32 v224, v144, v145
    v_cvt_pk_bf16_f32 v225, v146, v147
    v_cvt_pk_bf16_f32 v226, v148, v149
    v_cvt_pk_bf16_f32 v227, v150, v151
    v_cvt_pk_bf16_f32 v228, v152, v153
    v_cvt_pk_bf16_f32 v229, v154, v155
    v_cvt_pk_bf16_f32 v230, v156, v157
    v_cvt_pk_bf16_f32 v231, v158, v159
    v_cvt_pk_bf16_f32 v232, v160, v161
    v_cvt_pk_bf16_f32 v233, v162, v163
    v_max3_f32 v120, v124, v125, v126
    v_max3_f32 v122, v127, v128, v129
    v_max3_f32 v122, v122, v130, v131
    v_max3_f32 v120, v120, v132, v133
    v_max3_f32 v122, v122, v134, v135
    v_max3_f32 v120, v120, v136, v137
    v_max3_f32 v122, v122, v138, v139
    v_max3_f32 v120, v120, v140, v141
    v_max3_f32 v122, v122, v142, v143
    v_max_f32 v120, v120, v122
    v_mov_b32 v122, v120
    v_lshrrev_b32 v16, 2, v1
    v_and_b32 v22, 7, v16
    v_permlane32_swap_b32 v120, v122
    v_max_f32 v120, v120, v122
    v_mov_b32 v122, v120
    v_lshlrev_b32 v22, 1, v22
    v_bfe_u32 v15, v1, 1, 1
    v_permlane16_swap_b32 v120, v122
    v_max_f32 v120, v120, v122
    v_mul_f32 v120, s45, v120
    v_pk_fma_f32 v[124:125], v[124:125], s[44:45], v[120:121] op_sel_hi:[1,1,0] neg_lo:[0,0,1] neg_hi:[0,0,1]
    v_pk_fma_f32 v[126:127], v[126:127], s[44:45], v[120:121] op_sel_hi:[1,1,0] neg_lo:[0,0,1] neg_hi:[0,0,1]
    v_pk_fma_f32 v[128:129], v[128:129], s[44:45], v[120:121] op_sel_hi:[1,1,0] neg_lo:[0,0,1] neg_hi:[0,0,1]
    v_pk_fma_f32 v[130:131], v[130:131], s[44:45], v[120:121] op_sel_hi:[1,1,0] neg_lo:[0,0,1] neg_hi:[0,0,1]
    v_pk_fma_f32 v[132:133], v[132:133], s[44:45], v[120:121] op_sel_hi:[1,1,0] neg_lo:[0,0,1] neg_hi:[0,0,1]
    v_pk_fma_f32 v[134:135], v[134:135], s[44:45], v[120:121] op_sel_hi:[1,1,0] neg_lo:[0,0,1] neg_hi:[0,0,1]
    v_pk_fma_f32 v[136:137], v[136:137], s[44:45], v[120:121] op_sel_hi:[1,1,0] neg_lo:[0,0,1] neg_hi:[0,0,1]
    v_pk_fma_f32 v[138:139], v[138:139], s[44:45], v[120:121] op_sel_hi:[1,1,0] neg_lo:[0,0,1] neg_hi:[0,0,1]
    v_pk_fma_f32 v[140:141], v[140:141], s[44:45], v[120:121] op_sel_hi:[1,1,0] neg_lo:[0,0,1] neg_hi:[0,0,1]
    v_pk_fma_f32 v[142:143], v[142:143], s[44:45], v[120:121] op_sel_hi:[1,1,0] neg_lo:[0,0,1] neg_hi:[0,0,1]
    v_exp_f32 v124, v124
    v_exp_f32 v125, v125
    v_exp_f32 v126, v126
    v_exp_f32 v127, v127
    v_exp_f32 v128, v128
    v_exp_f32 v129, v129
    v_exp_f32 v130, v130
    v_exp_f32 v131, v131
    v_exp_f32 v132, v132
    v_exp_f32 v133, v133
    v_exp_f32 v134, v134
    v_exp_f32 v135, v135
    v_exp_f32 v136, v136
    v_exp_f32 v137, v137
    v_exp_f32 v138, v138
    v_exp_f32 v139, v139
    v_exp_f32 v140, v140
    v_exp_f32 v141, v141
    v_exp_f32 v142, v142
    v_exp_f32 v143, v143
    v_xor_b32 v22, v22, v15
    v_pk_add_f32 v[120:121], v[124:125], v[126:127]
    v_pk_add_f32 v[120:121], v[120:121], v[128:129]
    v_pk_add_f32 v[120:121], v[120:121], v[130:131]
    v_pk_add_f32 v[120:121], v[120:121], v[132:133]
    v_pk_add_f32 v[120:121], v[120:121], v[134:135]
    v_pk_add_f32 v[120:121], v[120:121], v[136:137]
    v_pk_add_f32 v[120:121], v[120:121], v[138:139]
    v_pk_add_f32 v[120:121], v[120:121], v[140:141]
    v_pk_add_f32 v[120:121], v[120:121], v[142:143]
    v_add_f32 v120, v120, v121
    v_lshlrev_b32 v22, 4, v22
    v_lshl_add_u32 v22, v16, 8, v22
    v_and_b32 v15, 1, v1
    v_lshl_add_u32 v22, v15, 3, v22
    v_add_u32 v16, s3, v22
    v_add_u32 v21, 0x10000, v16
    v_add_u32 v17, s47, v14
    v_xor_b32 v18, 64, v17
    v_xor_b32 v19, 128, v17
    v_xor_b32 v20, 192, v17
    s_waitcnt vmcnt(0)
    v_xor_b32 v22, 0, v16
    v_xor_b32 v23, 0, v21
    ds_read_b64_tr_b16 a[0:1], v22
    ds_read_b64_tr_b16 a[2:3], v22 offset:16384
    ds_read_b64_tr_b16 a[4:5], v22 offset:32768
    ds_read_b64_tr_b16 a[6:7], v22 offset:49152
    ds_read_b64_tr_b16 a[8:9], v23
    v_xor_b32 v15, 32, v16
    v_xor_b32 v0, 32, v21
    ds_read_b64_tr_b16 a[10:11], v15
    ds_read_b64_tr_b16 a[12:13], v15 offset:16384
    ds_read_b64_tr_b16 a[14:15], v15 offset:32768
    ds_read_b64_tr_b16 a[16:17], v15 offset:49152
    ds_read_b64_tr_b16 a[18:19], v0
    v_mov_b32 v122, v120
    s_nop 1
    v_permlane32_swap_b32 v120, v122
    v_add_f32 v120, v120, v122
    v_mov_b32 v122, v120
    s_nop 1
    v_permlane16_swap_b32 v120, v122
    v_add_f32 v120, v120, v122
    v_rcp_f32 v120, v120
    s_nop 0
    v_pk_mul_f32 v[124:125], v[124:125], v[120:121] op_sel_hi:[1,0]
    v_pk_mul_f32 v[126:127], v[126:127], v[120:121] op_sel_hi:[1,0]
    v_pk_mul_f32 v[128:129], v[128:129], v[120:121] op_sel_hi:[1,0]
    v_pk_mul_f32 v[130:131], v[130:131], v[120:121] op_sel_hi:[1,0]
    v_pk_mul_f32 v[132:133], v[132:133], v[120:121] op_sel_hi:[1,0]
    v_pk_mul_f32 v[134:135], v[134:135], v[120:121] op_sel_hi:[1,0]
    v_pk_mul_f32 v[136:137], v[136:137], v[120:121] op_sel_hi:[1,0]
    v_pk_mul_f32 v[138:139], v[138:139], v[120:121] op_sel_hi:[1,0]
    v_pk_mul_f32 v[140:141], v[140:141], v[120:121] op_sel_hi:[1,0]
    v_pk_mul_f32 v[142:143], v[142:143], v[120:121] op_sel_hi:[1,0]
    v_cvt_pk_bf16_f32 v240, v124, v125
    v_cvt_pk_bf16_f32 v241, v126, v127
    v_cvt_pk_bf16_f32 v242, v128, v129
    v_cvt_pk_bf16_f32 v243, v130, v131
    v_cvt_pk_bf16_f32 v244, v132, v133
    v_cvt_pk_bf16_f32 v245, v134, v135
    v_cvt_pk_bf16_f32 v246, v136, v137
    v_cvt_pk_bf16_f32 v247, v138, v139
    v_cvt_pk_bf16_f32 v248, v140, v141
    v_cvt_pk_bf16_f32 v249, v142, v143
    s_add_u32 s37, s84, s88
    buffer_load_dwordx4 v[24:27], v12, s[28:31], s37 offen
    s_nop 1
    s_waitcnt lgkmcnt(0)
    v_mfma_f32_16x16x32_bf16 v[120:123], a[0:3], v[176:179], 0
    v_xor_b32 v22, 64, v16
    v_mfma_f32_16x16x32_bf16 v[124:127], a[10:13], v[176:179], 0
    v_xor_b32 v23, 64, v21
    v_mfma_f32_16x16x32_bf16 v[120:123], a[4:7], v[180:183], v[120:123]
    ds_read_b64_tr_b16 a[20:21], v22
    ds_read_b64_tr_b16 a[22:23], v22 offset:16384
    v_mfma_f32_16x16x32_bf16 v[124:127], a[14:17], v[180:183], v[124:127]
    ds_read_b64_tr_b16 a[24:25], v22 offset:32768
    v_mfma_f32_16x16x16_bf16 v[120:123], a[8:9], v[184:185], v[120:123]
    buffer_load_dwordx4 v[28:31], v12, s[28:31], s37 offen offset:1024
    ds_read_b64_tr_b16 a[26:27], v22 offset:49152
    v_mfma_f32_16x16x16_bf16 v[124:127], a[18:19], v[184:185], v[124:127]
    ds_read_b64_tr_b16 a[28:29], v23
    v_mfma_f32_16x16x32_bf16 v[128:131], a[0:3], v[192:195], 0
    v_xor_b32 v15, 96, v16
    v_mfma_f32_16x16x32_bf16 v[132:135], a[10:13], v[192:195], 0
    v_xor_b32 v0, 96, v21
    v_mfma_f32_16x16x32_bf16 v[128:131], a[4:7], v[196:199], v[128:131]
    ds_read_b64_tr_b16 a[30:31], v15
    ds_read_b64_tr_b16 a[32:33], v15 offset:16384
    v_mfma_f32_16x16x32_bf16 v[132:135], a[14:17], v[196:199], v[132:135]
    ds_read_b64_tr_b16 a[34:35], v15 offset:32768
    buffer_load_dwordx4 v[32:35], v12, s[28:31], s37 offen offset:2048
    v_mfma_f32_16x16x16_bf16 v[128:131], a[8:9], v[200:201], v[128:131]
    ds_read_b64_tr_b16 a[36:37], v15 offset:49152
    v_mfma_f32_16x16x16_bf16 v[132:135], a[18:19], v[200:201], v[132:135]
    ds_read_b64_tr_b16 a[38:39], v0
    v_mfma_f32_16x16x32_bf16 v[136:139], a[0:3], v[208:211], 0
    v_cvt_pk_bf16_f32 v152, v120, v121
    v_mfma_f32_16x16x32_bf16 v[140:143], a[10:13], v[208:211], 0
    v_cvt_pk_bf16_f32 v153, v122, v123
    v_mfma_f32_16x16x32_bf16 v[136:139], a[4:7], v[212:215], v[136:139]
    v_mfma_f32_16x16x32_bf16 v[140:143], a[14:17], v[212:215], v[140:143]
    v_cvt_pk_bf16_f32 v154, v124, v125
    v_mfma_f32_16x16x16_bf16 v[136:139], a[8:9], v[216:217], v[136:139]
    buffer_load_dwordx4 v[36:39], v12, s[28:31], s37 offen offset:3072
    v_cvt_pk_bf16_f32 v155, v126, v127
    v_mfma_f32_16x16x16_bf16 v[140:143], a[18:19], v[216:217], v[140:143]
    ds_write_b128 v17, v[152:155]
    v_mfma_f32_16x16x32_bf16 v[144:147], a[0:3], v[224:227], 0
    v_cvt_pk_bf16_f32 v156, v128, v129
    v_mfma_f32_16x16x32_bf16 v[148:151], a[10:13], v[224:227], 0
    v_cvt_pk_bf16_f32 v157, v130, v131
    v_mfma_f32_16x16x32_bf16 v[144:147], a[4:7], v[228:231], v[144:147]
    v_mfma_f32_16x16x32_bf16 v[148:151], a[14:17], v[228:231], v[148:151]
    v_cvt_pk_bf16_f32 v158, v132, v133
    v_mfma_f32_16x16x16_bf16 v[144:147], a[8:9], v[232:233], v[144:147]
    buffer_load_dwordx4 v[40:43], v13, s[28:31], s37 offen
    v_cvt_pk_bf16_f32 v159, v134, v135
    v_mfma_f32_16x16x16_bf16 v[148:151], a[18:19], v[232:233], v[148:151]
    ds_write_b128 v17, v[156:159] offset:4096
    v_mfma_f32_16x16x32_bf16 v[120:123], a[0:3], v[240:243], 0
    v_cvt_pk_bf16_f32 v160, v136, v137
    v_mfma_f32_16x16x32_bf16 v[124:127], a[10:13], v[240:243], 0
    v_cvt_pk_bf16_f32 v161, v138, v139
    v_mfma_f32_16x16x32_bf16 v[120:123], a[4:7], v[244:247], v[120:123]
    v_mfma_f32_16x16x32_bf16 v[124:127], a[14:17], v[244:247], v[124:127]
    v_cvt_pk_bf16_f32 v162, v140, v141
    v_mfma_f32_16x16x16_bf16 v[120:123], a[8:9], v[248:249], v[120:123]
    v_cvt_pk_bf16_f32 v163, v142, v143
    buffer_load_dwordx4 v[44:47], v13, s[28:31], s37 offen offset:1024
    v_mfma_f32_16x16x16_bf16 v[124:127], a[18:19], v[248:249], v[124:127]
    ds_write_b128 v17, v[160:163] offset:8192
    s_waitcnt lgkmcnt(3)
    v_mfma_f32_16x16x32_bf16 v[128:131], a[20:23], v[176:179], 0
    v_cvt_pk_bf16_f32 v164, v144, v145
    v_cvt_pk_bf16_f32 v165, v146, v147
    v_mfma_f32_16x16x32_bf16 v[132:135], a[30:33], v[176:179], 0
    v_cvt_pk_bf16_f32 v166, v148, v149
    v_cvt_pk_bf16_f32 v167, v150, v151
    v_mfma_f32_16x16x32_bf16 v[128:131], a[24:27], v[180:183], v[128:131]
    ds_write_b128 v17, v[164:167] offset:12288
    v_xor_b32 v22, 128, v16
    buffer_load_dwordx4 v[48:51], v13, s[28:31], s37 offen offset:2048
    v_mfma_f32_16x16x32_bf16 v[132:135], a[34:37], v[180:183], v[132:135]
    v_xor_b32 v23, 128, v21
    ds_read_b64_tr_b16 a[40:41], v22
    v_mfma_f32_16x16x16_bf16 v[128:131], a[28:29], v[184:185], v[128:131]
    ds_read_b64_tr_b16 a[42:43], v22 offset:16384
    ds_read_b64_tr_b16 a[44:45], v22 offset:32768
    v_mfma_f32_16x16x16_bf16 v[132:135], a[38:39], v[184:185], v[132:135]
    ds_read_b64_tr_b16 a[46:47], v22 offset:49152
    ds_read_b64_tr_b16 a[48:49], v23
    v_mfma_f32_16x16x32_bf16 v[136:139], a[20:23], v[192:195], 0
    v_cvt_pk_bf16_f32 v168, v120, v121
    v_cvt_pk_bf16_f32 v169, v122, v123
    buffer_load_dwordx4 v[52:55], v13, s[28:31], s37 offen offset:3072
    v_mfma_f32_16x16x32_bf16 v[140:143], a[30:33], v[192:195], 0
    v_cvt_pk_bf16_f32 v170, v124, v125
    v_cvt_pk_bf16_f32 v171, v126, v127
    v_mfma_f32_16x16x32_bf16 v[136:139], a[24:27], v[196:199], v[136:139]
    ds_write_b128 v17, v[168:171] offset:16384
    v_xor_b32 v15, 160, v16
    v_mfma_f32_16x16x32_bf16 v[140:143], a[34:37], v[196:199], v[140:143]
    v_xor_b32 v0, 160, v21
    ds_read_b64_tr_b16 a[50:51], v15
    v_mfma_f32_16x16x16_bf16 v[136:139], a[28:29], v[200:201], v[136:139]
    ds_read_b64_tr_b16 a[52:53], v15 offset:16384
    s_add_u32 s37, s84, s89
    buffer_load_dwordx4 v[56:59], v12, s[28:31], s37 offen
    ds_read_b64_tr_b16 a[54:55], v15 offset:32768
    v_mfma_f32_16x16x16_bf16 v[140:143], a[38:39], v[200:201], v[140:143]
    ds_read_b64_tr_b16 a[56:57], v15 offset:49152
    ds_read_b64_tr_b16 a[58:59], v0
    v_mfma_f32_16x16x32_bf16 v[144:147], a[20:23], v[208:211], 0
    v_cvt_pk_bf16_f32 v172, v128, v129
    v_mfma_f32_16x16x32_bf16 v[148:151], a[30:33], v[208:211], 0
    v_cvt_pk_bf16_f32 v173, v130, v131
    v_mfma_f32_16x16x32_bf16 v[144:147], a[24:27], v[212:215], v[144:147]
    v_mfma_f32_16x16x32_bf16 v[148:151], a[34:37], v[212:215], v[148:151]
    v_cvt_pk_bf16_f32 v174, v132, v133
    v_mfma_f32_16x16x16_bf16 v[144:147], a[28:29], v[216:217], v[144:147]
    buffer_load_dwordx4 v[60:63], v12, s[28:31], s37 offen offset:1024
    v_cvt_pk_bf16_f32 v175, v134, v135
    v_mfma_f32_16x16x16_bf16 v[148:151], a[38:39], v[216:217], v[148:151]
    ds_write_b128 v18, v[172:175]
    v_mfma_f32_16x16x32_bf16 v[120:123], a[20:23], v[224:227], 0
    s_waitcnt lgkmcnt(15)
    v_mfma_f32_16x16x32_bf16 v[124:127], a[30:33], v[224:227], 0
    v_cvt_pk_bf16_f32 v152, v136, v137
    v_mfma_f32_16x16x32_bf16 v[120:123], a[24:27], v[228:231], v[120:123]
    v_cvt_pk_bf16_f32 v153, v138, v139
    v_mfma_f32_16x16x32_bf16 v[124:127], a[34:37], v[228:231], v[124:127]
    v_cvt_pk_bf16_f32 v154, v140, v141
    v_mfma_f32_16x16x16_bf16 v[120:123], a[28:29], v[232:233], v[120:123]
    buffer_load_dwordx4 v[64:67], v12, s[28:31], s37 offen offset:2048
    v_cvt_pk_bf16_f32 v155, v142, v143
    v_mfma_f32_16x16x16_bf16 v[124:127], a[38:39], v[232:233], v[124:127]
    ds_write_b128 v18, v[152:155] offset:4096
    v_mfma_f32_16x16x32_bf16 v[128:131], a[20:23], v[240:243], 0
    s_waitcnt lgkmcnt(15)
    v_mfma_f32_16x16x32_bf16 v[132:135], a[30:33], v[240:243], 0
    v_cvt_pk_bf16_f32 v156, v144, v145
    v_mfma_f32_16x16x32_bf16 v[128:131], a[24:27], v[244:247], v[128:131]
    v_cvt_pk_bf16_f32 v157, v146, v147
    v_mfma_f32_16x16x32_bf16 v[132:135], a[34:37], v[244:247], v[132:135]
    v_cvt_pk_bf16_f32 v158, v148, v149
    v_mfma_f32_16x16x16_bf16 v[128:131], a[28:29], v[248:249], v[128:131]
    buffer_load_dwordx4 v[68:71], v12, s[28:31], s37 offen offset:3072
    v_cvt_pk_bf16_f32 v159, v150, v151
    v_mfma_f32_16x16x16_bf16 v[132:135], a[38:39], v[248:249], v[132:135]
    ds_write_b128 v18, v[156:159] offset:8192
    s_waitcnt lgkmcnt(3)
    v_mfma_f32_16x16x32_bf16 v[136:139], a[40:43], v[176:179], 0
    v_cvt_pk_bf16_f32 v160, v120, v121
    v_mfma_f32_16x16x32_bf16 v[140:143], a[50:53], v[176:179], 0
    v_cvt_pk_bf16_f32 v161, v122, v123
    v_cvt_pk_bf16_f32 v162, v124, v125
    v_mfma_f32_16x16x32_bf16 v[136:139], a[44:47], v[180:183], v[136:139]
    buffer_load_dwordx4 v[72:75], v13, s[28:31], s37 offen
    v_cvt_pk_bf16_f32 v163, v126, v127
    ds_write_b128 v18, v[160:163] offset:12288
    v_mfma_f32_16x16x32_bf16 v[140:143], a[54:57], v[180:183], v[140:143]
    v_xor_b32 v22, 192, v16
    v_xor_b32 v23, 192, v21
    ds_read_b64_tr_b16 a[60:61], v22
    v_mfma_f32_16x16x16_bf16 v[136:139], a[48:49], v[184:185], v[136:139]
    ds_read_b64_tr_b16 a[62:63], v22 offset:16384
    ds_read_b64_tr_b16 a[64:65], v22 offset:32768
    v_mfma_f32_16x16x16_bf16 v[140:143], a[58:59], v[184:185], v[140:143]
    ds_read_b64_tr_b16 a[66:67], v22 offset:49152
    ds_read_b64_tr_b16 a[68:69], v23
    buffer_load_dwordx4 v[76:79], v13, s[28:31], s37 offen offset:1024
    v_mfma_f32_16x16x32_bf16 v[144:147], a[40:43], v[192:195], 0
    v_cvt_pk_bf16_f32 v164, v128, v129
    v_mfma_f32_16x16x32_bf16 v[148:151], a[50:53], v[192:195], 0
    v_cvt_pk_bf16_f32 v165, v130, v131
    v_cvt_pk_bf16_f32 v166, v132, v133
    v_mfma_f32_16x16x32_bf16 v[144:147], a[44:47], v[196:199], v[144:147]
    v_cvt_pk_bf16_f32 v167, v134, v135
    ds_write_b128 v18, v[164:167] offset:16384
    v_mfma_f32_16x16x32_bf16 v[148:151], a[54:57], v[196:199], v[148:151]
    v_xor_b32 v15, 224, v16
    v_xor_b32 v0, 224, v21
    buffer_load_dwordx4 v[80:83], v13, s[28:31], s37 offen offset:2048
    ds_read_b64_tr_b16 a[70:71], v15
    v_mfma_f32_16x16x16_bf16 v[144:147], a[48:49], v[200:201], v[144:147]
    ds_read_b64_tr_b16 a[72:73], v15 offset:16384
    ds_read_b64_tr_b16 a[74:75], v15 offset:32768
    v_mfma_f32_16x16x16_bf16 v[148:151], a[58:59], v[200:201], v[148:151]
    ds_read_b64_tr_b16 a[76:77], v15 offset:49152
    ds_read_b64_tr_b16 a[78:79], v0
    v_mfma_f32_16x16x32_bf16 v[120:123], a[40:43], v[208:211], 0
    v_mfma_f32_16x16x32_bf16 v[124:127], a[50:53], v[208:211], 0
    v_cvt_pk_bf16_f32 v168, v136, v137
    v_mfma_f32_16x16x32_bf16 v[120:123], a[44:47], v[212:215], v[120:123]
    buffer_load_dwordx4 v[84:87], v13, s[28:31], s37 offen offset:3072
    v_cvt_pk_bf16_f32 v169, v138, v139
    v_mfma_f32_16x16x32_bf16 v[124:127], a[54:57], v[212:215], v[124:127]
    v_cvt_pk_bf16_f32 v170, v140, v141
    v_mfma_f32_16x16x16_bf16 v[120:123], a[48:49], v[216:217], v[120:123]
    v_cvt_pk_bf16_f32 v171, v142, v143
    v_mfma_f32_16x16x16_bf16 v[124:127], a[58:59], v[216:217], v[124:127]
    ds_write_b128 v19, v[168:171]
    v_mfma_f32_16x16x32_bf16 v[128:131], a[40:43], v[224:227], 0
    s_waitcnt lgkmcnt(15)
    v_mfma_f32_16x16x32_bf16 v[132:135], a[50:53], v[224:227], 0
    v_cvt_pk_bf16_f32 v172, v144, v145
    s_add_u32 s37, s84, s90
    buffer_load_dwordx4 v[88:91], v12, s[28:31], s37 offen
    v_mfma_f32_16x16x32_bf16 v[128:131], a[44:47], v[228:231], v[128:131]
    v_cvt_pk_bf16_f32 v173, v146, v147
    v_mfma_f32_16x16x32_bf16 v[132:135], a[54:57], v[228:231], v[132:135]
    v_cvt_pk_bf16_f32 v174, v148, v149
    v_mfma_f32_16x16x16_bf16 v[128:131], a[48:49], v[232:233], v[128:131]
    v_cvt_pk_bf16_f32 v175, v150, v151
    v_mfma_f32_16x16x16_bf16 v[132:135], a[58:59], v[232:233], v[132:135]
    ds_write_b128 v19, v[172:175] offset:4096
    v_mfma_f32_16x16x32_bf16 v[136:139], a[40:43], v[240:243], 0
    s_waitcnt lgkmcnt(15)
    v_mfma_f32_16x16x32_bf16 v[140:143], a[50:53], v[240:243], 0
    v_cvt_pk_bf16_f32 v152, v120, v121
    buffer_load_dwordx4 v[92:95], v12, s[28:31], s37 offen offset:1024
    v_mfma_f32_16x16x32_bf16 v[136:139], a[44:47], v[244:247], v[136:139]
    v_cvt_pk_bf16_f32 v153, v122, v123
    v_mfma_f32_16x16x32_bf16 v[140:143], a[54:57], v[244:247], v[140:143]
    v_cvt_pk_bf16_f32 v154, v124, v125
    v_mfma_f32_16x16x16_bf16 v[136:139], a[48:49], v[248:249], v[136:139]
    v_cvt_pk_bf16_f32 v155, v126, v127
    v_mfma_f32_16x16x16_bf16 v[140:143], a[58:59], v[248:249], v[140:143]
    ds_write_b128 v19, v[152:155] offset:8192
    s_waitcnt lgkmcnt(3)
    v_mfma_f32_16x16x32_bf16 v[144:147], a[60:63], v[176:179], 0
    v_mfma_f32_16x16x32_bf16 v[148:151], a[70:73], v[176:179], 0
    buffer_load_dwordx4 v[96:99], v12, s[28:31], s37 offen offset:2048
    v_cvt_pk_bf16_f32 v156, v128, v129
    v_mfma_f32_16x16x32_bf16 v[144:147], a[64:67], v[180:183], v[144:147]
    v_cvt_pk_bf16_f32 v157, v130, v131
    v_mfma_f32_16x16x32_bf16 v[148:151], a[74:77], v[180:183], v[148:151]
    v_cvt_pk_bf16_f32 v158, v132, v133
    v_mfma_f32_16x16x16_bf16 v[144:147], a[68:69], v[184:185], v[144:147]
    v_cvt_pk_bf16_f32 v159, v134, v135
    v_mfma_f32_16x16x16_bf16 v[148:151], a[78:79], v[184:185], v[148:151]
    ds_write_b128 v19, v[156:159] offset:12288
    v_mfma_f32_16x16x32_bf16 v[120:123], a[60:63], v[192:195], 0
    v_mfma_f32_16x16x32_bf16 v[124:127], a[70:73], v[192:195], 0
    buffer_load_dwordx4 v[100:103], v12, s[28:31], s37 offen offset:3072
    v_cvt_pk_bf16_f32 v160, v136, v137
    v_mfma_f32_16x16x32_bf16 v[120:123], a[64:67], v[196:199], v[120:123]
    v_cvt_pk_bf16_f32 v161, v138, v139
    v_mfma_f32_16x16x32_bf16 v[124:127], a[74:77], v[196:199], v[124:127]
    v_cvt_pk_bf16_f32 v162, v140, v141
    v_mfma_f32_16x16x16_bf16 v[120:123], a[68:69], v[200:201], v[120:123]
    v_cvt_pk_bf16_f32 v163, v142, v143
    v_mfma_f32_16x16x16_bf16 v[124:127], a[78:79], v[200:201], v[124:127]
    ds_write_b128 v19, v[160:163] offset:16384
    v_mfma_f32_16x16x32_bf16 v[128:131], a[60:63], v[208:211], 0
    buffer_load_dwordx4 v[104:107], v13, s[28:31], s37 offen
    v_mfma_f32_16x16x32_bf16 v[132:135], a[70:73], v[208:211], 0
    v_cvt_pk_bf16_f32 v164, v144, v145
    v_mfma_f32_16x16x32_bf16 v[128:131], a[64:67], v[212:215], v[128:131]
    v_cvt_pk_bf16_f32 v165, v146, v147
    v_mfma_f32_16x16x32_bf16 v[132:135], a[74:77], v[212:215], v[132:135]
    v_cvt_pk_bf16_f32 v166, v148, v149
    v_mfma_f32_16x16x16_bf16 v[128:131], a[68:69], v[216:217], v[128:131]
    v_cvt_pk_bf16_f32 v167, v150, v151
    v_mfma_f32_16x16x16_bf16 v[132:135], a[78:79], v[216:217], v[132:135]
    ds_write_b128 v20, v[164:167]
    v_mfma_f32_16x16x32_bf16 v[136:139], a[60:63], v[224:227], 0
    s_waitcnt lgkmcnt(5)
    buffer_load_dwordx4 v[108:111], v13, s[28:31], s37 offen offset:1024
    v_mfma_f32_16x16x32_bf16 v[140:143], a[70:73], v[224:227], 0
    v_cvt_pk_bf16_f32 v168, v120, v121
    v_mfma_f32_16x16x32_bf16 v[136:139], a[64:67], v[228:231], v[136:139]
    v_cvt_pk_bf16_f32 v169, v122, v123
    v_mfma_f32_16x16x32_bf16 v[140:143], a[74:77], v[228:231], v[140:143]
    v_cvt_pk_bf16_f32 v170, v124, v125
    v_mfma_f32_16x16x16_bf16 v[136:139], a[68:69], v[232:233], v[136:139]
    v_cvt_pk_bf16_f32 v171, v126, v127
    v_mfma_f32_16x16x16_bf16 v[140:143], a[78:79], v[232:233], v[140:143]
    ds_write_b128 v20, v[168:171] offset:4096
    v_mfma_f32_16x16x32_bf16 v[144:147], a[60:63], v[240:243], 0
    s_waitcnt lgkmcnt(5)
    buffer_load_dwordx4 v[112:115], v13, s[28:31], s37 offen offset:2048
    v_mfma_f32_16x16x32_bf16 v[148:151], a[70:73], v[240:243], 0
    v_cvt_pk_bf16_f32 v172, v128, v129
    v_mfma_f32_16x16x32_bf16 v[144:147], a[64:67], v[244:247], v[144:147]
    v_cvt_pk_bf16_f32 v173, v130, v131
    v_mfma_f32_16x16x32_bf16 v[148:151], a[74:77], v[244:247], v[148:151]
    v_cvt_pk_bf16_f32 v174, v132, v133
    v_mfma_f32_16x16x16_bf16 v[144:147], a[68:69], v[248:249], v[144:147]
    v_cvt_pk_bf16_f32 v175, v134, v135
    v_mfma_f32_16x16x16_bf16 v[148:151], a[78:79], v[248:249], v[148:151]
    ds_write_b128 v20, v[172:175] offset:8192
    s_waitcnt lgkmcnt(5)
    v_cvt_pk_bf16_f32 v152, v136, v137
    buffer_load_dwordx4 v[116:119], v13, s[28:31], s37 offen offset:3072
    v_cvt_pk_bf16_f32 v153, v138, v139
    v_cvt_pk_bf16_f32 v154, v140, v141
    v_cvt_pk_bf16_f32 v155, v142, v143
    ds_write_b128 v20, v[152:155] offset:12288
    s_nop 2
    s_waitcnt lgkmcnt(5)
    v_cvt_pk_bf16_f32 v156, v144, v145
    v_cvt_pk_bf16_f32 v157, v146, v147
    v_cvt_pk_bf16_f32 v158, v148, v149
    v_cvt_pk_bf16_f32 v159, v150, v151
    ds_write_b128 v20, v[156:159] offset:16384
    v_add_u32 v246, s92, v14
    v_xor_b32 v15, s96, v246
    ds_read_b128 a[160:163], v15
    ds_read_b128 a[164:167], v15 offset:4096
    ds_read_b128 a[168:171], v15 offset:8192
    ds_read_b128 a[172:175], v15 offset:12288
    ds_read_b128 a[176:179], v15 offset:16384
    s_waitcnt vmcnt(16)
    s_waitcnt lgkmcnt(5)
    v_perm_b32 v152, v28, v24, s42
    v_perm_b32 v153, v36, v32, s42
    v_perm_b32 v154, v44, v40, s42
    v_perm_b32 v155, v52, v48, s42
    s_nop 0
    s_waitcnt lgkmcnt(0)
    v_mfma_f32_16x16x32_bf16 a[0:3], v[152:155], a[160:163], 0
    v_perm_b32 v156, v28, v24, s43
    v_perm_b32 v157, v36, v32, s43
    v_mfma_f32_16x16x32_bf16 a[32:35], v[152:155], a[164:167], 0
    v_perm_b32 v158, v44, v40, s43
    v_perm_b32 v159, v52, v48, s43
    v_mfma_f32_16x16x32_bf16 a[64:67], v[152:155], a[168:171], 0
    v_mfma_f32_16x16x32_bf16 a[96:99], v[152:155], a[172:175], 0
    s_add_u32 s37, s84, s91
    buffer_load_dwordx4 v[120:123], v12, s[28:31], s37 offen
    v_mfma_f32_16x16x32_bf16 a[128:131], v[152:155], a[176:179], 0
    v_xor_b32 v15, s97, v246
    ds_read_b128 a[180:183], v15
    v_mfma_f32_16x16x32_bf16 a[4:7], v[156:159], a[160:163], 0
    v_perm_b32 v160, v29, v25, s42
    v_perm_b32 v161, v37, v33, s42
    v_mfma_f32_16x16x32_bf16 a[36:39], v[156:159], a[164:167], 0
    v_perm_b32 v162, v45, v41, s42
    v_perm_b32 v163, v53, v49, s42
    v_mfma_f32_16x16x32_bf16 a[68:71], v[156:159], a[168:171], 0
    v_mfma_f32_16x16x32_bf16 a[100:103], v[156:159], a[172:175], 0
    buffer_load_dwordx4 v[124:127], v12, s[28:31], s37 offen offset:1024
    v_mfma_f32_16x16x32_bf16 a[132:135], v[156:159], a[176:179], 0
    ds_read_b128 a[184:187], v15 offset:4096
    v_mfma_f32_16x16x32_bf16 a[8:11], v[160:163], a[160:163], 0
    v_perm_b32 v152, v29, v25, s43
    v_perm_b32 v153, v37, v33, s43
    v_mfma_f32_16x16x32_bf16 a[40:43], v[160:163], a[164:167], 0
    v_perm_b32 v154, v45, v41, s43
    v_perm_b32 v155, v53, v49, s43
    v_mfma_f32_16x16x32_bf16 a[72:75], v[160:163], a[168:171], 0
    v_mfma_f32_16x16x32_bf16 a[104:107], v[160:163], a[172:175], 0
    buffer_load_dwordx4 v[128:131], v12, s[28:31], s37 offen offset:2048
    v_mfma_f32_16x16x32_bf16 a[136:139], v[160:163], a[176:179], 0
    ds_read_b128 a[188:191], v15 offset:8192
    v_mfma_f32_16x16x32_bf16 a[12:15], v[152:155], a[160:163], 0
    v_perm_b32 v156, v30, v26, s42
    v_perm_b32 v157, v38, v34, s42
    v_mfma_f32_16x16x32_bf16 a[44:47], v[152:155], a[164:167], 0
    v_perm_b32 v158, v46, v42, s42
    v_perm_b32 v159, v54, v50, s42
    v_mfma_f32_16x16x32_bf16 a[76:79], v[152:155], a[168:171], 0
    v_mfma_f32_16x16x32_bf16 a[108:111], v[152:155], a[172:175], 0
    buffer_load_dwordx4 v[132:135], v12, s[28:31], s37 offen offset:3072
    v_mfma_f32_16x16x32_bf16 a[140:143], v[152:155], a[176:179], 0
    ds_read_b128 a[192:195], v15 offset:12288
    v_mfma_f32_16x16x32_bf16 a[16:19], v[156:159], a[160:163], 0
    v_perm_b32 v160, v30, v26, s43
    v_perm_b32 v161, v38, v34, s43
    v_mfma_f32_16x16x32_bf16 a[48:51], v[156:159], a[164:167], 0
    v_perm_b32 v162, v46, v42, s43
    v_perm_b32 v163, v54, v50, s43
    v_mfma_f32_16x16x32_bf16 a[80:83], v[156:159], a[168:171], 0
    v_mfma_f32_16x16x32_bf16 a[112:115], v[156:159], a[172:175], 0
    buffer_load_dwordx4 v[136:139], v13, s[28:31], s37 offen
    v_mfma_f32_16x16x32_bf16 a[144:147], v[156:159], a[176:179], 0
    ds_read_b128 a[196:199], v15 offset:16384
    v_mfma_f32_16x16x32_bf16 a[20:23], v[160:163], a[160:163], 0
    v_perm_b32 v152, v31, v27, s42
    v_perm_b32 v153, v39, v35, s42
    v_mfma_f32_16x16x32_bf16 a[52:55], v[160:163], a[164:167], 0
    v_perm_b32 v154, v47, v43, s42
    v_perm_b32 v155, v55, v51, s42
    v_mfma_f32_16x16x32_bf16 a[84:87], v[160:163], a[168:171], 0
    v_mfma_f32_16x16x32_bf16 a[116:119], v[160:163], a[172:175], 0
    buffer_load_dwordx4 v[140:143], v13, s[28:31], s37 offen offset:1024
    v_mfma_f32_16x16x32_bf16 a[148:151], v[160:163], a[176:179], 0
    v_mfma_f32_16x16x32_bf16 a[24:27], v[152:155], a[160:163], 0
    v_perm_b32 v156, v31, v27, s43
    v_perm_b32 v157, v39, v35, s43
    v_mfma_f32_16x16x32_bf16 a[56:59], v[152:155], a[164:167], 0
    v_perm_b32 v158, v47, v43, s43
    v_perm_b32 v159, v55, v51, s43
    v_mfma_f32_16x16x32_bf16 a[88:91], v[152:155], a[168:171], 0
    v_mfma_f32_16x16x32_bf16 a[120:123], v[152:155], a[172:175], 0
    buffer_load_dwordx4 v[144:147], v13, s[28:31], s37 offen offset:2048
    v_mfma_f32_16x16x32_bf16 a[152:155], v[152:155], a[176:179], 0
    v_mfma_f32_16x16x32_bf16 a[28:31], v[156:159], a[160:163], 0
    s_waitcnt vmcnt(15)
    v_perm_b32 v160, v60, v56, s42
    v_perm_b32 v161, v68, v64, s42
    v_mfma_f32_16x16x32_bf16 a[60:63], v[156:159], a[164:167], 0
    v_perm_b32 v162, v76, v72, s42
    v_perm_b32 v163, v84, v80, s42
    v_mfma_f32_16x16x32_bf16 a[92:95], v[156:159], a[168:171], 0
    v_mfma_f32_16x16x32_bf16 a[124:127], v[156:159], a[172:175], 0
    buffer_load_dwordx4 v[148:151], v13, s[28:31], s37 offen offset:3072
    v_mfma_f32_16x16x32_bf16 a[156:159], v[156:159], a[176:179], 0
    s_waitcnt lgkmcnt(0)
    v_mfma_f32_16x16x32_bf16 a[0:3], v[160:163], a[180:183], a[0:3]
    v_perm_b32 v152, v60, v56, s43
    v_perm_b32 v153, v68, v64, s43
    v_mfma_f32_16x16x32_bf16 a[32:35], v[160:163], a[184:187], a[32:35]
    v_perm_b32 v154, v76, v72, s43
    v_perm_b32 v155, v84, v80, s43
    v_mfma_f32_16x16x32_bf16 a[64:67], v[160:163], a[188:191], a[64:67]
    s_add_u32 s37, s85, s88
    buffer_load_dwordx4 v[200:203], v12, s[28:31], s37 offen
    v_mfma_f32_16x16x32_bf16 a[96:99], v[160:163], a[192:195], a[96:99]
    buffer_load_dwordx4 v[204:207], v12, s[28:31], s37 offen offset:1024
    v_mfma_f32_16x16x32_bf16 a[128:131], v[160:163], a[196:199], a[128:131]
    v_xor_b32 v15, s98, v246
    ds_read_b128 a[200:203], v15
    v_mfma_f32_16x16x32_bf16 a[4:7], v[152:155], a[180:183], a[4:7]
    v_perm_b32 v156, v61, v57, s42
    v_perm_b32 v157, v69, v65, s42
    v_mfma_f32_16x16x32_bf16 a[36:39], v[152:155], a[184:187], a[36:39]
    v_perm_b32 v158, v77, v73, s42
    v_perm_b32 v159, v85, v81, s42
    v_mfma_f32_16x16x32_bf16 a[68:71], v[152:155], a[188:191], a[68:71]
    buffer_load_dwordx4 v[208:211], v12, s[28:31], s37 offen offset:2048
    v_mfma_f32_16x16x32_bf16 a[100:103], v[152:155], a[192:195], a[100:103]
    buffer_load_dwordx4 v[212:215], v12, s[28:31], s37 offen offset:3072
    v_mfma_f32_16x16x32_bf16 a[132:135], v[152:155], a[196:199], a[132:135]
    ds_read_b128 a[204:207], v15 offset:4096
    v_mfma_f32_16x16x32_bf16 a[8:11], v[156:159], a[180:183], a[8:11]
    v_perm_b32 v160, v61, v57, s43
    v_perm_b32 v161, v69, v65, s43
    v_mfma_f32_16x16x32_bf16 a[40:43], v[156:159], a[184:187], a[40:43]
    v_perm_b32 v162, v77, v73, s43
    v_perm_b32 v163, v85, v81, s43
    v_mfma_f32_16x16x32_bf16 a[72:75], v[156:159], a[188:191], a[72:75]
    buffer_load_dwordx4 v[216:219], v13, s[28:31], s37 offen
    v_mfma_f32_16x16x32_bf16 a[104:107], v[156:159], a[192:195], a[104:107]
    buffer_load_dwordx4 v[220:223], v13, s[28:31], s37 offen offset:1024
    v_mfma_f32_16x16x32_bf16 a[136:139], v[156:159], a[196:199], a[136:139]
    ds_read_b128 a[208:211], v15 offset:8192
    v_mfma_f32_16x16x32_bf16 a[12:15], v[160:163], a[180:183], a[12:15]
    v_perm_b32 v152, v62, v58, s42
    v_perm_b32 v153, v70, v66, s42
    v_mfma_f32_16x16x32_bf16 a[44:47], v[160:163], a[184:187], a[44:47]
    v_perm_b32 v154, v78, v74, s42
    v_perm_b32 v155, v86, v82, s42
    v_mfma_f32_16x16x32_bf16 a[76:79], v[160:163], a[188:191], a[76:79]
    buffer_load_dwordx4 v[224:227], v13, s[28:31], s37 offen offset:2048
    v_mfma_f32_16x16x32_bf16 a[108:111], v[160:163], a[192:195], a[108:111]
    buffer_load_dwordx4 v[228:231], v13, s[28:31], s37 offen offset:3072
    v_mfma_f32_16x16x32_bf16 a[140:143], v[160:163], a[196:199], a[140:143]
    ds_read_b128 a[212:215], v15 offset:12288
    v_mfma_f32_16x16x32_bf16 a[16:19], v[152:155], a[180:183], a[16:19]
    v_perm_b32 v156, v62, v58, s43
    v_perm_b32 v157, v70, v66, s43
    v_mfma_f32_16x16x32_bf16 a[48:51], v[152:155], a[184:187], a[48:51]
    v_perm_b32 v158, v78, v74, s43
    v_perm_b32 v159, v86, v82, s43
    v_mfma_f32_16x16x32_bf16 a[80:83], v[152:155], a[188:191], a[80:83]
    s_add_u32 s37, s85, s89
    buffer_load_dwordx4 v[24:27], v12, s[28:31], s37 offen
    v_mfma_f32_16x16x32_bf16 a[112:115], v[152:155], a[192:195], a[112:115]
    buffer_load_dwordx4 v[28:31], v12, s[28:31], s37 offen offset:1024
    v_mfma_f32_16x16x32_bf16 a[144:147], v[152:155], a[196:199], a[144:147]
    ds_read_b128 a[216:219], v15 offset:16384
    v_mfma_f32_16x16x32_bf16 a[20:23], v[156:159], a[180:183], a[20:23]
    v_perm_b32 v160, v63, v59, s42
    v_perm_b32 v161, v71, v67, s42
    v_mfma_f32_16x16x32_bf16 a[52:55], v[156:159], a[184:187], a[52:55]
    v_perm_b32 v162, v79, v75, s42
    v_perm_b32 v163, v87, v83, s42
    v_mfma_f32_16x16x32_bf16 a[84:87], v[156:159], a[188:191], a[84:87]
    buffer_load_dwordx4 v[32:35], v12, s[28:31], s37 offen offset:2048
    v_mfma_f32_16x16x32_bf16 a[116:119], v[156:159], a[192:195], a[116:119]
    buffer_load_dwordx4 v[36:39], v12, s[28:31], s37 offen offset:3072
    v_mfma_f32_16x16x32_bf16 a[148:151], v[156:159], a[196:199], a[148:151]
    v_mfma_f32_16x16x32_bf16 a[24:27], v[160:163], a[180:183], a[24:27]
    v_perm_b32 v152, v63, v59, s43
    v_perm_b32 v153, v71, v67, s43
    v_mfma_f32_16x16x32_bf16 a[56:59], v[160:163], a[184:187], a[56:59]
    v_perm_b32 v154, v79, v75, s43
    v_perm_b32 v155, v87, v83, s43
    v_mfma_f32_16x16x32_bf16 a[88:91], v[160:163], a[188:191], a[88:91]
    buffer_load_dwordx4 v[40:43], v13, s[28:31], s37 offen
    v_mfma_f32_16x16x32_bf16 a[120:123], v[160:163], a[192:195], a[120:123]
    buffer_load_dwordx4 v[44:47], v13, s[28:31], s37 offen offset:1024
    v_mfma_f32_16x16x32_bf16 a[152:155], v[160:163], a[196:199], a[152:155]
    v_mfma_f32_16x16x32_bf16 a[28:31], v[152:155], a[180:183], a[28:31]
    s_waitcnt vmcnt(22)
    v_perm_b32 v156, v92, v88, s42
    v_perm_b32 v157, v100, v96, s42
    v_mfma_f32_16x16x32_bf16 a[60:63], v[152:155], a[184:187], a[60:63]
    v_perm_b32 v158, v108, v104, s42
    v_perm_b32 v159, v116, v112, s42
    v_mfma_f32_16x16x32_bf16 a[92:95], v[152:155], a[188:191], a[92:95]
    buffer_load_dwordx4 v[48:51], v13, s[28:31], s37 offen offset:2048
    v_mfma_f32_16x16x32_bf16 a[124:127], v[152:155], a[192:195], a[124:127]
    buffer_load_dwordx4 v[52:55], v13, s[28:31], s37 offen offset:3072
    v_mfma_f32_16x16x32_bf16 a[156:159], v[152:155], a[196:199], a[156:159]
    s_waitcnt lgkmcnt(0)
    v_mfma_f32_16x16x32_bf16 a[0:3], v[156:159], a[200:203], a[0:3]
    v_perm_b32 v160, v92, v88, s43
    v_perm_b32 v161, v100, v96, s43
    v_mfma_f32_16x16x32_bf16 a[32:35], v[156:159], a[204:207], a[32:35]
    v_perm_b32 v162, v108, v104, s43
    v_perm_b32 v163, v116, v112, s43
    v_mfma_f32_16x16x32_bf16 a[64:67], v[156:159], a[208:211], a[64:67]
    s_add_u32 s70, s54, 0
    v_mfma_f32_16x16x32_bf16 a[96:99], v[156:159], a[212:215], a[96:99]
    s_add_u32 s37, s85, s90
    buffer_load_dwordx4 v[56:59], v12, s[28:31], s37 offen
    v_mfma_f32_16x16x32_bf16 a[128:131], v[156:159], a[216:219], a[128:131]
    v_xor_b32 v15, s99, v246
    ds_read_b128 a[220:223], v15
    v_mfma_f32_16x16x32_bf16 a[4:7], v[160:163], a[200:203], a[4:7]
    v_perm_b32 v152, v93, v89, s42
    v_perm_b32 v153, v101, v97, s42
    v_mfma_f32_16x16x32_bf16 a[36:39], v[160:163], a[204:207], a[36:39]
    v_perm_b32 v154, v109, v105, s42
    v_perm_b32 v155, v117, v113, s42
    v_mfma_f32_16x16x32_bf16 a[68:71], v[160:163], a[208:211], a[68:71]
    s_add_u32 s71, s54, 4096
    v_mfma_f32_16x16x32_bf16 a[100:103], v[160:163], a[212:215], a[100:103]
    buffer_load_dwordx4 v[60:63], v12, s[28:31], s37 offen offset:1024
    v_mfma_f32_16x16x32_bf16 a[132:135], v[160:163], a[216:219], a[132:135]
    ds_read_b128 a[224:227], v15 offset:4096
    v_mfma_f32_16x16x32_bf16 a[8:11], v[152:155], a[200:203], a[8:11]
    v_perm_b32 v156, v93, v89, s43
    v_perm_b32 v157, v101, v97, s43
    v_mfma_f32_16x16x32_bf16 a[40:43], v[152:155], a[204:207], a[40:43]
    v_perm_b32 v158, v109, v105, s43
    v_perm_b32 v159, v117, v113, s43
    v_mfma_f32_16x16x32_bf16 a[72:75], v[152:155], a[208:211], a[72:75]
    s_add_u32 s72, s54, 8192
    v_mfma_f32_16x16x32_bf16 a[104:107], v[152:155], a[212:215], a[104:107]
    buffer_load_dwordx4 v[64:67], v12, s[28:31], s37 offen offset:2048
    v_mfma_f32_16x16x32_bf16 a[136:139], v[152:155], a[216:219], a[136:139]
    ds_read_b128 a[228:231], v15 offset:8192
    v_mfma_f32_16x16x32_bf16 a[12:15], v[156:159], a[200:203], a[12:15]
    v_perm_b32 v160, v94, v90, s42
    v_perm_b32 v161, v102, v98, s42
    v_mfma_f32_16x16x32_bf16 a[44:47], v[156:159], a[204:207], a[44:47]
    v_perm_b32 v162, v110, v106, s42
    v_perm_b32 v163, v118, v114, s42
    v_mfma_f32_16x16x32_bf16 a[76:79], v[156:159], a[208:211], a[76:79]
    s_add_u32 s73, s54, 12288
    v_mfma_f32_16x16x32_bf16 a[108:111], v[156:159], a[212:215], a[108:111]
    buffer_load_dwordx4 v[68:71], v12, s[28:31], s37 offen offset:3072
    v_mfma_f32_16x16x32_bf16 a[140:143], v[156:159], a[216:219], a[140:143]
    ds_read_b128 a[232:235], v15 offset:12288
    v_mfma_f32_16x16x32_bf16 a[16:19], v[160:163], a[200:203], a[16:19]
    v_perm_b32 v152, v94, v90, s43
    v_perm_b32 v153, v102, v98, s43
    v_mfma_f32_16x16x32_bf16 a[48:51], v[160:163], a[204:207], a[48:51]
    v_perm_b32 v154, v110, v106, s43
    v_perm_b32 v155, v118, v114, s43
    v_mfma_f32_16x16x32_bf16 a[80:83], v[160:163], a[208:211], a[80:83]
    s_add_u32 s74, s54, 16384
    v_mfma_f32_16x16x32_bf16 a[112:115], v[160:163], a[212:215], a[112:115]
    buffer_load_dwordx4 v[72:75], v13, s[28:31], s37 offen
    v_mfma_f32_16x16x32_bf16 a[144:147], v[160:163], a[216:219], a[144:147]
    ds_read_b128 a[236:239], v15 offset:16384
    v_mfma_f32_16x16x32_bf16 a[20:23], v[152:155], a[200:203], a[20:23]
    v_perm_b32 v156, v95, v91, s42
    v_perm_b32 v157, v103, v99, s42
    v_mfma_f32_16x16x32_bf16 a[52:55], v[152:155], a[204:207], a[52:55]
    v_perm_b32 v158, v111, v107, s42
    v_perm_b32 v159, v119, v115, s42
    v_mfma_f32_16x16x32_bf16 a[84:87], v[152:155], a[208:211], a[84:87]
    v_lshlrev_b32 v22, 4, v1
    v_mfma_f32_16x16x32_bf16 a[116:119], v[152:155], a[212:215], a[116:119]
    buffer_load_dwordx4 v[76:79], v13, s[28:31], s37 offen offset:1024
    v_mfma_f32_16x16x32_bf16 a[148:151], v[152:155], a[216:219], a[148:151]
    v_mfma_f32_16x16x32_bf16 a[24:27], v[156:159], a[200:203], a[24:27]
    v_perm_b32 v160, v95, v91, s43
    v_perm_b32 v161, v103, v99, s43
    v_mfma_f32_16x16x32_bf16 a[56:59], v[156:159], a[204:207], a[56:59]
    v_perm_b32 v162, v111, v107, s43
    v_perm_b32 v163, v119, v115, s43
    v_mfma_f32_16x16x32_bf16 a[88:91], v[156:159], a[208:211], a[88:91]
    v_lshlrev_b32 v4, 10, v3
    v_mfma_f32_16x16x32_bf16 a[120:123], v[156:159], a[212:215], a[120:123]
    buffer_load_dwordx4 v[80:83], v13, s[28:31], s37 offen offset:2048
    v_mfma_f32_16x16x32_bf16 a[152:155], v[156:159], a[216:219], a[152:155]
    v_mfma_f32_16x16x32_bf16 a[28:31], v[160:163], a[200:203], a[28:31]
    s_waitcnt vmcnt(23)
    v_perm_b32 v152, v124, v120, s42
    v_perm_b32 v153, v132, v128, s42
    v_mfma_f32_16x16x32_bf16 a[60:63], v[160:163], a[204:207], a[60:63]
    v_perm_b32 v154, v140, v136, s42
    v_perm_b32 v155, v148, v144, s42
    v_mfma_f32_16x16x32_bf16 a[92:95], v[160:163], a[208:211], a[92:95]
    v_lshl_add_u32 v4, v2, 4, v4
    v_mfma_f32_16x16x32_bf16 a[124:127], v[160:163], a[212:215], a[124:127]
    buffer_load_dwordx4 v[84:87], v13, s[28:31], s37 offen offset:3072
    v_mfma_f32_16x16x32_bf16 a[156:159], v[160:163], a[216:219], a[156:159]
    s_waitcnt lgkmcnt(0)
    s_barrier
    v_mfma_f32_16x16x32_bf16 a[0:3], v[152:155], a[220:223], a[0:3]
    v_perm_b32 v156, v124, v120, s43
    v_perm_b32 v157, v132, v128, s43
    v_mfma_f32_16x16x32_bf16 a[32:35], v[152:155], a[224:227], a[32:35]
    v_perm_b32 v158, v140, v136, s43
    v_perm_b32 v159, v148, v144, s43
    v_mfma_f32_16x16x32_bf16 a[64:67], v[152:155], a[228:231], a[64:67]
    v_lshlrev_b32 v5, 11, v2
    v_mfma_f32_16x16x32_bf16 a[96:99], v[152:155], a[232:235], a[96:99]
    s_add_u32 s37, s85, s91
    buffer_load_dwordx4 v[88:91], v12, s[28:31], s37 offen
    v_mfma_f32_16x16x32_bf16 a[128:131], v[152:155], a[236:239], a[128:131]
    v_add_u32 v246, s93, v14
    v_xor_b32 v15, s96, v246
    ds_read_b128 a[240:243], v15
    v_mfma_f32_16x16x32_bf16 a[4:7], v[156:159], a[220:223], a[4:7]
    v_perm_b32 v160, v125, v121, s42
    v_perm_b32 v161, v133, v129, s42
    v_mfma_f32_16x16x32_bf16 a[36:39], v[156:159], a[224:227], a[36:39]
    v_perm_b32 v162, v141, v137, s42
    v_perm_b32 v163, v149, v145, s42
    v_mfma_f32_16x16x32_bf16 a[68:71], v[156:159], a[228:231], a[68:71]
    v_lshl_add_u32 v5, v3, 4, v5
    v_mfma_f32_16x16x32_bf16 a[100:103], v[156:159], a[232:235], a[100:103]
    buffer_load_dwordx4 v[92:95], v12, s[28:31], s37 offen offset:1024
    v_mfma_f32_16x16x32_bf16 a[132:135], v[156:159], a[236:239], a[132:135]
    ds_read_b128 a[244:247], v15 offset:4096
    v_mfma_f32_16x16x32_bf16 a[8:11], v[160:163], a[220:223], a[8:11]
    v_perm_b32 v152, v125, v121, s43
    v_perm_b32 v153, v133, v129, s43
    v_mfma_f32_16x16x32_bf16 a[40:43], v[160:163], a[224:227], a[40:43]
    v_perm_b32 v154, v141, v137, s43
    v_perm_b32 v155, v149, v145, s43
    v_mfma_f32_16x16x32_bf16 a[72:75], v[160:163], a[228:231], a[72:75]
    v_and_b32 v6, 7, v1
    v_mfma_f32_16x16x32_bf16 a[104:107], v[160:163], a[232:235], a[104:107]
    buffer_load_dwordx4 v[96:99], v12, s[28:31], s37 offen offset:2048
    v_mfma_f32_16x16x32_bf16 a[136:139], v[160:163], a[236:239], a[136:139]
    ds_read_b128 a[248:251], v15 offset:8192
    v_mfma_f32_16x16x32_bf16 a[12:15], v[152:155], a[220:223], a[12:15]
    v_perm_b32 v156, v126, v122, s42
    v_perm_b32 v157, v134, v130, s42
    v_mfma_f32_16x16x32_bf16 a[44:47], v[152:155], a[224:227], a[44:47]
    v_perm_b32 v158, v142, v138, s42
    v_perm_b32 v159, v150, v146, s42
    v_mfma_f32_16x16x32_bf16 a[76:79], v[152:155], a[228:231], a[76:79]
    v_lshlrev_b32 v6, 2, v6
    v_mfma_f32_16x16x32_bf16 a[108:111], v[152:155], a[232:235], a[108:111]
    buffer_load_dwordx4 v[100:103], v12, s[28:31], s37 offen offset:3072
    v_mfma_f32_16x16x32_bf16 a[140:143], v[152:155], a[236:239], a[140:143]
    ds_read_b128 a[252:255], v15 offset:12288
    v_mfma_f32_16x16x32_bf16 a[16:19], v[156:159], a[220:223], a[16:19]
    v_perm_b32 v160, v126, v122, s43
    v_perm_b32 v161, v134, v130, s43
    v_mfma_f32_16x16x32_bf16 a[48:51], v[156:159], a[224:227], a[48:51]
    v_perm_b32 v162, v142, v138, s43
    v_perm_b32 v163, v150, v146, s43
    v_mfma_f32_16x16x32_bf16 a[80:83], v[156:159], a[228:231], a[80:83]
    v_mov_b32 v16, 0
    v_mfma_f32_16x16x32_bf16 a[112:115], v[156:159], a[232:235], a[112:115]
    buffer_load_dwordx4 v[104:107], v13, s[28:31], s37 offen
    v_mfma_f32_16x16x32_bf16 a[144:147], v[156:159], a[236:239], a[144:147]
    ds_read_b128 v[248:251], v15 offset:16384
    v_mfma_f32_16x16x32_bf16 a[20:23], v[160:163], a[220:223], a[20:23]
    v_perm_b32 v152, v127, v123, s42
    v_perm_b32 v153, v135, v131, s42
    v_mfma_f32_16x16x32_bf16 a[52:55], v[160:163], a[224:227], a[52:55]
    v_perm_b32 v154, v143, v139, s42
    v_perm_b32 v155, v151, v147, s42
    v_mfma_f32_16x16x32_bf16 a[84:87], v[160:163], a[228:231], a[84:87]
    v_mov_b32 v17, 1
    v_mfma_f32_16x16x32_bf16 a[116:119], v[160:163], a[232:235], a[116:119]
    buffer_load_dwordx4 v[108:111], v13, s[28:31], s37 offen offset:1024
    v_mfma_f32_16x16x32_bf16 a[148:151], v[160:163], a[236:239], a[148:151]
    v_mfma_f32_16x16x32_bf16 a[24:27], v[152:155], a[220:223], a[24:27]
    v_perm_b32 v156, v127, v123, s43
    v_perm_b32 v157, v135, v131, s43
    v_mfma_f32_16x16x32_bf16 a[56:59], v[152:155], a[224:227], a[56:59]
    v_perm_b32 v158, v143, v139, s43
    v_perm_b32 v159, v151, v147, s43
    v_mfma_f32_16x16x32_bf16 a[88:91], v[152:155], a[228:231], a[88:91]
    s_mov_b32 s40, 0x01010101
    v_mfma_f32_16x16x32_bf16 a[120:123], v[152:155], a[232:235], a[120:123]
    buffer_load_dwordx4 v[112:115], v13, s[28:31], s37 offen offset:2048
    v_mfma_f32_16x16x32_bf16 a[152:155], v[152:155], a[236:239], a[152:155]
    v_mfma_f32_16x16x32_bf16 a[28:31], v[156:159], a[220:223], a[28:31]
    s_waitcnt vmcnt(23)
    v_perm_b32 v160, v204, v200, s42
    v_perm_b32 v161, v212, v208, s42
    v_mfma_f32_16x16x32_bf16 a[60:63], v[156:159], a[224:227], a[60:63]
    v_perm_b32 v162, v220, v216, s42
    v_perm_b32 v163, v228, v224, s42
    v_mfma_f32_16x16x32_bf16 a[92:95], v[156:159], a[228:231], a[92:95]
    s_mov_b32 s41, 0
    v_mfma_f32_16x16x32_bf16 a[124:127], v[156:159], a[232:235], a[124:127]
    buffer_load_dwordx4 v[116:119], v13, s[28:31], s37 offen offset:3072
    v_mfma_f32_16x16x32_bf16 a[156:159], v[156:159], a[236:239], a[156:159]
    s_waitcnt lgkmcnt(0)
    v_mfma_f32_16x16x32_bf16 a[0:3], v[160:163], a[240:243], a[0:3]
    v_perm_b32 v152, v204, v200, s43
    v_perm_b32 v153, v212, v208, s43
    v_mfma_f32_16x16x32_bf16 a[32:35], v[160:163], a[244:247], a[32:35]
    v_perm_b32 v154, v220, v216, s43
    v_perm_b32 v155, v228, v224, s43
    v_mfma_f32_16x16x32_bf16 a[64:67], v[160:163], a[248:251], a[64:67]
    buffer_load_dwordx2 v[8:9], v16, s[76:79], s56 offen sc1
    v_mfma_f32_16x16x32_bf16 a[96:99], v[160:163], a[252:255], a[96:99]
    s_add_u32 s37, s86, s88
    buffer_load_dwordx4 v[120:123], v12, s[28:31], s37 offen
    v_mfma_f32_16x16x32_bf16 a[128:131], v[160:163], v[248:251], a[128:131]
    v_xor_b32 v15, s97, v246
    ds_read_b128 a[160:163], v15
    v_mfma_f32_16x16x32_bf16 a[4:7], v[152:155], a[240:243], a[4:7]
    v_perm_b32 v156, v205, v201, s42
    v_perm_b32 v157, v213, v209, s42
    v_mfma_f32_16x16x32_bf16 a[36:39], v[152:155], a[244:247], a[36:39]
    v_perm_b32 v158, v221, v217, s42
    v_perm_b32 v159, v229, v225, s42
    v_mfma_f32_16x16x32_bf16 a[68:71], v[152:155], a[248:251], a[68:71]
    s_lshl_b32 s44, s32, 13
    v_mfma_f32_16x16x32_bf16 a[100:103], v[152:155], a[252:255], a[100:103]
    buffer_load_dwordx4 v[124:127], v12, s[28:31], s37 offen offset:1024
    v_mfma_f32_16x16x32_bf16 a[132:135], v[152:155], v[248:251], a[132:135]
    ds_read_b128 a[164:167], v15 offset:4096
    v_mfma_f32_16x16x32_bf16 a[8:11], v[156:159], a[240:243], a[8:11]
    v_perm_b32 v160, v205, v201, s43
    v_perm_b32 v161, v213, v209, s43
    v_mfma_f32_16x16x32_bf16 a[40:43], v[156:159], a[244:247], a[40:43]
    v_perm_b32 v162, v221, v217, s43
    v_perm_b32 v163, v229, v225, s43
    v_mfma_f32_16x16x32_bf16 a[72:75], v[156:159], a[248:251], a[72:75]
    s_add_u32 s45, s44, 0x8000
    v_mfma_f32_16x16x32_bf16 a[104:107], v[156:159], a[252:255], a[104:107]
    buffer_load_dwordx4 v[128:131], v12, s[28:31], s37 offen offset:2048
    v_mfma_f32_16x16x32_bf16 a[136:139], v[156:159], v[248:251], a[136:139]
    ds_read_b128 a[168:171], v15 offset:8192
    v_mfma_f32_16x16x32_bf16 a[12:15], v[160:163], a[240:243], a[12:15]
    v_perm_b32 v152, v206, v202, s42
    v_perm_b32 v153, v214, v210, s42
    v_mfma_f32_16x16x32_bf16 a[44:47], v[160:163], a[244:247], a[44:47]
    v_perm_b32 v154, v222, v218, s42
    v_perm_b32 v155, v230, v226, s42
    v_mfma_f32_16x16x32_bf16 a[76:79], v[160:163], a[248:251], a[76:79]
    s_add_u32 s46, s44, 0x10000
    v_mfma_f32_16x16x32_bf16 a[108:111], v[160:163], a[252:255], a[108:111]
    buffer_load_dwordx4 v[132:135], v12, s[28:31], s37 offen offset:3072
    v_mfma_f32_16x16x32_bf16 a[140:143], v[160:163], v[248:251], a[140:143]
    ds_read_b128 a[172:175], v15 offset:12288
    v_mfma_f32_16x16x32_bf16 a[16:19], v[152:155], a[240:243], a[16:19]
    v_perm_b32 v156, v206, v202, s43
    v_perm_b32 v157, v214, v210, s43
    v_mfma_f32_16x16x32_bf16 a[48:51], v[152:155], a[244:247], a[48:51]
    v_perm_b32 v158, v222, v218, s43
    v_perm_b32 v159, v230, v226, s43
    v_mfma_f32_16x16x32_bf16 a[80:83], v[152:155], a[248:251], a[80:83]
    s_cmp_lt_u32 s32, 2
    s_cselect_b32 s46, s46, 0x30000
    v_mfma_f32_16x16x32_bf16 a[112:115], v[152:155], a[252:255], a[112:115]
    buffer_load_dwordx4 v[136:139], v13, s[28:31], s37 offen
    v_mfma_f32_16x16x32_bf16 a[144:147], v[152:155], v[248:251], a[144:147]
    ds_read_b128 a[176:179], v15 offset:16384
    v_mfma_f32_16x16x32_bf16 a[20:23], v[156:159], a[240:243], a[20:23]
    v_perm_b32 v160, v207, v203, s42
    v_perm_b32 v161, v215, v211, s42
    v_mfma_f32_16x16x32_bf16 a[52:55], v[156:159], a[244:247], a[52:55]
    v_perm_b32 v162, v223, v219, s42
    v_perm_b32 v163, v231, v227, s42
    v_mfma_f32_16x16x32_bf16 a[84:87], v[156:159], a[248:251], a[84:87]
    s_lshl_b32 s38, 1, s34
    v_mfma_f32_16x16x32_bf16 a[116:119], v[156:159], a[252:255], a[116:119]
    buffer_load_dwordx4 v[140:143], v13, s[28:31], s37 offen offset:1024
    v_mfma_f32_16x16x32_bf16 a[148:151], v[156:159], v[248:251], a[148:151]
    v_mfma_f32_16x16x32_bf16 a[24:27], v[160:163], a[240:243], a[24:27]
    v_perm_b32 v152, v207, v203, s43
    v_perm_b32 v153, v215, v211, s43
    v_mfma_f32_16x16x32_bf16 a[56:59], v[160:163], a[244:247], a[56:59]
    v_perm_b32 v154, v223, v219, s43
    v_perm_b32 v155, v231, v227, s43
    v_mfma_f32_16x16x32_bf16 a[88:91], v[160:163], a[248:251], a[88:91]
    s_and_b32 s4, s34, 1
    v_mfma_f32_16x16x32_bf16 a[120:123], v[160:163], a[252:255], a[120:123]
    buffer_load_dwordx4 v[144:147], v13, s[28:31], s37 offen offset:2048
    v_mfma_f32_16x16x32_bf16 a[152:155], v[160:163], v[248:251], a[152:155]
    v_mfma_f32_16x16x32_bf16 a[28:31], v[152:155], a[240:243], a[28:31]
    s_waitcnt vmcnt(24)
    v_perm_b32 v156, v28, v24, s42
    v_perm_b32 v157, v36, v32, s42
    v_mfma_f32_16x16x32_bf16 a[60:63], v[152:155], a[244:247], a[60:63]
    v_perm_b32 v158, v44, v40, s42
    v_perm_b32 v159, v52, v48, s42
    v_mfma_f32_16x16x32_bf16 a[92:95], v[152:155], a[248:251], a[92:95]
    s_mul_i32 s4, s4, 10
    v_mfma_f32_16x16x32_bf16 a[124:127], v[152:155], a[252:255], a[124:127]
    buffer_load_dwordx4 v[148:151], v13, s[28:31], s37 offen offset:3072
    v_mfma_f32_16x16x32_bf16 a[156:159], v[152:155], v[248:251], a[156:159]
    s_waitcnt lgkmcnt(0)
    v_mfma_f32_16x16x32_bf16 a[0:3], v[156:159], a[160:163], a[0:3]
    v_perm_b32 v160, v28, v24, s43
    v_perm_b32 v161, v36, v32, s43
    v_mfma_f32_16x16x32_bf16 a[32:35], v[156:159], a[164:167], a[32:35]
    v_perm_b32 v162, v44, v40, s43
    v_perm_b32 v163, v52, v48, s43
    v_mfma_f32_16x16x32_bf16 a[64:67], v[156:159], a[168:171], a[64:67]
    s_lshr_b32 s5, s34, 1
    v_mfma_f32_16x16x32_bf16 a[96:99], v[156:159], a[172:175], a[96:99]
    s_add_u32 s37, s86, s89
    buffer_load_dwordx4 v[200:203], v12, s[28:31], s37 offen
    v_mfma_f32_16x16x32_bf16 a[128:131], v[156:159], a[176:179], a[128:131]
    v_xor_b32 v15, s98, v246
    ds_read_b128 a[180:183], v15
    v_mfma_f32_16x16x32_bf16 a[4:7], v[160:163], a[160:163], a[4:7]
    v_perm_b32 v152, v29, v25, s42
    v_perm_b32 v153, v37, v33, s42
    v_mfma_f32_16x16x32_bf16 a[36:39], v[160:163], a[164:167], a[36:39]
    v_perm_b32 v154, v45, v41, s42
    v_perm_b32 v155, v53, v49, s42
    v_mfma_f32_16x16x32_bf16 a[68:71], v[160:163], a[168:171], a[68:71]
    s_cmp_eq_u32 s5, s32
    s_cselect_b32 s4, s4, 1000
    v_mfma_f32_16x16x32_bf16 a[100:103], v[160:163], a[172:175], a[100:103]
    buffer_load_dwordx4 v[204:207], v12, s[28:31], s37 offen offset:1024
    v_mfma_f32_16x16x32_bf16 a[132:135], v[160:163], a[176:179], a[132:135]
    ds_read_b128 a[184:187], v15 offset:4096
    v_mfma_f32_16x16x32_bf16 a[8:11], v[152:155], a[160:163], a[8:11]
    v_perm_b32 v156, v29, v25, s43
    v_perm_b32 v157, v37, v33, s43
    v_mfma_f32_16x16x32_bf16 a[40:43], v[152:155], a[164:167], a[40:43]
    v_perm_b32 v158, v45, v41, s43
    v_perm_b32 v159, v53, v49, s43
    v_mfma_f32_16x16x32_bf16 a[72:75], v[152:155], a[168:171], a[72:75]
    v_subrev_u32 v242, s4, v3
    v_mfma_f32_16x16x32_bf16 a[104:107], v[152:155], a[172:175], a[104:107]
    buffer_load_dwordx4 v[208:211], v12, s[28:31], s37 offen offset:2048
    v_mfma_f32_16x16x32_bf16 a[136:139], v[152:155], a[176:179], a[136:139]
    ds_read_b128 a[188:191], v15 offset:8192
    v_mfma_f32_16x16x32_bf16 a[12:15], v[156:159], a[160:163], a[12:15]
    v_perm_b32 v160, v30, v26, s42
    v_perm_b32 v161, v38, v34, s42
    v_mfma_f32_16x16x32_bf16 a[44:47], v[156:159], a[164:167], a[44:47]
    v_perm_b32 v162, v46, v42, s42
    v_perm_b32 v163, v54, v50, s42
    v_mfma_f32_16x16x32_bf16 a[76:79], v[156:159], a[168:171], a[76:79]
    s_lshl_b32 s5, s34, 10
    v_mfma_f32_16x16x32_bf16 a[108:111], v[156:159], a[172:175], a[108:111]
    buffer_load_dwordx4 v[212:215], v12, s[28:31], s37 offen offset:3072
    v_mfma_f32_16x16x32_bf16 a[140:143], v[156:159], a[176:179], a[140:143]
    ds_read_b128 a[192:195], v15 offset:12288
    v_mfma_f32_16x16x32_bf16 a[16:19], v[160:163], a[160:163], a[16:19]
    v_perm_b32 v152, v30, v26, s43
    v_perm_b32 v153, v38, v34, s43
    v_mfma_f32_16x16x32_bf16 a[48:51], v[160:163], a[164:167], a[48:51]
    v_perm_b32 v154, v46, v42, s43
    v_perm_b32 v155, v54, v50, s43
    v_mfma_f32_16x16x32_bf16 a[80:83], v[160:163], a[168:171], a[80:83]
    v_lshlrev_b32 v243, 4, v2
    v_mfma_f32_16x16x32_bf16 a[112:115], v[160:163], a[172:175], a[112:115]
    buffer_load_dwordx4 v[216:219], v13, s[28:31], s37 offen
    v_mfma_f32_16x16x32_bf16 a[144:147], v[160:163], a[176:179], a[144:147]
    ds_read_b128 a[196:199], v15 offset:16384
    v_mfma_f32_16x16x32_bf16 a[20:23], v[152:155], a[160:163], a[20:23]
    v_perm_b32 v156, v31, v27, s42
    v_perm_b32 v157, v39, v35, s42
    v_mfma_f32_16x16x32_bf16 a[52:55], v[152:155], a[164:167], a[52:55]
    v_perm_b32 v158, v47, v43, s42
    v_perm_b32 v159, v55, v51, s42
    v_mfma_f32_16x16x32_bf16 a[84:87], v[152:155], a[168:171], a[84:87]
    v_add_u32 v243, s5, v243
    v_mfma_f32_16x16x32_bf16 a[116:119], v[152:155], a[172:175], a[116:119]
    buffer_load_dwordx4 v[220:223], v13, s[28:31], s37 offen offset:1024
    v_mfma_f32_16x16x32_bf16 a[148:151], v[152:155], a[176:179], a[148:151]
    v_mfma_f32_16x16x32_bf16 a[24:27], v[156:159], a[160:163], a[24:27]
    v_perm_b32 v160, v31, v27, s43
    v_perm_b32 v161, v39, v35, s43
    v_mfma_f32_16x16x32_bf16 a[56:59], v[156:159], a[164:167], a[56:59]
    v_perm_b32 v162, v47, v43, s43
    v_perm_b32 v163, v55, v51, s43
    v_mfma_f32_16x16x32_bf16 a[88:91], v[156:159], a[168:171], a[88:91]
    v_mov_b32 v244, 0x7f000000
    v_mfma_f32_16x16x32_bf16 a[120:123], v[156:159], a[172:175], a[120:123]
    buffer_load_dwordx4 v[224:227], v13, s[28:31], s37 offen offset:2048
    v_mfma_f32_16x16x32_bf16 a[152:155], v[156:159], a[176:179], a[152:155]
    v_mfma_f32_16x16x32_bf16 a[28:31], v[160:163], a[160:163], a[28:31]
    s_waitcnt vmcnt(24)
    v_perm_b32 v152, v60, v56, s42
    v_perm_b32 v153, v68, v64, s42
    v_mfma_f32_16x16x32_bf16 a[60:63], v[160:163], a[164:167], a[60:63]
    v_perm_b32 v154, v76, v72, s42
    v_perm_b32 v155, v84, v80, s42
    v_mfma_f32_16x16x32_bf16 a[92:95], v[160:163], a[168:171], a[92:95]
    v_add_u32 v7, s44, v22
    v_mfma_f32_16x16x32_bf16 a[124:127], v[160:163], a[172:175], a[124:127]
    buffer_load_dwordx4 v[228:231], v13, s[28:31], s37 offen offset:3072
    v_mfma_f32_16x16x32_bf16 a[156:159], v[160:163], a[176:179], a[156:159]
    s_waitcnt lgkmcnt(0)
    v_mfma_f32_16x16x32_bf16 a[0:3], v[152:155], a[180:183], a[0:3]
    v_perm_b32 v156, v60, v56, s43
    v_perm_b32 v157, v68, v64, s43
    v_mfma_f32_16x16x32_bf16 a[32:35], v[152:155], a[184:187], a[32:35]
    v_perm_b32 v158, v76, v72, s43
    v_perm_b32 v159, v84, v80, s43
    v_mfma_f32_16x16x32_bf16 a[64:67], v[152:155], a[188:191], a[64:67]
    v_add_u32 v11, 0x10000, v7
    v_mfma_f32_16x16x32_bf16 a[96:99], v[152:155], a[192:195], a[96:99]
    s_add_u32 s37, s86, s90
    buffer_load_dwordx4 v[24:27], v12, s[28:31], s37 offen
    v_mfma_f32_16x16x32_bf16 a[128:131], v[152:155], a[196:199], a[128:131]
    v_xor_b32 v15, s99, v246
    ds_read_b128 a[200:203], v15
    v_mfma_f32_16x16x32_bf16 a[4:7], v[156:159], a[180:183], a[4:7]
    v_perm_b32 v160, v61, v57, s42
    v_perm_b32 v161, v69, v65, s42
    v_mfma_f32_16x16x32_bf16 a[36:39], v[156:159], a[184:187], a[36:39]
    v_perm_b32 v162, v77, v73, s42
    v_perm_b32 v163, v85, v81, s42
    v_mfma_f32_16x16x32_bf16 a[68:71], v[156:159], a[188:191], a[68:71]
    v_add_u32 v245, 0, v242
    v_mfma_f32_16x16x32_bf16 a[100:103], v[156:159], a[192:195], a[100:103]
    buffer_load_dwordx4 v[28:31], v12, s[28:31], s37 offen offset:1024
    v_mfma_f32_16x16x32_bf16 a[132:135], v[156:159], a[196:199], a[132:135]
    ds_read_b128 a[204:207], v15 offset:4096
    v_mfma_f32_16x16x32_bf16 a[8:11], v[160:163], a[180:183], a[8:11]
    v_perm_b32 v152, v61, v57, s43
    v_perm_b32 v153, v69, v65, s43
    v_mfma_f32_16x16x32_bf16 a[40:43], v[160:163], a[184:187], a[40:43]
    v_perm_b32 v154, v77, v73, s43
    v_perm_b32 v155, v85, v81, s43
    v_mfma_f32_16x16x32_bf16 a[72:75], v[160:163], a[188:191], a[72:75]
    v_cmp_gt_u32 vcc, 10, v245
    v_mfma_f32_16x16x32_bf16 a[104:107], v[160:163], a[192:195], a[104:107]
    buffer_load_dwordx4 v[32:35], v12, s[28:31], s37 offen offset:2048
    v_mfma_f32_16x16x32_bf16 a[136:139], v[160:163], a[196:199], a[136:139]
    ds_read_b128 a[208:211], v15 offset:8192
    v_mfma_f32_16x16x32_bf16 a[12:15], v[152:155], a[180:183], a[12:15]
    v_perm_b32 v156, v62, v58, s42
    v_perm_b32 v157, v70, v66, s42
    v_mfma_f32_16x16x32_bf16 a[44:47], v[152:155], a[184:187], a[44:47]
    v_perm_b32 v158, v78, v74, s42
    v_perm_b32 v159, v86, v82, s42
    v_mfma_f32_16x16x32_bf16 a[76:79], v[152:155], a[188:191], a[76:79]
    v_lshl_add_u32 v245, v245, 13, v243
    v_mfma_f32_16x16x32_bf16 a[108:111], v[152:155], a[192:195], a[108:111]
    buffer_load_dwordx4 v[36:39], v12, s[28:31], s37 offen offset:3072
    v_mfma_f32_16x16x32_bf16 a[140:143], v[152:155], a[196:199], a[140:143]
    ds_read_b128 a[212:215], v15 offset:12288
    v_mfma_f32_16x16x32_bf16 a[16:19], v[156:159], a[180:183], a[16:19]
    v_perm_b32 v160, v62, v58, s43
    v_perm_b32 v161, v70, v66, s43
    v_mfma_f32_16x16x32_bf16 a[48:51], v[156:159], a[184:187], a[48:51]
    v_perm_b32 v162, v78, v74, s43
    v_perm_b32 v163, v86, v82, s43
    v_mfma_f32_16x16x32_bf16 a[80:83], v[156:159], a[188:191], a[80:83]
    v_cndmask_b32 v237, v244, v245, vcc
    v_mfma_f32_16x16x32_bf16 a[112:115], v[156:159], a[192:195], a[112:115]
    buffer_load_dwordx4 v[40:43], v13, s[28:31], s37 offen
    v_mfma_f32_16x16x32_bf16 a[144:147], v[156:159], a[196:199], a[144:147]
    ds_read_b128 a[216:219], v15 offset:16384
    v_mfma_f32_16x16x32_bf16 a[20:23], v[160:163], a[180:183], a[20:23]
    v_perm_b32 v152, v63, v59, s42
    v_perm_b32 v153, v71, v67, s42
    v_mfma_f32_16x16x32_bf16 a[52:55], v[160:163], a[184:187], a[52:55]
    v_perm_b32 v154, v79, v75, s42
    v_perm_b32 v155, v87, v83, s42
    v_mfma_f32_16x16x32_bf16 a[84:87], v[160:163], a[188:191], a[84:87]
    v_cndmask_b32 v232, v22, v244, vcc
    v_mfma_f32_16x16x32_bf16 a[116:119], v[160:163], a[192:195], a[116:119]
    buffer_load_dwordx4 v[44:47], v13, s[28:31], s37 offen offset:1024
    v_mfma_f32_16x16x32_bf16 a[148:151], v[160:163], a[196:199], a[148:151]
    v_mfma_f32_16x16x32_bf16 a[24:27], v[152:155], a[180:183], a[24:27]
    v_perm_b32 v156, v63, v59, s43
    v_perm_b32 v157, v71, v67, s43
    v_mfma_f32_16x16x32_bf16 a[56:59], v[152:155], a[184:187], a[56:59]
    v_perm_b32 v158, v79, v75, s43
    v_perm_b32 v159, v87, v83, s43
    v_mfma_f32_16x16x32_bf16 a[88:91], v[152:155], a[188:191], a[88:91]
    v_add_u32 v245, 4, v242
    v_mfma_f32_16x16x32_bf16 a[120:123], v[152:155], a[192:195], a[120:123]
    buffer_load_dwordx4 v[48:51], v13, s[28:31], s37 offen offset:2048
    v_mfma_f32_16x16x32_bf16 a[152:155], v[152:155], a[196:199], a[152:155]
    v_mfma_f32_16x16x32_bf16 a[28:31], v[156:159], a[180:183], a[28:31]
    s_waitcnt vmcnt(24)
    v_perm_b32 v160, v92, v88, s42
    v_perm_b32 v161, v100, v96, s42
    v_mfma_f32_16x16x32_bf16 a[60:63], v[156:159], a[184:187], a[60:63]
    v_perm_b32 v162, v108, v104, s42
    v_perm_b32 v163, v116, v112, s42
    v_mfma_f32_16x16x32_bf16 a[92:95], v[156:159], a[188:191], a[92:95]
    v_cmp_gt_u32 vcc, 10, v245
    v_mfma_f32_16x16x32_bf16 a[124:127], v[156:159], a[192:195], a[124:127]
    buffer_load_dwordx4 v[52:55], v13, s[28:31], s37 offen offset:3072
    v_mfma_f32_16x16x32_bf16 a[156:159], v[156:159], a[196:199], a[156:159]
    s_waitcnt lgkmcnt(0)
    v_mfma_f32_16x16x32_bf16 a[0:3], v[160:163], a[200:203], a[0:3]
    v_perm_b32 v152, v92, v88, s43
    v_perm_b32 v153, v100, v96, s43
    v_mfma_f32_16x16x32_bf16 a[32:35], v[160:163], a[204:207], a[32:35]
    v_perm_b32 v154, v108, v104, s43
    v_perm_b32 v155, v116, v112, s43
    v_mfma_f32_16x16x32_bf16 a[64:67], v[160:163], a[208:211], a[64:67]
    v_lshl_add_u32 v245, v245, 13, v243
    v_mfma_f32_16x16x32_bf16 a[96:99], v[160:163], a[212:215], a[96:99]
    s_add_u32 s37, s86, s91
    buffer_load_dwordx4 v[56:59], v12, s[28:31], s37 offen
    v_mfma_f32_16x16x32_bf16 a[128:131], v[160:163], a[216:219], a[128:131]
    v_add_u32 v246, s94, v14
    v_xor_b32 v15, s96, v246
    ds_read_b128 a[220:223], v15
    v_mfma_f32_16x16x32_bf16 a[4:7], v[152:155], a[200:203], a[4:7]
    v_perm_b32 v156, v93, v89, s42
    v_perm_b32 v157, v101, v97, s42
    v_mfma_f32_16x16x32_bf16 a[36:39], v[152:155], a[204:207], a[36:39]
    v_perm_b32 v158, v109, v105, s42
    v_perm_b32 v159, v117, v113, s42
    v_mfma_f32_16x16x32_bf16 a[68:71], v[152:155], a[208:211], a[68:71]
    v_cndmask_b32 v238, v244, v245, vcc
    v_mfma_f32_16x16x32_bf16 a[100:103], v[152:155], a[212:215], a[100:103]
    buffer_load_dwordx4 v[60:63], v12, s[28:31], s37 offen offset:1024
    v_mfma_f32_16x16x32_bf16 a[132:135], v[152:155], a[216:219], a[132:135]
    ds_read_b128 a[224:227], v15 offset:4096
    v_mfma_f32_16x16x32_bf16 a[8:11], v[156:159], a[200:203], a[8:11]
    v_perm_b32 v160, v93, v89, s43
    v_perm_b32 v161, v101, v97, s43
    v_mfma_f32_16x16x32_bf16 a[40:43], v[156:159], a[204:207], a[40:43]
    v_perm_b32 v162, v109, v105, s43
    v_perm_b32 v163, v117, v113, s43
    v_mfma_f32_16x16x32_bf16 a[72:75], v[156:159], a[208:211], a[72:75]
    v_cndmask_b32 v233, v22, v244, vcc
    v_mfma_f32_16x16x32_bf16 a[104:107], v[156:159], a[212:215], a[104:107]
    buffer_load_dwordx4 v[64:67], v12, s[28:31], s37 offen offset:2048
    v_mfma_f32_16x16x32_bf16 a[136:139], v[156:159], a[216:219], a[136:139]
    ds_read_b128 a[228:231], v15 offset:8192
    v_mfma_f32_16x16x32_bf16 a[12:15], v[160:163], a[200:203], a[12:15]
    v_perm_b32 v152, v94, v90, s42
    v_perm_b32 v153, v102, v98, s42
    v_mfma_f32_16x16x32_bf16 a[44:47], v[160:163], a[204:207], a[44:47]
    v_perm_b32 v154, v110, v106, s42
    v_perm_b32 v155, v118, v114, s42
    v_mfma_f32_16x16x32_bf16 a[76:79], v[160:163], a[208:211], a[76:79]
    v_add_u32 v245, 8, v242
    v_mfma_f32_16x16x32_bf16 a[108:111], v[160:163], a[212:215], a[108:111]
    buffer_load_dwordx4 v[68:71], v12, s[28:31], s37 offen offset:3072
    v_mfma_f32_16x16x32_bf16 a[140:143], v[160:163], a[216:219], a[140:143]
    ds_read_b128 a[232:235], v15 offset:12288
    v_mfma_f32_16x16x32_bf16 a[16:19], v[152:155], a[200:203], a[16:19]
    v_perm_b32 v156, v94, v90, s43
    v_perm_b32 v157, v102, v98, s43
    v_mfma_f32_16x16x32_bf16 a[48:51], v[152:155], a[204:207], a[48:51]
    v_perm_b32 v158, v110, v106, s43
    v_perm_b32 v159, v118, v114, s43
    v_mfma_f32_16x16x32_bf16 a[80:83], v[152:155], a[208:211], a[80:83]
    v_cmp_gt_u32 vcc, 10, v245
    v_mfma_f32_16x16x32_bf16 a[112:115], v[152:155], a[212:215], a[112:115]
    buffer_load_dwordx4 v[72:75], v13, s[28:31], s37 offen
    v_mfma_f32_16x16x32_bf16 a[144:147], v[152:155], a[216:219], a[144:147]
    ds_read_b128 a[236:239], v15 offset:16384
    v_mfma_f32_16x16x32_bf16 a[20:23], v[156:159], a[200:203], a[20:23]
    v_perm_b32 v160, v95, v91, s42
    v_perm_b32 v161, v103, v99, s42
    v_mfma_f32_16x16x32_bf16 a[52:55], v[156:159], a[204:207], a[52:55]
    v_perm_b32 v162, v111, v107, s42
    v_perm_b32 v163, v119, v115, s42
    v_mfma_f32_16x16x32_bf16 a[84:87], v[156:159], a[208:211], a[84:87]
    v_lshl_add_u32 v245, v245, 13, v243
    v_mfma_f32_16x16x32_bf16 a[116:119], v[156:159], a[212:215], a[116:119]
    buffer_load_dwordx4 v[76:79], v13, s[28:31], s37 offen offset:1024
    v_mfma_f32_16x16x32_bf16 a[148:151], v[156:159], a[216:219], a[148:151]
    v_mfma_f32_16x16x32_bf16 a[24:27], v[160:163], a[200:203], a[24:27]
    v_perm_b32 v152, v95, v91, s43
    v_perm_b32 v153, v103, v99, s43
    v_mfma_f32_16x16x32_bf16 a[56:59], v[160:163], a[204:207], a[56:59]
    v_perm_b32 v154, v111, v107, s43
    v_perm_b32 v155, v119, v115, s43
    v_mfma_f32_16x16x32_bf16 a[88:91], v[160:163], a[208:211], a[88:91]
    v_cndmask_b32 v239, v244, v245, vcc
    v_mfma_f32_16x16x32_bf16 a[120:123], v[160:163], a[212:215], a[120:123]
    buffer_load_dwordx4 v[80:83], v13, s[28:31], s37 offen offset:2048
    v_mfma_f32_16x16x32_bf16 a[152:155], v[160:163], a[216:219], a[152:155]
    v_mfma_f32_16x16x32_bf16 a[28:31], v[152:155], a[200:203], a[28:31]
    s_waitcnt vmcnt(23)
    v_perm_b32 v156, v124, v120, s42
    v_perm_b32 v157, v132, v128, s42
    v_mfma_f32_16x16x32_bf16 a[60:63], v[152:155], a[204:207], a[60:63]
    v_perm_b32 v158, v140, v136, s42
    v_perm_b32 v159, v148, v144, s42
    v_mfma_f32_16x16x32_bf16 a[92:95], v[152:155], a[208:211], a[92:95]
    v_cndmask_b32 v234, v22, v244, vcc
    v_mfma_f32_16x16x32_bf16 a[124:127], v[152:155], a[212:215], a[124:127]
    buffer_load_dwordx4 v[84:87], v13, s[28:31], s37 offen offset:3072
    v_mfma_f32_16x16x32_bf16 a[156:159], v[152:155], a[216:219], a[156:159]
    s_waitcnt lgkmcnt(0)
    v_mfma_f32_16x16x32_bf16 a[0:3], v[156:159], a[220:223], a[0:3]
    v_perm_b32 v160, v124, v120, s43
    v_perm_b32 v161, v132, v128, s43
    v_mfma_f32_16x16x32_bf16 a[32:35], v[156:159], a[224:227], a[32:35]
    v_perm_b32 v162, v140, v136, s43
    v_perm_b32 v163, v148, v144, s43
    v_mfma_f32_16x16x32_bf16 a[64:67], v[156:159], a[228:231], a[64:67]
    v_add_u32 v245, 12, v242
    v_mfma_f32_16x16x32_bf16 a[96:99], v[156:159], a[232:235], a[96:99]
    s_add_u32 s37, s87, s88
    buffer_load_dwordx4 v[88:91], v12, s[28:31], s37 offen
    v_mfma_f32_16x16x32_bf16 a[128:131], v[156:159], a[236:239], a[128:131]
    v_xor_b32 v15, s97, v246
    ds_read_b128 a[240:243], v15
    ds_read_b128 a[244:247], v15 offset:4096
    v_mfma_f32_16x16x32_bf16 a[4:7], v[160:163], a[220:223], a[4:7]
    v_perm_b32 v152, v125, v121, s42
    v_perm_b32 v153, v133, v129, s42
    v_mfma_f32_16x16x32_bf16 a[36:39], v[160:163], a[224:227], a[36:39]
    v_perm_b32 v154, v141, v137, s42
    v_perm_b32 v155, v149, v145, s42
    v_mfma_f32_16x16x32_bf16 a[68:71], v[160:163], a[228:231], a[68:71]
    v_cmp_gt_u32 vcc, 10, v245
    v_mfma_f32_16x16x32_bf16 a[100:103], v[160:163], a[232:235], a[100:103]
    buffer_load_dwordx4 v[92:95], v12, s[28:31], s37 offen offset:1024
    v_mfma_f32_16x16x32_bf16 a[132:135], v[160:163], a[236:239], a[132:135]
    ds_read_b128 a[248:251], v15 offset:8192
    v_mfma_f32_16x16x32_bf16 a[8:11], v[152:155], a[220:223], a[8:11]
    v_perm_b32 v156, v125, v121, s43
    v_perm_b32 v157, v133, v129, s43
    v_mfma_f32_16x16x32_bf16 a[40:43], v[152:155], a[224:227], a[40:43]
    v_perm_b32 v158, v141, v137, s43
    v_perm_b32 v159, v149, v145, s43
    v_mfma_f32_16x16x32_bf16 a[72:75], v[152:155], a[228:231], a[72:75]
    v_lshl_add_u32 v245, v245, 13, v243
    v_mfma_f32_16x16x32_bf16 a[104:107], v[152:155], a[232:235], a[104:107]
    buffer_load_dwordx4 v[96:99], v12, s[28:31], s37 offen offset:2048
    v_mfma_f32_16x16x32_bf16 a[136:139], v[152:155], a[236:239], a[136:139]
    ds_read_b128 a[252:255], v15 offset:12288
    v_mfma_f32_16x16x32_bf16 a[12:15], v[156:159], a[220:223], a[12:15]
    v_perm_b32 v160, v126, v122, s42
    v_perm_b32 v161, v134, v130, s42
    v_mfma_f32_16x16x32_bf16 a[44:47], v[156:159], a[224:227], a[44:47]
    v_perm_b32 v162, v142, v138, s42
    v_perm_b32 v163, v150, v146, s42
    v_mfma_f32_16x16x32_bf16 a[76:79], v[156:159], a[228:231], a[76:79]
    v_cndmask_b32 v240, v244, v245, vcc
    v_mfma_f32_16x16x32_bf16 a[108:111], v[156:159], a[232:235], a[108:111]
    buffer_load_dwordx4 v[100:103], v12, s[28:31], s37 offen offset:3072
    v_mfma_f32_16x16x32_bf16 a[140:143], v[156:159], a[236:239], a[140:143]
    ds_read_b128 v[248:251], v15 offset:16384
    v_mfma_f32_16x16x32_bf16 a[16:19], v[160:163], a[220:223], a[16:19]
    v_perm_b32 v152, v126, v122, s43
    v_perm_b32 v153, v134, v130, s43
    v_mfma_f32_16x16x32_bf16 a[48:51], v[160:163], a[224:227], a[48:51]
    v_perm_b32 v154, v142, v138, s43
    v_perm_b32 v155, v150, v146, s43
    v_mfma_f32_16x16x32_bf16 a[80:83], v[160:163], a[228:231], a[80:83]
    v_cndmask_b32 v235, v22, v244, vcc
    v_mfma_f32_16x16x32_bf16 a[112:115], v[160:163], a[232:235], a[112:115]
    buffer_load_dwordx4 v[104:107], v13, s[28:31], s37 offen
    v_mfma_f32_16x16x32_bf16 a[144:147], v[160:163], a[236:239], a[144:147]
    v_xor_b32 v15, s98, v246
    ds_read_b128 a[160:163], v15
    ds_read_b128 a[164:167], v15 offset:4096
    v_mfma_f32_16x16x32_bf16 a[20:23], v[152:155], a[220:223], a[20:23]
    v_perm_b32 v156, v127, v123, s42
    v_perm_b32 v157, v135, v131, s42
    v_mfma_f32_16x16x32_bf16 a[52:55], v[152:155], a[224:227], a[52:55]
    v_perm_b32 v158, v143, v139, s42
    v_perm_b32 v159, v151, v147, s42
    v_mfma_f32_16x16x32_bf16 a[84:87], v[152:155], a[228:231], a[84:87]
    v_add_u32 v245, 16, v242
    v_mfma_f32_16x16x32_bf16 a[116:119], v[152:155], a[232:235], a[116:119]
    buffer_load_dwordx4 v[108:111], v13, s[28:31], s37 offen offset:1024
    v_mfma_f32_16x16x32_bf16 a[148:151], v[152:155], a[236:239], a[148:151]
    ds_read_b128 a[168:171], v15 offset:8192
    v_mfma_f32_16x16x32_bf16 a[24:27], v[156:159], a[220:223], a[24:27]
    v_perm_b32 v160, v127, v123, s43
    v_perm_b32 v161, v135, v131, s43
    v_mfma_f32_16x16x32_bf16 a[56:59], v[156:159], a[224:227], a[56:59]
    v_perm_b32 v162, v143, v139, s43
    v_perm_b32 v163, v151, v147, s43
    v_mfma_f32_16x16x32_bf16 a[88:91], v[156:159], a[228:231], a[88:91]
    v_cmp_gt_u32 vcc, 10, v245
    v_mfma_f32_16x16x32_bf16 a[120:123], v[156:159], a[232:235], a[120:123]
    buffer_load_dwordx4 v[112:115], v13, s[28:31], s37 offen offset:2048
    v_mfma_f32_16x16x32_bf16 a[152:155], v[156:159], a[236:239], a[152:155]
    ds_read_b128 a[172:175], v15 offset:12288
    v_mfma_f32_16x16x32_bf16 a[28:31], v[160:163], a[220:223], a[28:31]
    s_waitcnt vmcnt(23)
    v_perm_b32 v152, v204, v200, s42
    v_perm_b32 v153, v212, v208, s42
    v_mfma_f32_16x16x32_bf16 a[60:63], v[160:163], a[224:227], a[60:63]
    v_perm_b32 v154, v220, v216, s42
    v_perm_b32 v155, v228, v224, s42
    v_mfma_f32_16x16x32_bf16 a[92:95], v[160:163], a[228:231], a[92:95]
    v_lshl_add_u32 v245, v245, 13, v243
    v_mfma_f32_16x16x32_bf16 a[124:127], v[160:163], a[232:235], a[124:127]
    buffer_load_dwordx4 v[116:119], v13, s[28:31], s37 offen offset:3072
    v_mfma_f32_16x16x32_bf16 a[156:159], v[160:163], a[236:239], a[156:159]
    ds_read_b128 a[176:179], v15 offset:16384
    s_waitcnt lgkmcnt(5)
    v_mfma_f32_16x16x32_bf16 a[0:3], v[152:155], a[240:243], a[0:3]
    v_perm_b32 v156, v204, v200, s43
    v_perm_b32 v157, v212, v208, s43
    v_mfma_f32_16x16x32_bf16 a[32:35], v[152:155], a[244:247], a[32:35]
    v_perm_b32 v158, v220, v216, s43
    v_perm_b32 v159, v228, v224, s43
    v_mfma_f32_16x16x32_bf16 a[64:67], v[152:155], a[248:251], a[64:67]
    v_cndmask_b32 v241, v244, v245, vcc
    v_mfma_f32_16x16x32_bf16 a[96:99], v[152:155], a[252:255], a[96:99]
    s_add_u32 s37, s87, s89
    buffer_load_dwordx4 v[120:123], v12, s[28:31], s37 offen
    v_mfma_f32_16x16x32_bf16 a[128:131], v[152:155], v[248:251], a[128:131]
    v_xor_b32 v15, s99, v246
    ds_read_b128 a[180:183], v15
    ds_read_b128 a[184:187], v15 offset:4096
    v_mfma_f32_16x16x32_bf16 a[4:7], v[156:159], a[240:243], a[4:7]
    v_perm_b32 v160, v205, v201, s42
    v_perm_b32 v161, v213, v209, s42
    v_mfma_f32_16x16x32_bf16 a[36:39], v[156:159], a[244:247], a[36:39]
    v_perm_b32 v162, v221, v217, s42
    v_perm_b32 v163, v229, v225, s42
    v_mfma_f32_16x16x32_bf16 a[68:71], v[156:159], a[248:251], a[68:71]
    v_cndmask_b32 v236, v22, v244, vcc
    v_mfma_f32_16x16x32_bf16 a[100:103], v[156:159], a[252:255], a[100:103]
    buffer_load_dwordx4 v[124:127], v12, s[28:31], s37 offen offset:1024
    v_mfma_f32_16x16x32_bf16 a[132:135], v[156:159], v[248:251], a[132:135]
    ds_read_b128 a[188:191], v15 offset:8192
    v_mfma_f32_16x16x32_bf16 a[8:11], v[160:163], a[240:243], a[8:11]
    v_perm_b32 v152, v205, v201, s43
    v_perm_b32 v153, v213, v209, s43
    v_mfma_f32_16x16x32_bf16 a[40:43], v[160:163], a[244:247], a[40:43]
    v_perm_b32 v154, v221, v217, s43
    v_perm_b32 v155, v229, v225, s43
    v_mfma_f32_16x16x32_bf16 a[72:75], v[160:163], a[248:251], a[72:75]
    v_and_b32 v8, v8, v9
    v_mfma_f32_16x16x32_bf16 a[104:107], v[160:163], a[252:255], a[104:107]
    buffer_load_dwordx4 v[128:131], v12, s[28:31], s37 offen offset:2048
    v_mfma_f32_16x16x32_bf16 a[136:139], v[160:163], v[248:251], a[136:139]
    ds_read_b128 a[192:195], v15 offset:12288
    v_mfma_f32_16x16x32_bf16 a[12:15], v[152:155], a[240:243], a[12:15]
    v_perm_b32 v156, v206, v202, s42
    v_perm_b32 v157, v214, v210, s42
    v_mfma_f32_16x16x32_bf16 a[44:47], v[152:155], a[244:247], a[44:47]
    v_perm_b32 v158, v222, v218, s42
    v_perm_b32 v159, v230, v226, s42
    v_mfma_f32_16x16x32_bf16 a[76:79], v[152:155], a[248:251], a[76:79]
    v_cmp_eq_u32 vcc, s40, v8
    v_mfma_f32_16x16x32_bf16 a[108:111], v[152:155], a[252:255], a[108:111]
    buffer_load_dwordx4 v[132:135], v12, s[28:31], s37 offen offset:3072
    v_mfma_f32_16x16x32_bf16 a[140:143], v[152:155], v[248:251], a[140:143]
    ds_read_b128 a[196:199], v15 offset:16384
    v_mfma_f32_16x16x32_bf16 a[16:19], v[156:159], a[240:243], a[16:19]
    v_perm_b32 v160, v206, v202, s43
    v_perm_b32 v161, v214, v210, s43
    v_mfma_f32_16x16x32_bf16 a[48:51], v[156:159], a[244:247], a[48:51]
    v_perm_b32 v162, v222, v218, s43
    v_perm_b32 v163, v230, v226, s43
    v_mfma_f32_16x16x32_bf16 a[80:83], v[156:159], a[248:251], a[80:83]
    s_and_b32 s47, vcc_lo, 0xff
    v_mfma_f32_16x16x32_bf16 a[112:115], v[156:159], a[252:255], a[112:115]
    buffer_load_dwordx4 v[136:139], v13, s[28:31], s37 offen
    v_mfma_f32_16x16x32_bf16 a[144:147], v[156:159], v[248:251], a[144:147]
    v_add_u32 v246, s95, v14
    v_xor_b32 v15, s96, v246
    ds_read_b128 a[200:203], v15
    ds_read_b128 a[204:207], v15 offset:4096
    v_mfma_f32_16x16x32_bf16 a[20:23], v[160:163], a[240:243], a[20:23]
    v_perm_b32 v152, v207, v203, s42
    v_perm_b32 v153, v215, v211, s42
    v_mfma_f32_16x16x32_bf16 a[52:55], v[160:163], a[244:247], a[52:55]
    v_perm_b32 v154, v223, v219, s42
    v_perm_b32 v155, v231, v227, s42
    v_mfma_f32_16x16x32_bf16 a[84:87], v[160:163], a[248:251], a[84:87]
    v_mfma_f32_16x16x32_bf16 a[116:119], v[160:163], a[252:255], a[116:119]
    buffer_load_dwordx4 v[140:143], v13, s[28:31], s37 offen offset:1024
    v_mfma_f32_16x16x32_bf16 a[148:151], v[160:163], v[248:251], a[148:151]
    ds_read_b128 a[208:211], v15 offset:8192
    v_mfma_f32_16x16x32_bf16 a[24:27], v[152:155], a[240:243], a[24:27]
    v_perm_b32 v156, v207, v203, s43
    v_perm_b32 v157, v215, v211, s43
    v_mfma_f32_16x16x32_bf16 a[56:59], v[152:155], a[244:247], a[56:59]
    v_perm_b32 v158, v223, v219, s43
    v_perm_b32 v159, v231, v227, s43
    v_mfma_f32_16x16x32_bf16 a[88:91], v[152:155], a[248:251], a[88:91]
    v_mfma_f32_16x16x32_bf16 a[120:123], v[152:155], a[252:255], a[120:123]
    buffer_load_dwordx4 v[144:147], v13, s[28:31], s37 offen offset:2048
    v_mfma_f32_16x16x32_bf16 a[152:155], v[152:155], v[248:251], a[152:155]
    ds_read_b128 a[212:215], v15 offset:12288
    v_mfma_f32_16x16x32_bf16 a[28:31], v[156:159], a[240:243], a[28:31]
    s_waitcnt vmcnt(23)
    v_perm_b32 v160, v28, v24, s42
    v_perm_b32 v161, v36, v32, s42
    v_mfma_f32_16x16x32_bf16 a[60:63], v[156:159], a[244:247], a[60:63]
    v_perm_b32 v162, v44, v40, s42
    v_perm_b32 v163, v52, v48, s42
    v_mfma_f32_16x16x32_bf16 a[92:95], v[156:159], a[248:251], a[92:95]
    v_mfma_f32_16x16x32_bf16 a[124:127], v[156:159], a[252:255], a[124:127]
    buffer_load_dwordx4 v[148:151], v13, s[28:31], s37 offen offset:3072
    v_mfma_f32_16x16x32_bf16 a[156:159], v[156:159], v[248:251], a[156:159]
    ds_read_b128 a[216:219], v15 offset:16384
    s_waitcnt lgkmcnt(10)
    v_mfma_f32_16x16x32_bf16 a[0:3], v[160:163], a[160:163], a[0:3]
    v_perm_b32 v152, v28, v24, s43
    v_perm_b32 v153, v36, v32, s43
    v_mfma_f32_16x16x32_bf16 a[32:35], v[160:163], a[164:167], a[32:35]
    v_perm_b32 v154, v44, v40, s43
    v_perm_b32 v155, v52, v48, s43
    v_mfma_f32_16x16x32_bf16 a[64:67], v[160:163], a[168:171], a[64:67]
    v_mfma_f32_16x16x32_bf16 a[96:99], v[160:163], a[172:175], a[96:99]
    s_add_u32 s37, s87, s90
    buffer_load_dwordx4 v[200:203], v12, s[28:31], s37 offen
    v_mfma_f32_16x16x32_bf16 a[128:131], v[160:163], a[176:179], a[128:131]
    v_xor_b32 v15, s97, v246
    ds_read_b128 a[220:223], v15
    ds_read_b128 a[224:227], v15 offset:4096
    v_mfma_f32_16x16x32_bf16 a[4:7], v[152:155], a[160:163], a[4:7]
    v_perm_b32 v156, v29, v25, s42
    v_perm_b32 v157, v37, v33, s42
    v_mfma_f32_16x16x32_bf16 a[36:39], v[152:155], a[164:167], a[36:39]
    v_perm_b32 v158, v45, v41, s42
    v_perm_b32 v159, v53, v49, s42
    v_mfma_f32_16x16x32_bf16 a[68:71], v[152:155], a[168:171], a[68:71]
    v_mfma_f32_16x16x32_bf16 a[100:103], v[152:155], a[172:175], a[100:103]
    buffer_load_dwordx4 v[204:207], v12, s[28:31], s37 offen offset:1024
    v_mfma_f32_16x16x32_bf16 a[132:135], v[152:155], a[176:179], a[132:135]
    ds_read_b128 a[228:231], v15 offset:8192
    v_mfma_f32_16x16x32_bf16 a[8:11], v[156:159], a[160:163], a[8:11]
    v_perm_b32 v160, v29, v25, s43
    v_perm_b32 v161, v37, v33, s43
    v_mfma_f32_16x16x32_bf16 a[40:43], v[156:159], a[164:167], a[40:43]
    v_perm_b32 v162, v45, v41, s43
    v_perm_b32 v163, v53, v49, s43
    v_mfma_f32_16x16x32_bf16 a[72:75], v[156:159], a[168:171], a[72:75]
    v_mfma_f32_16x16x32_bf16 a[104:107], v[156:159], a[172:175], a[104:107]
    buffer_load_dwordx4 v[208:211], v12, s[28:31], s37 offen offset:2048
    v_mfma_f32_16x16x32_bf16 a[136:139], v[156:159], a[176:179], a[136:139]
    ds_read_b128 a[232:235], v15 offset:12288
    v_mfma_f32_16x16x32_bf16 a[12:15], v[160:163], a[160:163], a[12:15]
    v_perm_b32 v152, v30, v26, s42
    v_perm_b32 v153, v38, v34, s42
    v_mfma_f32_16x16x32_bf16 a[44:47], v[160:163], a[164:167], a[44:47]
    v_perm_b32 v154, v46, v42, s42
    v_perm_b32 v155, v54, v50, s42
    v_mfma_f32_16x16x32_bf16 a[76:79], v[160:163], a[168:171], a[76:79]
    v_mfma_f32_16x16x32_bf16 a[108:111], v[160:163], a[172:175], a[108:111]
    buffer_load_dwordx4 v[212:215], v12, s[28:31], s37 offen offset:3072
    v_mfma_f32_16x16x32_bf16 a[140:143], v[160:163], a[176:179], a[140:143]
    ds_read_b128 a[236:239], v15 offset:16384
    v_mfma_f32_16x16x32_bf16 a[16:19], v[152:155], a[160:163], a[16:19]
    v_perm_b32 v156, v30, v26, s43
    v_perm_b32 v157, v38, v34, s43
    v_mfma_f32_16x16x32_bf16 a[48:51], v[152:155], a[164:167], a[48:51]
    v_perm_b32 v158, v46, v42, s43
    v_perm_b32 v159, v54, v50, s43
    v_mfma_f32_16x16x32_bf16 a[80:83], v[152:155], a[168:171], a[80:83]
    v_mfma_f32_16x16x32_bf16 a[112:115], v[152:155], a[172:175], a[112:115]
    buffer_load_dwordx4 v[216:219], v13, s[28:31], s37 offen
    v_mfma_f32_16x16x32_bf16 a[144:147], v[152:155], a[176:179], a[144:147]
    v_xor_b32 v15, s98, v246
    ds_read_b128 a[240:243], v15
    ds_read_b128 a[244:247], v15 offset:4096
    v_mfma_f32_16x16x32_bf16 a[20:23], v[156:159], a[160:163], a[20:23]
    v_perm_b32 v160, v31, v27, s42
    v_perm_b32 v161, v39, v35, s42
    v_mfma_f32_16x16x32_bf16 a[52:55], v[156:159], a[164:167], a[52:55]
    v_perm_b32 v162, v47, v43, s42
    v_perm_b32 v163, v55, v51, s42
    v_mfma_f32_16x16x32_bf16 a[84:87], v[156:159], a[168:171], a[84:87]
    v_mfma_f32_16x16x32_bf16 a[116:119], v[156:159], a[172:175], a[116:119]
    buffer_load_dwordx4 v[220:223], v13, s[28:31], s37 offen offset:1024
    v_mfma_f32_16x16x32_bf16 a[148:151], v[156:159], a[176:179], a[148:151]
    ds_read_b128 a[248:251], v15 offset:8192
    v_mfma_f32_16x16x32_bf16 a[24:27], v[160:163], a[160:163], a[24:27]
    v_perm_b32 v152, v31, v27, s43
    v_perm_b32 v153, v39, v35, s43
    v_mfma_f32_16x16x32_bf16 a[56:59], v[160:163], a[164:167], a[56:59]
    v_perm_b32 v154, v47, v43, s43
    v_perm_b32 v155, v55, v51, s43
    v_mfma_f32_16x16x32_bf16 a[88:91], v[160:163], a[168:171], a[88:91]
    v_mfma_f32_16x16x32_bf16 a[120:123], v[160:163], a[172:175], a[120:123]
    buffer_load_dwordx4 v[224:227], v13, s[28:31], s37 offen offset:2048
    v_mfma_f32_16x16x32_bf16 a[152:155], v[160:163], a[176:179], a[152:155]
    ds_read_b128 a[252:255], v15 offset:12288
    v_mfma_f32_16x16x32_bf16 a[28:31], v[152:155], a[160:163], a[28:31]
    s_waitcnt vmcnt(23)
    v_perm_b32 v156, v60, v56, s42
    v_perm_b32 v157, v68, v64, s42
    v_mfma_f32_16x16x32_bf16 a[60:63], v[152:155], a[164:167], a[60:63]
    v_perm_b32 v158, v76, v72, s42
    v_perm_b32 v159, v84, v80, s42
    v_mfma_f32_16x16x32_bf16 a[92:95], v[152:155], a[168:171], a[92:95]
    v_mfma_f32_16x16x32_bf16 a[124:127], v[152:155], a[172:175], a[124:127]
    buffer_load_dwordx4 v[228:231], v13, s[28:31], s37 offen offset:3072
    v_mfma_f32_16x16x32_bf16 a[156:159], v[152:155], a[176:179], a[156:159]
    ds_read_b128 v[248:251], v15 offset:16384
    s_waitcnt lgkmcnt(15)
    v_mfma_f32_16x16x32_bf16 a[0:3], v[156:159], a[180:183], a[0:3]
    s_waitcnt vmcnt(16)
    v_perm_b32 v160, v92, v88, s42
    v_perm_b32 v161, v100, v96, s42
    v_mfma_f32_16x16x32_bf16 a[32:35], v[156:159], a[184:187], a[32:35]
    v_perm_b32 v162, v108, v104, s42
    v_perm_b32 v163, v116, v112, s42
    v_mfma_f32_16x16x32_bf16 a[64:67], v[156:159], a[188:191], a[64:67]
    v_xor_b32 v15, s99, v246
    ds_read_b128 a[160:163], v15
    s_add_u32 s37, s87, s91
    buffer_load_dwordx4 v[24:27], v12, s[28:31], s37 offen
    v_mfma_f32_16x16x32_bf16 a[96:99], v[156:159], a[192:195], a[96:99]
    ds_read_b128 a[164:167], v15 offset:4096
    ds_read_b128 a[168:171], v15 offset:8192
    buffer_load_dwordx4 v[28:31], v12, s[28:31], s37 offen offset:1024
    v_mfma_f32_16x16x32_bf16 a[128:131], v[156:159], a[196:199], a[128:131]
    ds_read_b128 a[172:175], v15 offset:12288
    ds_read_b128 a[176:179], v15 offset:16384
    buffer_load_dwordx4 v[32:35], v12, s[28:31], s37 offen offset:2048
    s_waitcnt lgkmcnt(15)
    v_mfma_f32_16x16x32_bf16 a[0:3], v[160:163], a[200:203], a[0:3]
    s_waitcnt vmcnt(11)
    v_perm_b32 v152, v124, v120, s42
    v_perm_b32 v153, v132, v128, s42
    v_mfma_f32_16x16x32_bf16 a[32:35], v[160:163], a[204:207], a[32:35]
    v_perm_b32 v154, v140, v136, s42
    v_perm_b32 v155, v148, v144, s42
    v_mfma_f32_16x16x32_bf16 a[64:67], v[160:163], a[208:211], a[64:67]
    buffer_load_dwordx4 v[36:39], v12, s[28:31], s37 offen offset:3072
    v_mfma_f32_16x16x32_bf16 a[96:99], v[160:163], a[212:215], a[96:99]
    buffer_load_dwordx4 v[40:43], v13, s[28:31], s37 offen
    v_mfma_f32_16x16x32_bf16 a[128:131], v[160:163], a[216:219], a[128:131]
    buffer_load_dwordx4 v[44:47], v13, s[28:31], s37 offen offset:1024
    s_waitcnt lgkmcnt(10)
    v_mfma_f32_16x16x32_bf16 a[0:3], v[152:155], a[220:223], a[0:3]
    s_waitcnt vmcnt(6)
    v_perm_b32 v156, v204, v200, s42
    v_perm_b32 v157, v212, v208, s42
    v_mfma_f32_16x16x32_bf16 a[32:35], v[152:155], a[224:227], a[32:35]
    v_perm_b32 v158, v220, v216, s42
    v_perm_b32 v159, v228, v224, s42
    v_mfma_f32_16x16x32_bf16 a[64:67], v[152:155], a[228:231], a[64:67]
    buffer_load_dwordx4 v[48:51], v13, s[28:31], s37 offen offset:2048
    v_mfma_f32_16x16x32_bf16 a[96:99], v[152:155], a[232:235], a[96:99]
    buffer_load_dwordx4 v[52:55], v13, s[28:31], s37 offen offset:3072
    v_mfma_f32_16x16x32_bf16 a[128:131], v[152:155], a[236:239], a[128:131]
    s_waitcnt lgkmcnt(5)
    v_mfma_f32_16x16x32_bf16 a[0:3], v[156:159], a[240:243], a[0:3]
    v_perm_b32 v160, v60, v56, s43
    v_perm_b32 v161, v68, v64, s43
    v_mfma_f32_16x16x32_bf16 a[32:35], v[156:159], a[244:247], a[32:35]
    v_perm_b32 v162, v76, v72, s43
    v_perm_b32 v163, v84, v80, s43
    v_mfma_f32_16x16x32_bf16 a[64:67], v[156:159], a[248:251], a[64:67]
    v_mfma_f32_16x16x32_bf16 a[96:99], v[156:159], a[252:255], a[96:99]
    v_mfma_f32_16x16x32_bf16 a[128:131], v[156:159], v[248:251], a[128:131]
    v_mfma_f32_16x16x32_bf16 a[4:7], v[160:163], a[180:183], a[4:7]
    v_perm_b32 v152, v92, v88, s43
    v_perm_b32 v153, v100, v96, s43
    v_mfma_f32_16x16x32_bf16 a[36:39], v[160:163], a[184:187], a[36:39]
    v_perm_b32 v154, v108, v104, s43
    v_perm_b32 v155, v116, v112, s43
    v_mfma_f32_16x16x32_bf16 a[68:71], v[160:163], a[188:191], a[68:71]
    v_mfma_f32_16x16x32_bf16 a[100:103], v[160:163], a[192:195], a[100:103]
    v_mfma_f32_16x16x32_bf16 a[132:135], v[160:163], a[196:199], a[132:135]
    v_mfma_f32_16x16x32_bf16 a[4:7], v[152:155], a[200:203], a[4:7]
    v_perm_b32 v156, v124, v120, s43
    v_perm_b32 v157, v132, v128, s43
    v_mfma_f32_16x16x32_bf16 a[36:39], v[152:155], a[204:207], a[36:39]
    v_perm_b32 v158, v140, v136, s43
    v_perm_b32 v159, v148, v144, s43
    v_mfma_f32_16x16x32_bf16 a[68:71], v[152:155], a[208:211], a[68:71]
    v_mfma_f32_16x16x32_bf16 a[100:103], v[152:155], a[212:215], a[100:103]
    v_mfma_f32_16x16x32_bf16 a[132:135], v[152:155], a[216:219], a[132:135]
    v_mfma_f32_16x16x32_bf16 a[4:7], v[156:159], a[220:223], a[4:7]
    v_perm_b32 v160, v204, v200, s43
    v_perm_b32 v161, v212, v208, s43
    v_mfma_f32_16x16x32_bf16 a[36:39], v[156:159], a[224:227], a[36:39]
    v_perm_b32 v162, v220, v216, s43
    v_perm_b32 v163, v228, v224, s43
    v_mfma_f32_16x16x32_bf16 a[68:71], v[156:159], a[228:231], a[68:71]
    v_mfma_f32_16x16x32_bf16 a[100:103], v[156:159], a[232:235], a[100:103]
    v_mfma_f32_16x16x32_bf16 a[132:135], v[156:159], a[236:239], a[132:135]
    v_mfma_f32_16x16x32_bf16 a[4:7], v[160:163], a[240:243], a[4:7]
    s_waitcnt vmcnt(0)
    v_perm_b32 v152, v28, v24, s42
    v_perm_b32 v153, v36, v32, s42
    v_mfma_f32_16x16x32_bf16 a[36:39], v[160:163], a[244:247], a[36:39]
    v_perm_b32 v154, v44, v40, s42
    v_perm_b32 v155, v52, v48, s42
    v_mfma_f32_16x16x32_bf16 a[68:71], v[160:163], a[248:251], a[68:71]
    v_mfma_f32_16x16x32_bf16 a[100:103], v[160:163], a[252:255], a[100:103]
    v_mfma_f32_16x16x32_bf16 a[132:135], v[160:163], v[248:251], a[132:135]
    s_waitcnt lgkmcnt(0)
    v_mfma_f32_16x16x32_bf16 a[0:3], v[152:155], a[160:163], a[0:3]
    v_perm_b32 v156, v28, v24, s43
    v_perm_b32 v157, v36, v32, s43
    v_mfma_f32_16x16x32_bf16 a[32:35], v[152:155], a[164:167], a[32:35]
    v_perm_b32 v158, v44, v40, s43
    v_perm_b32 v159, v52, v48, s43
    v_mfma_f32_16x16x32_bf16 a[64:67], v[152:155], a[168:171], a[64:67]
    v_mfma_f32_16x16x32_bf16 a[96:99], v[152:155], a[172:175], a[96:99]
    v_mfma_f32_16x16x32_bf16 a[128:131], v[152:155], a[176:179], a[128:131]
    v_mfma_f32_16x16x32_bf16 a[4:7], v[156:159], a[160:163], a[4:7]
    v_perm_b32 v160, v61, v57, s42
    v_perm_b32 v161, v69, v65, s42
    v_mfma_f32_16x16x32_bf16 a[36:39], v[156:159], a[164:167], a[36:39]
    v_perm_b32 v162, v77, v73, s42
    v_perm_b32 v163, v85, v81, s42
    v_mfma_f32_16x16x32_bf16 a[68:71], v[156:159], a[168:171], a[68:71]
    v_mfma_f32_16x16x32_bf16 a[100:103], v[156:159], a[172:175], a[100:103]
    v_mfma_f32_16x16x32_bf16 a[132:135], v[156:159], a[176:179], a[132:135]
    v_mfma_f32_16x16x32_bf16 a[8:11], v[160:163], a[180:183], a[8:11]
    v_perm_b32 v152, v93, v89, s42
    v_perm_b32 v153, v101, v97, s42
    v_mfma_f32_16x16x32_bf16 a[40:43], v[160:163], a[184:187], a[40:43]
    v_perm_b32 v154, v109, v105, s42
    v_perm_b32 v155, v117, v113, s42
    v_mfma_f32_16x16x32_bf16 a[72:75], v[160:163], a[188:191], a[72:75]
    v_mfma_f32_16x16x32_bf16 a[104:107], v[160:163], a[192:195], a[104:107]
    v_accvgpr_read_b32 v164, a0
    v_accvgpr_read_b32 v165, a4
    v_accvgpr_read_b32 v166, a1
    v_mfma_f32_16x16x32_bf16 a[136:139], v[160:163], a[196:199], a[136:139]
    v_accvgpr_read_b32 v167, a5
    v_cvt_pk_bf16_f32 v176, v164, v165
    v_mfma_f32_16x16x32_bf16 a[8:11], v[152:155], a[200:203], a[8:11]
    v_perm_b32 v156, v125, v121, s42
    v_perm_b32 v157, v133, v129, s42
    v_mfma_f32_16x16x32_bf16 a[40:43], v[152:155], a[204:207], a[40:43]
    v_perm_b32 v158, v141, v137, s42
    v_perm_b32 v159, v149, v145, s42
    v_mfma_f32_16x16x32_bf16 a[72:75], v[152:155], a[208:211], a[72:75]
    v_cvt_pk_bf16_f32 v177, v166, v167
    v_accvgpr_read_b32 v168, a2
    v_accvgpr_read_b32 v169, a6
    v_mfma_f32_16x16x32_bf16 a[104:107], v[152:155], a[212:215], a[104:107]
    v_accvgpr_read_b32 v170, a3
    v_accvgpr_read_b32 v171, a7
    v_mfma_f32_16x16x32_bf16 a[136:139], v[152:155], a[216:219], a[136:139]
    v_cvt_pk_bf16_f32 v178, v168, v169
    v_cvt_pk_bf16_f32 v179, v170, v171
    buffer_store_dwordx4 v[176:179], v232, s[16:19], s70 offen sc1
    v_mfma_f32_16x16x32_bf16 a[8:11], v[156:159], a[220:223], a[8:11]
    v_perm_b32 v160, v205, v201, s42
    v_perm_b32 v161, v213, v209, s42
    v_mfma_f32_16x16x32_bf16 a[40:43], v[156:159], a[224:227], a[40:43]
    v_perm_b32 v162, v221, v217, s42
    v_perm_b32 v163, v229, v225, s42
    v_mfma_f32_16x16x32_bf16 a[72:75], v[156:159], a[228:231], a[72:75]
    ds_write_b128 v237, v[176:179]
    v_accvgpr_read_b32 v172, a32
    v_mfma_f32_16x16x32_bf16 a[104:107], v[156:159], a[232:235], a[104:107]
    v_accvgpr_read_b32 v173, a36
    v_accvgpr_read_b32 v174, a33
    v_mfma_f32_16x16x32_bf16 a[136:139], v[156:159], a[236:239], a[136:139]
    v_accvgpr_read_b32 v175, a37
    v_cvt_pk_bf16_f32 v180, v172, v173
    v_cvt_pk_bf16_f32 v181, v174, v175
    v_mfma_f32_16x16x32_bf16 a[8:11], v[160:163], a[240:243], a[8:11]
    v_perm_b32 v152, v29, v25, s42
    v_perm_b32 v153, v37, v33, s42
    v_mfma_f32_16x16x32_bf16 a[40:43], v[160:163], a[244:247], a[40:43]
    v_perm_b32 v154, v45, v41, s42
    v_perm_b32 v155, v53, v49, s42
    v_mfma_f32_16x16x32_bf16 a[72:75], v[160:163], a[248:251], a[72:75]
    v_accvgpr_read_b32 v164, a34
    v_accvgpr_read_b32 v165, a38
    v_mfma_f32_16x16x32_bf16 a[104:107], v[160:163], a[252:255], a[104:107]
    v_accvgpr_read_b32 v166, a35
    v_accvgpr_read_b32 v167, a39
    v_cvt_pk_bf16_f32 v182, v164, v165
    v_mfma_f32_16x16x32_bf16 a[136:139], v[160:163], v[248:251], a[136:139]
    v_cvt_pk_bf16_f32 v183, v166, v167
    buffer_store_dwordx4 v[180:183], v233, s[16:19], s71 offen sc1
    v_mfma_f32_16x16x32_bf16 a[8:11], v[152:155], a[160:163], a[8:11]
    v_perm_b32 v156, v61, v57, s43
    v_perm_b32 v157, v69, v65, s43
    v_mfma_f32_16x16x32_bf16 a[40:43], v[152:155], a[164:167], a[40:43]
    v_perm_b32 v158, v77, v73, s43
    v_perm_b32 v159, v85, v81, s43
    v_mfma_f32_16x16x32_bf16 a[72:75], v[152:155], a[168:171], a[72:75]
    ds_write_b128 v238, v[180:183]
    v_accvgpr_read_b32 v168, a64
    v_mfma_f32_16x16x32_bf16 a[104:107], v[152:155], a[172:175], a[104:107]
    v_accvgpr_read_b32 v169, a68
    v_accvgpr_read_b32 v170, a65
    v_accvgpr_read_b32 v171, a69
    v_mfma_f32_16x16x32_bf16 a[136:139], v[152:155], a[176:179], a[136:139]
    v_cvt_pk_bf16_f32 v184, v168, v169
    v_cvt_pk_bf16_f32 v185, v170, v171
    v_mfma_f32_16x16x32_bf16 a[12:15], v[156:159], a[180:183], a[12:15]
    v_perm_b32 v160, v93, v89, s43
    v_perm_b32 v161, v101, v97, s43
    v_mfma_f32_16x16x32_bf16 a[44:47], v[156:159], a[184:187], a[44:47]
    v_perm_b32 v162, v109, v105, s43
    v_perm_b32 v163, v117, v113, s43
    v_mfma_f32_16x16x32_bf16 a[76:79], v[156:159], a[188:191], a[76:79]
    v_accvgpr_read_b32 v172, a66
    v_accvgpr_read_b32 v173, a70
    v_accvgpr_read_b32 v174, a67
    v_mfma_f32_16x16x32_bf16 a[108:111], v[156:159], a[192:195], a[108:111]
    v_accvgpr_read_b32 v175, a71
    v_cvt_pk_bf16_f32 v186, v172, v173
    v_mfma_f32_16x16x32_bf16 a[140:143], v[156:159], a[196:199], a[140:143]
    v_cvt_pk_bf16_f32 v187, v174, v175
    buffer_store_dwordx4 v[184:187], v234, s[16:19], s72 offen sc1
    ds_write_b128 v239, v[184:187]
    v_mfma_f32_16x16x32_bf16 a[12:15], v[160:163], a[200:203], a[12:15]
    v_perm_b32 v152, v125, v121, s43
    v_perm_b32 v153, v133, v129, s43
    v_mfma_f32_16x16x32_bf16 a[44:47], v[160:163], a[204:207], a[44:47]
    v_perm_b32 v154, v141, v137, s43
    v_perm_b32 v155, v149, v145, s43
    v_mfma_f32_16x16x32_bf16 a[76:79], v[160:163], a[208:211], a[76:79]
    v_accvgpr_read_b32 v164, a96
    v_accvgpr_read_b32 v165, a100
    v_mfma_f32_16x16x32_bf16 a[108:111], v[160:163], a[212:215], a[108:111]
    v_accvgpr_read_b32 v166, a97
    v_accvgpr_read_b32 v167, a101
    v_mfma_f32_16x16x32_bf16 a[140:143], v[160:163], a[216:219], a[140:143]
    v_cvt_pk_bf16_f32 v188, v164, v165
    v_cvt_pk_bf16_f32 v189, v166, v167
    v_accvgpr_read_b32 v168, a98
    v_mfma_f32_16x16x32_bf16 a[12:15], v[152:155], a[220:223], a[12:15]
    v_perm_b32 v156, v205, v201, s43
    v_perm_b32 v157, v213, v209, s43
    v_mfma_f32_16x16x32_bf16 a[44:47], v[152:155], a[224:227], a[44:47]
    v_perm_b32 v158, v221, v217, s43
    v_perm_b32 v159, v229, v225, s43
    v_mfma_f32_16x16x32_bf16 a[76:79], v[152:155], a[228:231], a[76:79]
    v_accvgpr_read_b32 v169, a102
    v_accvgpr_read_b32 v170, a99
    v_mfma_f32_16x16x32_bf16 a[108:111], v[152:155], a[232:235], a[108:111]
    v_accvgpr_read_b32 v171, a103
    v_cvt_pk_bf16_f32 v190, v168, v169
    v_cvt_pk_bf16_f32 v191, v170, v171
    v_mfma_f32_16x16x32_bf16 a[140:143], v[152:155], a[236:239], a[140:143]
    buffer_store_dwordx4 v[188:191], v235, s[16:19], s73 offen sc1
    ds_write_b128 v240, v[188:191]
    v_mfma_f32_16x16x32_bf16 a[12:15], v[156:159], a[240:243], a[12:15]
    v_perm_b32 v160, v29, v25, s43
    v_perm_b32 v161, v37, v33, s43
    v_mfma_f32_16x16x32_bf16 a[44:47], v[156:159], a[244:247], a[44:47]
    v_perm_b32 v162, v45, v41, s43
    v_perm_b32 v163, v53, v49, s43
    v_mfma_f32_16x16x32_bf16 a[76:79], v[156:159], a[248:251], a[76:79]
    v_accvgpr_read_b32 v172, a128
    v_accvgpr_read_b32 v173, a132
    v_mfma_f32_16x16x32_bf16 a[108:111], v[156:159], a[252:255], a[108:111]
    v_accvgpr_read_b32 v174, a129
    v_accvgpr_read_b32 v175, a133
    v_cvt_pk_bf16_f32 v192, v172, v173
    v_mfma_f32_16x16x32_bf16 a[140:143], v[156:159], v[248:251], a[140:143]
    v_cvt_pk_bf16_f32 v193, v174, v175
    v_accvgpr_read_b32 v164, a130
    v_mfma_f32_16x16x32_bf16 a[12:15], v[160:163], a[160:163], a[12:15]
    v_perm_b32 v152, v62, v58, s42
    v_perm_b32 v153, v70, v66, s42
    v_mfma_f32_16x16x32_bf16 a[44:47], v[160:163], a[164:167], a[44:47]
    v_perm_b32 v154, v78, v74, s42
    v_perm_b32 v155, v86, v82, s42
    v_mfma_f32_16x16x32_bf16 a[76:79], v[160:163], a[168:171], a[76:79]
    v_accvgpr_read_b32 v165, a134
    v_accvgpr_read_b32 v166, a131
    v_accvgpr_read_b32 v167, a135
    v_mfma_f32_16x16x32_bf16 a[108:111], v[160:163], a[172:175], a[108:111]
    v_cvt_pk_bf16_f32 v194, v164, v165
    v_cvt_pk_bf16_f32 v195, v166, v167
    v_mfma_f32_16x16x32_bf16 a[140:143], v[160:163], a[176:179], a[140:143]
    buffer_store_dwordx4 v[192:195], v236, s[16:19], s74 offen sc1
    ds_write_b128 v241, v[192:195]
    v_mfma_f32_16x16x32_bf16 a[16:19], v[152:155], a[180:183], a[16:19]
    v_perm_b32 v156, v94, v90, s42
    v_perm_b32 v157, v102, v98, s42
    v_mfma_f32_16x16x32_bf16 a[48:51], v[152:155], a[184:187], a[48:51]
    v_perm_b32 v158, v110, v106, s42
    v_perm_b32 v159, v118, v114, s42
    v_mfma_f32_16x16x32_bf16 a[80:83], v[152:155], a[188:191], a[80:83]
    v_mfma_f32_16x16x32_bf16 a[112:115], v[152:155], a[192:195], a[112:115]
    v_accvgpr_read_b32 v164, a8
    v_accvgpr_read_b32 v165, a12
    v_accvgpr_read_b32 v166, a9
    v_mfma_f32_16x16x32_bf16 a[144:147], v[152:155], a[196:199], a[144:147]
    v_accvgpr_read_b32 v167, a13
    v_cvt_pk_bf16_f32 v196, v164, v165
    v_cvt_pk_bf16_f32 v197, v166, v167
    v_mfma_f32_16x16x32_bf16 a[16:19], v[156:159], a[200:203], a[16:19]
    v_perm_b32 v160, v126, v122, s42
    v_perm_b32 v161, v134, v130, s42
    v_mfma_f32_16x16x32_bf16 a[48:51], v[156:159], a[204:207], a[48:51]
    v_perm_b32 v162, v142, v138, s42
    v_perm_b32 v163, v150, v146, s42
    v_mfma_f32_16x16x32_bf16 a[80:83], v[156:159], a[208:211], a[80:83]
    v_accvgpr_read_b32 v168, a10
    v_accvgpr_read_b32 v169, a14
    v_mfma_f32_16x16x32_bf16 a[112:115], v[156:159], a[212:215], a[112:115]
    v_accvgpr_read_b32 v170, a11
    v_accvgpr_read_b32 v171, a15
    v_cvt_pk_bf16_f32 v198, v168, v169
    v_mfma_f32_16x16x32_bf16 a[144:147], v[156:159], a[216:219], a[144:147]
    v_cvt_pk_bf16_f32 v199, v170, v171
    buffer_store_dwordx4 v[196:199], v232, s[16:19], s70 offen offset:1024 sc1
    v_mfma_f32_16x16x32_bf16 a[16:19], v[160:163], a[220:223], a[16:19]
    v_perm_b32 v152, v206, v202, s42
    v_perm_b32 v153, v214, v210, s42
    v_mfma_f32_16x16x32_bf16 a[48:51], v[160:163], a[224:227], a[48:51]
    v_perm_b32 v154, v222, v218, s42
    v_perm_b32 v155, v230, v226, s42
    v_mfma_f32_16x16x32_bf16 a[80:83], v[160:163], a[228:231], a[80:83]
    ds_write_b128 v237, v[196:199] offset:256
    s_waitcnt lgkmcnt(5)
    v_accvgpr_read_b32 v172, a40
    v_mfma_f32_16x16x32_bf16 a[112:115], v[160:163], a[232:235], a[112:115]
    v_accvgpr_read_b32 v173, a44
    v_accvgpr_read_b32 v174, a41
    v_mfma_f32_16x16x32_bf16 a[144:147], v[160:163], a[236:239], a[144:147]
    v_accvgpr_read_b32 v175, a45
    v_cvt_pk_bf16_f32 v176, v172, v173
    v_cvt_pk_bf16_f32 v177, v174, v175
    v_mfma_f32_16x16x32_bf16 a[16:19], v[152:155], a[240:243], a[16:19]
    v_perm_b32 v156, v30, v26, s42
    v_perm_b32 v157, v38, v34, s42
    v_mfma_f32_16x16x32_bf16 a[48:51], v[152:155], a[244:247], a[48:51]
    v_perm_b32 v158, v46, v42, s42
    v_perm_b32 v159, v54, v50, s42
    v_mfma_f32_16x16x32_bf16 a[80:83], v[152:155], a[248:251], a[80:83]
    v_accvgpr_read_b32 v164, a42
    v_accvgpr_read_b32 v165, a46
    v_mfma_f32_16x16x32_bf16 a[112:115], v[152:155], a[252:255], a[112:115]
    v_accvgpr_read_b32 v166, a43
    v_accvgpr_read_b32 v167, a47
    v_cvt_pk_bf16_f32 v178, v164, v165
    v_mfma_f32_16x16x32_bf16 a[144:147], v[152:155], v[248:251], a[144:147]
    v_cvt_pk_bf16_f32 v179, v166, v167
    buffer_store_dwordx4 v[176:179], v233, s[16:19], s71 offen offset:1024 sc1
    ds_write_b128 v238, v[176:179] offset:256
    v_mfma_f32_16x16x32_bf16 a[16:19], v[156:159], a[160:163], a[16:19]
    v_perm_b32 v160, v62, v58, s43
    v_perm_b32 v161, v70, v66, s43
    v_mfma_f32_16x16x32_bf16 a[48:51], v[156:159], a[164:167], a[48:51]
    v_perm_b32 v162, v78, v74, s43
    v_perm_b32 v163, v86, v82, s43
    v_mfma_f32_16x16x32_bf16 a[80:83], v[156:159], a[168:171], a[80:83]
    s_waitcnt lgkmcnt(5)
    v_accvgpr_read_b32 v168, a72
    v_mfma_f32_16x16x32_bf16 a[112:115], v[156:159], a[172:175], a[112:115]
    v_accvgpr_read_b32 v169, a76
    v_accvgpr_read_b32 v170, a73
    v_accvgpr_read_b32 v171, a77
    v_mfma_f32_16x16x32_bf16 a[144:147], v[156:159], a[176:179], a[144:147]
    v_cvt_pk_bf16_f32 v180, v168, v169
    v_cvt_pk_bf16_f32 v181, v170, v171
    v_mfma_f32_16x16x32_bf16 a[20:23], v[160:163], a[180:183], a[20:23]
    v_perm_b32 v152, v94, v90, s43
    v_perm_b32 v153, v102, v98, s43
    v_mfma_f32_16x16x32_bf16 a[52:55], v[160:163], a[184:187], a[52:55]
    v_perm_b32 v154, v110, v106, s43
    v_perm_b32 v155, v118, v114, s43
    v_mfma_f32_16x16x32_bf16 a[84:87], v[160:163], a[188:191], a[84:87]
    v_accvgpr_read_b32 v172, a74
    v_accvgpr_read_b32 v173, a78
    v_accvgpr_read_b32 v174, a75
    v_mfma_f32_16x16x32_bf16 a[116:119], v[160:163], a[192:195], a[116:119]
    v_accvgpr_read_b32 v175, a79
    v_cvt_pk_bf16_f32 v182, v172, v173
    v_mfma_f32_16x16x32_bf16 a[148:151], v[160:163], a[196:199], a[148:151]
    v_cvt_pk_bf16_f32 v183, v174, v175
    buffer_store_dwordx4 v[180:183], v234, s[16:19], s72 offen offset:1024 sc1
    ds_write_b128 v239, v[180:183] offset:256
    v_mfma_f32_16x16x32_bf16 a[20:23], v[152:155], a[200:203], a[20:23]
    v_perm_b32 v156, v126, v122, s43
    v_perm_b32 v157, v134, v130, s43
    v_mfma_f32_16x16x32_bf16 a[52:55], v[152:155], a[204:207], a[52:55]
    v_perm_b32 v158, v142, v138, s43
    v_perm_b32 v159, v150, v146, s43
    v_mfma_f32_16x16x32_bf16 a[84:87], v[152:155], a[208:211], a[84:87]
    s_waitcnt lgkmcnt(5)
    v_accvgpr_read_b32 v164, a104
    v_mfma_f32_16x16x32_bf16 a[116:119], v[152:155], a[212:215], a[116:119]
    v_accvgpr_read_b32 v165, a108
    v_accvgpr_read_b32 v166, a105
    v_accvgpr_read_b32 v167, a109
    v_mfma_f32_16x16x32_bf16 a[148:151], v[152:155], a[216:219], a[148:151]
    v_cvt_pk_bf16_f32 v184, v164, v165
    v_cvt_pk_bf16_f32 v185, v166, v167
    v_accvgpr_read_b32 v168, a106
    v_mfma_f32_16x16x32_bf16 a[20:23], v[156:159], a[220:223], a[20:23]
    v_perm_b32 v160, v206, v202, s43
    v_perm_b32 v161, v214, v210, s43
    v_mfma_f32_16x16x32_bf16 a[52:55], v[156:159], a[224:227], a[52:55]
    v_perm_b32 v162, v222, v218, s43
    v_perm_b32 v163, v230, v226, s43
    v_mfma_f32_16x16x32_bf16 a[84:87], v[156:159], a[228:231], a[84:87]
    v_accvgpr_read_b32 v169, a110
    v_accvgpr_read_b32 v170, a107
    v_mfma_f32_16x16x32_bf16 a[116:119], v[156:159], a[232:235], a[116:119]
    v_accvgpr_read_b32 v171, a111
    v_cvt_pk_bf16_f32 v186, v168, v169
    v_cvt_pk_bf16_f32 v187, v170, v171
    v_mfma_f32_16x16x32_bf16 a[148:151], v[156:159], a[236:239], a[148:151]
    buffer_store_dwordx4 v[184:187], v235, s[16:19], s73 offen offset:1024 sc1
    ds_write_b128 v240, v[184:187] offset:256
    v_mfma_f32_16x16x32_bf16 a[20:23], v[160:163], a[240:243], a[20:23]
    v_perm_b32 v152, v30, v26, s43
    v_perm_b32 v153, v38, v34, s43
    v_mfma_f32_16x16x32_bf16 a[52:55], v[160:163], a[244:247], a[52:55]
    v_perm_b32 v154, v46, v42, s43
    v_perm_b32 v155, v54, v50, s43
    v_mfma_f32_16x16x32_bf16 a[84:87], v[160:163], a[248:251], a[84:87]
    s_waitcnt lgkmcnt(5)
    v_accvgpr_read_b32 v172, a136
    v_accvgpr_read_b32 v173, a140
    v_mfma_f32_16x16x32_bf16 a[116:119], v[160:163], a[252:255], a[116:119]
    v_accvgpr_read_b32 v174, a137
    v_accvgpr_read_b32 v175, a141
    v_mfma_f32_16x16x32_bf16 a[148:151], v[160:163], v[248:251], a[148:151]
    v_cvt_pk_bf16_f32 v188, v172, v173
    v_cvt_pk_bf16_f32 v189, v174, v175
    v_accvgpr_read_b32 v164, a138
    v_mfma_f32_16x16x32_bf16 a[20:23], v[152:155], a[160:163], a[20:23]
    v_perm_b32 v156, v63, v59, s42
    v_perm_b32 v157, v71, v67, s42
    v_mfma_f32_16x16x32_bf16 a[52:55], v[152:155], a[164:167], a[52:55]
    v_perm_b32 v158, v79, v75, s42
    v_perm_b32 v159, v87, v83, s42
    v_mfma_f32_16x16x32_bf16 a[84:87], v[152:155], a[168:171], a[84:87]
    v_accvgpr_read_b32 v165, a142
    v_accvgpr_read_b32 v166, a139
    v_mfma_f32_16x16x32_bf16 a[116:119], v[152:155], a[172:175], a[116:119]
    v_accvgpr_read_b32 v167, a143
    v_cvt_pk_bf16_f32 v190, v164, v165
    v_cvt_pk_bf16_f32 v191, v166, v167
    v_mfma_f32_16x16x32_bf16 a[148:151], v[152:155], a[176:179], a[148:151]
    buffer_store_dwordx4 v[188:191], v236, s[16:19], s74 offen offset:1024 sc1
    ds_write_b128 v241, v[188:191] offset:256
    v_mfma_f32_16x16x32_bf16 a[24:27], v[156:159], a[180:183], a[24:27]
    v_perm_b32 v160, v95, v91, s42
    v_perm_b32 v161, v103, v99, s42
    v_mfma_f32_16x16x32_bf16 a[56:59], v[156:159], a[184:187], a[56:59]
    v_perm_b32 v162, v111, v107, s42
    v_perm_b32 v163, v119, v115, s42
    v_mfma_f32_16x16x32_bf16 a[88:91], v[156:159], a[188:191], a[88:91]
    v_mfma_f32_16x16x32_bf16 a[120:123], v[156:159], a[192:195], a[120:123]
    s_waitcnt lgkmcnt(5)
    v_accvgpr_read_b32 v164, a16
    v_accvgpr_read_b32 v165, a20
    v_mfma_f32_16x16x32_bf16 a[152:155], v[156:159], a[196:199], a[152:155]
    v_accvgpr_read_b32 v166, a17
    v_accvgpr_read_b32 v167, a21
    v_cvt_pk_bf16_f32 v192, v164, v165
    v_mfma_f32_16x16x32_bf16 a[24:27], v[160:163], a[200:203], a[24:27]
    v_perm_b32 v152, v127, v123, s42
    v_perm_b32 v153, v135, v131, s42
    v_mfma_f32_16x16x32_bf16 a[56:59], v[160:163], a[204:207], a[56:59]
    v_perm_b32 v154, v143, v139, s42
    v_perm_b32 v155, v151, v147, s42
    v_mfma_f32_16x16x32_bf16 a[88:91], v[160:163], a[208:211], a[88:91]
    v_cvt_pk_bf16_f32 v193, v166, v167
    v_accvgpr_read_b32 v168, a18
    v_mfma_f32_16x16x32_bf16 a[120:123], v[160:163], a[212:215], a[120:123]
    v_accvgpr_read_b32 v169, a22
    v_accvgpr_read_b32 v170, a19
    v_accvgpr_read_b32 v171, a23
    v_mfma_f32_16x16x32_bf16 a[152:155], v[160:163], a[216:219], a[152:155]
    v_cvt_pk_bf16_f32 v194, v168, v169
    v_cvt_pk_bf16_f32 v195, v170, v171
    v_mfma_f32_16x16x32_bf16 a[24:27], v[152:155], a[220:223], a[24:27]
    v_perm_b32 v156, v207, v203, s42
    v_perm_b32 v157, v215, v211, s42
    v_mfma_f32_16x16x32_bf16 a[56:59], v[152:155], a[224:227], a[56:59]
    v_perm_b32 v158, v223, v219, s42
    v_perm_b32 v159, v231, v227, s42
    v_mfma_f32_16x16x32_bf16 a[88:91], v[152:155], a[228:231], a[88:91]
    buffer_store_dwordx4 v[192:195], v232, s[16:19], s70 offen offset:2048 sc1
    ds_write_b128 v237, v[192:195] offset:512
    s_waitcnt lgkmcnt(5)
    v_mfma_f32_16x16x32_bf16 a[120:123], v[152:155], a[232:235], a[120:123]
    v_accvgpr_read_b32 v172, a48
    v_accvgpr_read_b32 v173, a52
    v_accvgpr_read_b32 v174, a49
    v_mfma_f32_16x16x32_bf16 a[152:155], v[152:155], a[236:239], a[152:155]
    v_accvgpr_read_b32 v175, a53
    v_cvt_pk_bf16_f32 v196, v172, v173
    v_mfma_f32_16x16x32_bf16 a[24:27], v[156:159], a[240:243], a[24:27]
    v_perm_b32 v160, v31, v27, s42
    v_perm_b32 v161, v39, v35, s42
    v_mfma_f32_16x16x32_bf16 a[56:59], v[156:159], a[244:247], a[56:59]
    v_perm_b32 v162, v47, v43, s42
    v_perm_b32 v163, v55, v51, s42
    v_mfma_f32_16x16x32_bf16 a[88:91], v[156:159], a[248:251], a[88:91]
    v_cvt_pk_bf16_f32 v197, v174, v175
    v_accvgpr_read_b32 v164, a50
    v_accvgpr_read_b32 v165, a54
    v_mfma_f32_16x16x32_bf16 a[120:123], v[156:159], a[252:255], a[120:123]
    v_accvgpr_read_b32 v166, a51
    v_accvgpr_read_b32 v167, a55
    v_mfma_f32_16x16x32_bf16 a[152:155], v[156:159], v[248:251], a[152:155]
    v_cvt_pk_bf16_f32 v198, v164, v165
    v_cvt_pk_bf16_f32 v199, v166, v167
    buffer_store_dwordx4 v[196:199], v233, s[16:19], s71 offen offset:2048 sc1
    v_mfma_f32_16x16x32_bf16 a[24:27], v[160:163], a[160:163], a[24:27]
    v_perm_b32 v152, v63, v59, s43
    v_perm_b32 v153, v71, v67, s43
    v_mfma_f32_16x16x32_bf16 a[56:59], v[160:163], a[164:167], a[56:59]
    v_perm_b32 v154, v79, v75, s43
    v_perm_b32 v155, v87, v83, s43
    v_mfma_f32_16x16x32_bf16 a[88:91], v[160:163], a[168:171], a[88:91]
    ds_write_b128 v238, v[196:199] offset:512
    s_waitcnt lgkmcnt(5)
    v_accvgpr_read_b32 v168, a80
    v_mfma_f32_16x16x32_bf16 a[120:123], v[160:163], a[172:175], a[120:123]
    v_accvgpr_read_b32 v169, a84
    v_accvgpr_read_b32 v170, a81
    v_mfma_f32_16x16x32_bf16 a[152:155], v[160:163], a[176:179], a[152:155]
    v_accvgpr_read_b32 v171, a85
    v_cvt_pk_bf16_f32 v176, v168, v169
    v_cvt_pk_bf16_f32 v177, v170, v171
    v_mfma_f32_16x16x32_bf16 a[28:31], v[152:155], a[180:183], a[28:31]
    v_perm_b32 v156, v95, v91, s43
    v_perm_b32 v157, v103, v99, s43
    v_mfma_f32_16x16x32_bf16 a[60:63], v[152:155], a[184:187], a[60:63]
    v_perm_b32 v158, v111, v107, s43
    v_perm_b32 v159, v119, v115, s43
    v_mfma_f32_16x16x32_bf16 a[92:95], v[152:155], a[188:191], a[92:95]
    v_accvgpr_read_b32 v172, a82
    v_accvgpr_read_b32 v173, a86
    v_mfma_f32_16x16x32_bf16 a[124:127], v[152:155], a[192:195], a[124:127]
    v_accvgpr_read_b32 v174, a83
    v_accvgpr_read_b32 v175, a87
    v_cvt_pk_bf16_f32 v178, v172, v173
    v_mfma_f32_16x16x32_bf16 a[156:159], v[152:155], a[196:199], a[156:159]
    v_cvt_pk_bf16_f32 v179, v174, v175
    buffer_store_dwordx4 v[176:179], v234, s[16:19], s72 offen offset:2048 sc1
    v_mfma_f32_16x16x32_bf16 a[28:31], v[156:159], a[200:203], a[28:31]
    v_perm_b32 v160, v127, v123, s43
    v_perm_b32 v161, v135, v131, s43
    v_mfma_f32_16x16x32_bf16 a[60:63], v[156:159], a[204:207], a[60:63]
    v_perm_b32 v162, v143, v139, s43
    v_perm_b32 v163, v151, v147, s43
    v_mfma_f32_16x16x32_bf16 a[92:95], v[156:159], a[208:211], a[92:95]
    ds_write_b128 v239, v[176:179] offset:512
    s_waitcnt lgkmcnt(5)
    v_accvgpr_read_b32 v164, a112
    v_mfma_f32_16x16x32_bf16 a[124:127], v[156:159], a[212:215], a[124:127]
    v_accvgpr_read_b32 v165, a116
    v_accvgpr_read_b32 v166, a113
    v_accvgpr_read_b32 v167, a117
    v_mfma_f32_16x16x32_bf16 a[156:159], v[156:159], a[216:219], a[156:159]
    v_cvt_pk_bf16_f32 v180, v164, v165
    v_cvt_pk_bf16_f32 v181, v166, v167
    v_mfma_f32_16x16x32_bf16 a[28:31], v[160:163], a[220:223], a[28:31]
    v_perm_b32 v152, v207, v203, s43
    v_perm_b32 v153, v215, v211, s43
    v_mfma_f32_16x16x32_bf16 a[60:63], v[160:163], a[224:227], a[60:63]
    v_perm_b32 v154, v223, v219, s43
    v_perm_b32 v155, v231, v227, s43
    v_mfma_f32_16x16x32_bf16 a[92:95], v[160:163], a[228:231], a[92:95]
    v_accvgpr_read_b32 v168, a114
    v_accvgpr_read_b32 v169, a118
    v_accvgpr_read_b32 v170, a115
    v_mfma_f32_16x16x32_bf16 a[124:127], v[160:163], a[232:235], a[124:127]
    v_accvgpr_read_b32 v171, a119
    v_cvt_pk_bf16_f32 v182, v168, v169
    v_mfma_f32_16x16x32_bf16 a[156:159], v[160:163], a[236:239], a[156:159]
    v_cvt_pk_bf16_f32 v183, v170, v171
    buffer_store_dwordx4 v[180:183], v235, s[16:19], s73 offen offset:2048 sc1
    ds_write_b128 v240, v[180:183] offset:512
    v_mfma_f32_16x16x32_bf16 a[28:31], v[152:155], a[240:243], a[28:31]
    v_perm_b32 v156, v31, v27, s43
    v_perm_b32 v157, v39, v35, s43
    v_mfma_f32_16x16x32_bf16 a[60:63], v[152:155], a[244:247], a[60:63]
    v_perm_b32 v158, v47, v43, s43
    v_perm_b32 v159, v55, v51, s43
    v_mfma_f32_16x16x32_bf16 a[92:95], v[152:155], a[248:251], a[92:95]
    s_waitcnt lgkmcnt(5)
    v_accvgpr_read_b32 v172, a144
    v_accvgpr_read_b32 v173, a148
    v_mfma_f32_16x16x32_bf16 a[124:127], v[152:155], a[252:255], a[124:127]
    v_accvgpr_read_b32 v174, a145
    v_accvgpr_read_b32 v175, a149
    v_mfma_f32_16x16x32_bf16 a[156:159], v[152:155], v[248:251], a[156:159]
    v_cvt_pk_bf16_f32 v184, v172, v173
    v_cvt_pk_bf16_f32 v185, v174, v175
    v_accvgpr_read_b32 v164, a146
    v_mfma_f32_16x16x32_bf16 a[28:31], v[156:159], a[160:163], a[28:31]
    v_mfma_f32_16x16x32_bf16 a[60:63], v[156:159], a[164:167], a[60:63]
    v_mfma_f32_16x16x32_bf16 a[92:95], v[156:159], a[168:171], a[92:95]
    v_accvgpr_read_b32 v165, a150
    v_accvgpr_read_b32 v166, a147
    v_mfma_f32_16x16x32_bf16 a[124:127], v[156:159], a[172:175], a[124:127]
    v_accvgpr_read_b32 v167, a151
    v_cvt_pk_bf16_f32 v186, v164, v165
    v_cvt_pk_bf16_f32 v187, v166, v167
    v_mfma_f32_16x16x32_bf16 a[156:159], v[156:159], a[176:179], a[156:159]
    buffer_store_dwordx4 v[184:187], v236, s[16:19], s74 offen offset:2048 sc1
    ds_write_b128 v241, v[184:187] offset:512
    s_nop 7
    s_waitcnt lgkmcnt(5)
    v_accvgpr_read_b32 v164, a24
    v_accvgpr_read_b32 v165, a28
    v_accvgpr_read_b32 v166, a25
    v_accvgpr_read_b32 v167, a29
    v_cvt_pk_bf16_f32 v188, v164, v165
    v_cvt_pk_bf16_f32 v189, v166, v167
    v_accvgpr_read_b32 v168, a26
    v_accvgpr_read_b32 v169, a30
    v_accvgpr_read_b32 v170, a27
    v_accvgpr_read_b32 v171, a31
    v_cvt_pk_bf16_f32 v190, v168, v169
    v_cvt_pk_bf16_f32 v191, v170, v171
    buffer_store_dwordx4 v[188:191], v232, s[16:19], s70 offen offset:3072 sc1
    ds_write_b128 v237, v[188:191] offset:768
    s_waitcnt lgkmcnt(5)
    v_accvgpr_read_b32 v172, a56
    v_accvgpr_read_b32 v173, a60
    v_accvgpr_read_b32 v174, a57
    v_accvgpr_read_b32 v175, a61
    v_cvt_pk_bf16_f32 v192, v172, v173
    v_cvt_pk_bf16_f32 v193, v174, v175
    v_accvgpr_read_b32 v164, a58
    v_accvgpr_read_b32 v165, a62
    v_accvgpr_read_b32 v166, a59
    v_accvgpr_read_b32 v167, a63
    v_cvt_pk_bf16_f32 v194, v164, v165
    v_cvt_pk_bf16_f32 v195, v166, v167
    buffer_store_dwordx4 v[192:195], v233, s[16:19], s71 offen offset:3072 sc1
    ds_write_b128 v238, v[192:195] offset:768
    s_waitcnt lgkmcnt(5)
    v_accvgpr_read_b32 v168, a88
    v_accvgpr_read_b32 v169, a92
    v_accvgpr_read_b32 v170, a89
    v_accvgpr_read_b32 v171, a93
    v_cvt_pk_bf16_f32 v196, v168, v169
    v_cvt_pk_bf16_f32 v197, v170, v171
    v_accvgpr_read_b32 v172, a90
    v_accvgpr_read_b32 v173, a94
    v_accvgpr_read_b32 v174, a91
    v_accvgpr_read_b32 v175, a95
    v_cvt_pk_bf16_f32 v198, v172, v173
    v_cvt_pk_bf16_f32 v199, v174, v175
    buffer_store_dwordx4 v[196:199], v234, s[16:19], s72 offen offset:3072 sc1
    ds_write_b128 v239, v[196:199] offset:768
    s_waitcnt lgkmcnt(5)
    v_accvgpr_read_b32 v164, a120
    v_accvgpr_read_b32 v165, a124
    v_accvgpr_read_b32 v166, a121
    v_accvgpr_read_b32 v167, a125
    v_cvt_pk_bf16_f32 v176, v164, v165
    v_cvt_pk_bf16_f32 v177, v166, v167
    v_accvgpr_read_b32 v168, a122
    v_accvgpr_read_b32 v169, a126
    v_accvgpr_read_b32 v170, a123
    v_accvgpr_read_b32 v171, a127
    v_cvt_pk_bf16_f32 v178, v168, v169
    v_cvt_pk_bf16_f32 v179, v170, v171
    buffer_store_dwordx4 v[176:179], v235, s[16:19], s73 offen offset:3072 sc1
    ds_write_b128 v240, v[176:179] offset:768
    s_waitcnt lgkmcnt(5)
    v_accvgpr_read_b32 v172, a152
    v_accvgpr_read_b32 v173, a156
    v_accvgpr_read_b32 v174, a153
    v_accvgpr_read_b32 v175, a157
    v_cvt_pk_bf16_f32 v180, v172, v173
    v_cvt_pk_bf16_f32 v181, v174, v175
    v_accvgpr_read_b32 v164, a154
    v_accvgpr_read_b32 v165, a158
    v_accvgpr_read_b32 v166, a155
    v_accvgpr_read_b32 v167, a159
    v_cvt_pk_bf16_f32 v182, v164, v165
    v_cvt_pk_bf16_f32 v183, v166, v167
    buffer_store_dwordx4 v[180:183], v236, s[16:19], s74 offen offset:3072 sc1
    ds_write_b128 v241, v[180:183] offset:768
    buffer_load_dword v10, v6, s[16:19], s55 offen sc1
    v_and_b32 v128, 1, v2
    v_lshlrev_b32 v128, 4, v128
    v_mov_b32 v129, 0x3f80
    v_lshlrev_b32 v128, v128, v129
    v_bfe_u32 v129, v2, 1, 1
    v_lshrrev_b32 v130, 2, v2
    v_lshl_add_u32 v130, v130, 2, v129
    v_add_u32 v131, 0, v3
    v_cmp_eq_u32 vcc, v131, v130
    s_nop 1
    v_cndmask_b32 v120, 0, v128, vcc
    v_add_u32 v131, 4, v3
    v_cmp_eq_u32 vcc, v131, v130
    s_nop 1
    v_cndmask_b32 v121, 0, v128, vcc
    v_add_u32 v131, 8, v3
    v_cmp_eq_u32 vcc, v131, v130
    s_nop 1
    v_cndmask_b32 v122, 0, v128, vcc
    v_add_u32 v131, 12, v3
    v_cmp_eq_u32 vcc, v131, v130
    s_nop 1
    v_cndmask_b32 v123, 0, v128, vcc
    v_add_u32 v131, -2, v3
    v_cmp_eq_u32 vcc, v131, v130
    s_nop 1
    v_cndmask_b32 v124, 0, v128, vcc
    v_add_u32 v131, 2, v3
    v_cmp_eq_u32 vcc, v131, v130
    s_nop 1
    v_cndmask_b32 v125, 0, v128, vcc
    v_add_u32 v131, 6, v3
    v_cmp_eq_u32 vcc, v131, v130
    s_nop 1
    v_cndmask_b32 v126, 0, v128, vcc
    v_add_u32 v131, 10, v3
    v_cmp_eq_u32 vcc, v131, v130
    s_nop 1
    v_cndmask_b32 v127, 0, v128, vcc
    s_waitcnt vmcnt(1)
    s_mov_b64 exec, 1
    buffer_store_dword v17, v16, s[16:19], s75 offen sc1
    s_mov_b64 exec, -1
    s_waitcnt vmcnt(1)
    v_cmp_eq_u32 vcc, 1, v10
    s_and_b32 s39, vcc_lo, s47
    s_andn2_b32 s39, s39, s38
    s_cbranch_scc0 L_f0
    s_or_b32 s38, s38, s39
L_g0:
    s_ff1_i32_b32 s4, s39
    s_bitset0_b32 s39, s4
    s_mul_i32 s5, s4, 20736
    s_lshl_b32 s4, s4, 10
    s_add_u32 m0, s44, s4
    s_add_u32 s6, s48, s5
    buffer_load_dwordx4 v4, s[16:19], s6 offen sc1 nt lds
    s_add_u32 m0, s45, s4
    s_add_u32 s6, s49, s5
    buffer_load_dwordx4 v4, s[16:19], s6 offen sc1 nt lds
    s_add_u32 m0, s46, s4
    s_add_u32 s6, s50, s5
    buffer_load_dwordx4 v4, s[16:19], s6 offen sc1 nt lds
    s_cmp_lg_u32 s39, 0
    s_cbranch_scc1 L_g0
L_f0:
    s_waitcnt lgkmcnt(0)
    s_barrier
    s_cmp_eq_u32 s38, 0xff
    s_cbranch_scc1 L_go
L_poll0:
    v_cmp_ne_u32 vcc, s40, v8
    s_cbranch_vccz L_poll0e
    s_add_u32 s41, s41, 1
    s_cmp_gt_u32 s41, 0x40000
    s_cbranch_scc1 L_poll0e
    buffer_load_dwordx2 v[8:9], v16, s[76:79], s56 offen sc1
    s_waitcnt vmcnt(0)
    v_and_b32 v8, v8, v9
    s_branch L_poll0
L_poll0e:
    s_mov_b32 s47, 0xff
L_poll1:
    buffer_load_dword v10, v6, s[16:19], s55 offen sc1
    s_add_u32 s41, s41, 1
    s_waitcnt vmcnt(0)
    v_cmp_eq_u32 vcc, 1, v10
    s_and_b32 s39, vcc_lo, s47
    s_andn2_b32 s39, s39, s38
    s_cbranch_scc0 L_f1
    s_or_b32 s38, s38, s39
L_g1:
    s_ff1_i32_b32 s4, s39
    s_bitset0_b32 s39, s4
    s_mul_i32 s5, s4, 20736
    s_lshl_b32 s4, s4, 10
    s_add_u32 m0, s44, s4
    s_add_u32 s6, s48, s5
    buffer_load_dwordx4 v4, s[16:19], s6 offen sc1 nt lds
    s_add_u32 m0, s45, s4
    s_add_u32 s6, s49, s5
    buffer_load_dwordx4 v4, s[16:19], s6 offen sc1 nt lds
    s_add_u32 m0, s46, s4
    s_add_u32 s6, s50, s5
    buffer_load_dwordx4 v4, s[16:19], s6 offen sc1 nt lds
    s_cmp_lg_u32 s39, 0
    s_cbranch_scc1 L_g1
L_f1:
    s_cmp_eq_u32 s38, 0xff
    s_cbranch_scc1 L_go
    s_cmp_lt_u32 s41, 0x80000
    s_cbranch_scc1 L_poll1
L_go:
    s_waitcnt vmcnt(0)
    ds_read_b128 v[24:27], v7 offset:0
    ds_read_b128 v[28:31], v7 offset:1024
    ds_read_b128 v[32:35], v7 offset:2048
    ds_read_b128 v[36:39], v7 offset:3072
    ds_read_b128 v[40:43], v7 offset:4096
    ds_read_b128 v[44:47], v7 offset:5120
    ds_read_b128 v[48:51], v7 offset:6144
    ds_read_b128 v[52:55], v7 offset:7168
    ds_read_b128 v[56:59], v7 offset:32768
    ds_read_b128 v[60:63], v7 offset:33792
    ds_read_b128 v[64:67], v7 offset:34816
    ds_read_b128 v[68:71], v7 offset:35840
    s_waitcnt lgkmcnt(11)
    v_mfma_f32_16x16x32_bf16 v[136:139], v[120:123], v[24:27], 0
    v_mfma_f32_16x16x32_bf16 v[140:143], v[124:127], v[24:27], 0
    ds_read_b128 v[72:75], v7 offset:36864
    s_waitcnt lgkmcnt(11)
    v_mfma_f32_16x16x32_bf16 v[136:139], v[120:123], v[28:31], v[136:139]
    v_mfma_f32_16x16x32_bf16 v[140:143], v[124:127], v[28:31], v[140:143]
    ds_read_b128 v[76:79], v7 offset:37888
    s_waitcnt lgkmcnt(11)
    v_mfma_f32_16x16x32_bf16 v[136:139], v[120:123], v[32:35], v[136:139]
    v_mfma_f32_16x16x32_bf16 v[140:143], v[124:127], v[32:35], v[140:143]
    ds_read_b128 v[80:83], v7 offset:38912
    s_waitcnt lgkmcnt(11)
    v_mfma_f32_16x16x32_bf16 v[136:139], v[120:123], v[36:39], v[136:139]
    v_mfma_f32_16x16x32_bf16 v[140:143], v[124:127], v[36:39], v[140:143]
    ds_read_b128 v[84:87], v7 offset:39936
    s_waitcnt lgkmcnt(11)
    v_mfma_f32_16x16x32_bf16 v[136:139], v[120:123], v[40:43], v[136:139]
    v_mfma_f32_16x16x32_bf16 v[140:143], v[124:127], v[40:43], v[140:143]
    ds_read_b128 v[88:91], v11 offset:0
    s_waitcnt lgkmcnt(11)
    v_mfma_f32_16x16x32_bf16 v[136:139], v[120:123], v[44:47], v[136:139]
    v_mfma_f32_16x16x32_bf16 v[140:143], v[124:127], v[44:47], v[140:143]
    ds_read_b128 v[92:95], v11 offset:1024
    s_waitcnt lgkmcnt(11)
    v_mfma_f32_16x16x32_bf16 v[136:139], v[120:123], v[48:51], v[136:139]
    v_mfma_f32_16x16x32_bf16 v[140:143], v[124:127], v[48:51], v[140:143]
    ds_read_b128 v[96:99], v11 offset:2048
    s_waitcnt lgkmcnt(11)
    v_mfma_f32_16x16x32_bf16 v[136:139], v[120:123], v[52:55], v[136:139]
    v_mfma_f32_16x16x32_bf16 v[140:143], v[124:127], v[52:55], v[140:143]
    ds_read_b128 v[100:103], v11 offset:3072
    s_waitcnt lgkmcnt(11)
    v_mfma_f32_16x16x32_bf16 v[144:147], v[120:123], v[56:59], 0
    v_mfma_f32_16x16x32_bf16 v[148:151], v[124:127], v[56:59], 0
    ds_read_b128 v[104:107], v11 offset:4096
    s_waitcnt lgkmcnt(11)
    v_mfma_f32_16x16x32_bf16 v[144:147], v[120:123], v[60:63], v[144:147]
    v_mfma_f32_16x16x32_bf16 v[148:151], v[124:127], v[60:63], v[148:151]
    ds_read_b128 v[108:111], v11 offset:5120
    s_waitcnt lgkmcnt(11)
    v_mfma_f32_16x16x32_bf16 v[144:147], v[120:123], v[64:67], v[144:147]
    v_mfma_f32_16x16x32_bf16 v[148:151], v[124:127], v[64:67], v[148:151]
    ds_read_b128 v[112:115], v11 offset:6144
    s_waitcnt lgkmcnt(11)
    v_mfma_f32_16x16x32_bf16 v[144:147], v[120:123], v[68:71], v[144:147]
    v_mfma_f32_16x16x32_bf16 v[148:151], v[124:127], v[68:71], v[148:151]
    ds_read_b128 v[116:119], v11 offset:7168
    v_cvt_pk_bf16_f32 v160, v136, v137
    v_cvt_pk_bf16_f32 v161, v138, v139
    v_cvt_pk_bf16_f32 v162, v140, v141
    v_cvt_pk_bf16_f32 v163, v142, v143
    buffer_store_dwordx4 v[160:163], v5, s[80:83], s51 offen sc1
    s_waitcnt lgkmcnt(11)
    v_mfma_f32_16x16x32_bf16 v[144:147], v[120:123], v[72:75], v[144:147]
    v_mfma_f32_16x16x32_bf16 v[148:151], v[124:127], v[72:75], v[148:151]
    s_waitcnt lgkmcnt(10)
    v_mfma_f32_16x16x32_bf16 v[144:147], v[120:123], v[76:79], v[144:147]
    v_mfma_f32_16x16x32_bf16 v[148:151], v[124:127], v[76:79], v[148:151]
    s_waitcnt lgkmcnt(9)
    v_mfma_f32_16x16x32_bf16 v[144:147], v[120:123], v[80:83], v[144:147]
    v_mfma_f32_16x16x32_bf16 v[148:151], v[124:127], v[80:83], v[148:151]
    s_waitcnt lgkmcnt(8)
    v_mfma_f32_16x16x32_bf16 v[144:147], v[120:123], v[84:87], v[144:147]
    v_mfma_f32_16x16x32_bf16 v[148:151], v[124:127], v[84:87], v[148:151]
    s_waitcnt lgkmcnt(7)
    v_mfma_f32_16x16x32_bf16 v[152:155], v[120:123], v[88:91], 0
    v_mfma_f32_16x16x32_bf16 v[156:159], v[124:127], v[88:91], 0
    s_waitcnt lgkmcnt(6)
    v_mfma_f32_16x16x32_bf16 v[152:155], v[120:123], v[92:95], v[152:155]
    v_mfma_f32_16x16x32_bf16 v[156:159], v[124:127], v[92:95], v[156:159]
    s_waitcnt lgkmcnt(5)
    v_mfma_f32_16x16x32_bf16 v[152:155], v[120:123], v[96:99], v[152:155]
    v_mfma_f32_16x16x32_bf16 v[156:159], v[124:127], v[96:99], v[156:159]
    s_waitcnt lgkmcnt(4)
    v_mfma_f32_16x16x32_bf16 v[152:155], v[120:123], v[100:103], v[152:155]
    v_mfma_f32_16x16x32_bf16 v[156:159], v[124:127], v[100:103], v[156:159]
    v_cvt_pk_bf16_f32 v164, v144, v145
    v_cvt_pk_bf16_f32 v165, v146, v147
    v_cvt_pk_bf16_f32 v166, v148, v149
    v_cvt_pk_bf16_f32 v167, v150, v151
    buffer_store_dwordx4 v[164:167], v5, s[80:83], s52 offen sc1
    s_waitcnt lgkmcnt(3)
    v_mfma_f32_16x16x32_bf16 v[152:155], v[120:123], v[104:107], v[152:155]
    v_mfma_f32_16x16x32_bf16 v[156:159], v[124:127], v[104:107], v[156:159]
    s_waitcnt lgkmcnt(2)
    v_mfma_f32_16x16x32_bf16 v[152:155], v[120:123], v[108:111], v[152:155]
    v_mfma_f32_16x16x32_bf16 v[156:159], v[124:127], v[108:111], v[156:159]
    s_waitcnt lgkmcnt(1)
    v_mfma_f32_16x16x32_bf16 v[152:155], v[120:123], v[112:115], v[152:155]
    v_mfma_f32_16x16x32_bf16 v[156:159], v[124:127], v[112:115], v[156:159]
    s_waitcnt lgkmcnt(0)
    v_mfma_f32_16x16x32_bf16 v[152:155], v[120:123], v[116:119], v[152:155]
    v_mfma_f32_16x16x32_bf16 v[156:159], v[124:127], v[116:119], v[156:159]
    s_nop 7
    v_cvt_pk_bf16_f32 v168, v152, v153
    v_cvt_pk_bf16_f32 v169, v154, v155
    v_cvt_pk_bf16_f32 v170, v156, v157
    v_cvt_pk_bf16_f32 v171, v158, v159
    buffer_store_dwordx4 v[168:171], v5, s[80:83], s53 offen sc1
L_main_end:
    s_endpgm
L_code_end:
.section .rodata,"a"
.p2align 6
.amdhsa_kernel concat_heads__gqa_block_cached__gqa_block_cached__near_ridge_kernel
  .amdhsa_next_free_vgpr 512
  .amdhsa_next_free_sgpr 102
  .amdhsa_accum_offset 256
  .amdhsa_group_segment_fixed_size 0
  .amdhsa_kernarg_size 104
  .amdhsa_user_sgpr_count 2
  .amdhsa_user_sgpr_kernarg_segment_ptr 1
  .amdhsa_system_sgpr_workgroup_id_x 1
.end_amdhsa_kernel
```
